```python
import torch

def _softmax(x, axis=-1):
    return torch.softmax(x, dim=axis)
def _gelu(x):
    return torch.nn.functional.gelu(x, approximate="tanh")
def _silu(x):
    return torch.nn.functional.silu(x)
def _sigmoid(x):
    return torch.sigmoid(x)
def _layernorm(x, axis=-1, eps=1e-5):
    m = x.mean(dim=axis, keepdim=True)
    v = x.var(dim=axis, keepdim=True, unbiased=False)
    return (x - m) / torch.sqrt(v + eps)
def _scatter_add(tgt, idx, src, axis=0):
    return tgt.clone().index_add_(axis, idx, src)
def _segment_sum(src, seg, n):
    out = torch.zeros((n,) + src.shape[1:], dtype=src.dtype)
    return out.index_add_(0, seg, src)
def _pad(x, pw):
    flat = tuple(v for pair in reversed(pw) for v in pair)
    return torch.nn.functional.pad(x, flat)

kernel_name = 'gated_mix__softmax_full_mha__mixer_channel_mlp__prompt'

def setup_inputs():

    _w = (lambda a: (lambda t: t.to(torch.bfloat16) if t.is_floating_point() else t)(torch.as_tensor(a)))
    def _A_setup():
        B, S, D = 1, 2048, 640
        return {
            "x": _w((lambda *s: torch.randn(*s, dtype=torch.bfloat16) * 0.05)(B, S, D)),
            "wqkv": _w((lambda *s: torch.randn(*s, dtype=torch.bfloat16) * 0.8)(D, 3 * D)),
            "wo": _w((lambda *s: torch.randn(*s, dtype=torch.bfloat16) * 0.1)(D, D)),
        }
    _A_in = _A_setup()

    def _B_setup():
        B, S, D, F = 1, 2048, 640, 1536
        return {
            "x": _w((lambda *s: torch.randn(*s, dtype=torch.bfloat16) * 0.05)(B, S, D)),
            "w1": _w((lambda *s: torch.randn(*s, dtype=torch.bfloat16) * 1.6)(D, F) * (D ** -0.5)),
            "b1": _w((lambda *s: torch.randn(*s, dtype=torch.bfloat16) * 1.6)(F)),
            "w2": _w((lambda *s: torch.randn(*s, dtype=torch.bfloat16) * 0.05)(F, D) * (F ** -0.5)),
            "b2": _w((lambda *s: torch.randn(*s, dtype=torch.bfloat16) * 0.05)(D)),
        }
    _B_in = _B_setup()

    return {
        "A_x": _A_in["x"],
        "A_wqkv": _A_in["wqkv"],
        "A_wo": _A_in["wo"],
        "B_x": _B_in["x"],
        "B_w1": _B_in["w1"],
        "B_b1": _B_in["b1"],
        "B_w2": _B_in["w2"],
        "B_b2": _B_in["b2"],
        "gate_w": _w((lambda *s: torch.randn(*s, dtype=torch.bfloat16) * 0.05)(640) * 16.0),
    }

def reference(A_x, A_wqkv, A_wo, B_x, B_w1, B_b1, B_w2, B_b2, gate_w):
    def _A_ref(x, wqkv, wo):
        B, S, D = x.shape
        H = 32; Dh = D // H
        qkv = (lambda x, *d: x.permute(*d))((x @ wqkv).reshape(B, S, 3, H, Dh), 2, 0, 3, 1, 4)
        q, k, v = qkv[0], qkv[1], qkv[2]
        scale = Dh ** -0.5
        scores = torch.einsum("bhqd,bhkd->bhqk", q, k) * scale
        p = _softmax(scores, axis=-1)
        o = torch.einsum("bhqk,bhkd->bhqd", p, v)
        return (lambda x, *d: x.permute(*d))(o, 0, 2, 1, 3).reshape(B, S, D) @ wo

    def _B_ref(x, w1, b1, w2, b2):
        y = _layernorm(x, axis=-1)
        h = _gelu(torch.einsum("bsd,df->bsf", y, w1) + b1)
        return torch.einsum("bsf,fd->bsd", h, w2) + b2

    x = A_x
    g = _sigmoid((x * gate_w).sum(-1, keepdims=True))
    a = _A_ref(x, A_wqkv, A_wo)
    b = _B_ref(x, B_w1, B_b1, B_w2, B_b2)
    return g * a + (1 - g) * b
```

```asm
; @launch grid=(512,1,1) block=(512,1,1) lds=81920
.amdgcn_target "amdgcn-amd-amdhsa--gfx950"
.text
.globl gated_mix__softmax_full_mha__mixer_channel_mlp__prompt_kernel
.p2align 8
.type gated_mix__softmax_full_mha__mixer_channel_mlp__prompt_kernel,@function
gated_mix__softmax_full_mha__mixer_channel_mlp__prompt_kernel:

    s_cmp_ge_u32 s2, 512
    s_cbranch_scc1 pk_exit
    s_load_dwordx2 s[10:11], s[0:1], 88
    s_load_dwordx4 s[4:7], s[0:1], 0
    v_lshrrev_b32 v1, 6, v0
    v_and_b32 v0, 63, v0
    s_and_b32 s96, s2, 255
    v_readfirstlane_b32 s97, v1
    s_nop 3
    s_waitcnt lgkmcnt(0)
    s_cmp_lg_u32 s2, 0
    s_cbranch_scc1 nomake_1
    s_cmp_lg_u32 s97, 0
    s_cbranch_scc1 nomake_1
    s_load_dwordx2 s[8:9], s[0:1], 80
    s_mov_b64 exec, 1
    v_mov_b32 v2, 0x1f02000
    global_load_dword v3, v2, s[10:11] sc1
    s_waitcnt vmcnt(0) lgkmcnt(0)
    v_add_u32 v3, 1, v3
    v_max_u32 v3, 1, v3
    global_store_dword v2, v3, s[10:11] sc1
    v_mov_b32 v2, 0
    global_store_dword v2, v3, s[8:9] sc1
    s_mov_b64 exec, -1
nomake_1:
    s_cmp_ge_u32 s2, 256
    s_cbranch_scc1 pk_grole
    s_cmp_lg_u32 s97, 7
    s_cbranch_scc1 pc_2
    s_getpc_b64 s[40:41]
pch_3:
    s_sub_u32 s40, s40, pch_3-gated_mix__softmax_full_mha__mixer_channel_mlp__prompt_kernel
    s_subb_u32 s41, s41, 0
    s_lshr_b32 s42, s96, 3
    v_lshlrev_b32 v2, 5, v0
    v_add_u32 v2, s42, v2
    v_lshlrev_b32 v2, 7, v2
    v_min_u32 v2, pk_exit-gated_mix__softmax_full_mha__mixer_channel_mlp__prompt_kernel-4, v2
    global_load_dword v127, v2, s[40:41]
pc_2:
    s_load_dwordx4 s[4:7], s[0:1], 0
    s_load_dwordx2 s[8:9], s[0:1], 64
    s_waitcnt lgkmcnt(0)
    s_lshl_b32 s24, s96, 3
    s_add_u32 s24, s24, s97
    s_mul_i32 s25, s24, 1280
    v_lshlrev_b32 v10, 4, v0
    v_lshlrev_b32 v11, 2, v0
    v_add_u32 v12, s25, v10
    v_add_u32 v13, s25, v11
    global_load_dwordx4 v[16:19], v12, s[4:5]
    global_load_dword v20, v13, s[4:5] offset:1024
    global_load_dwordx4 v[32:35], v10, s[8:9]
    global_load_dword v36, v11, s[8:9] offset:1024
    s_waitcnt vmcnt(0)
    v_lshlrev_b32 v40, 16, v16
    v_and_b32 v41, 0xffff0000, v16
    v_lshlrev_b32 v42, 16, v17
    v_and_b32 v43, 0xffff0000, v17
    v_lshlrev_b32 v44, 16, v18
    v_and_b32 v45, 0xffff0000, v18
    v_lshlrev_b32 v46, 16, v19
    v_and_b32 v47, 0xffff0000, v19
    v_lshlrev_b32 v48, 16, v20
    v_and_b32 v49, 0xffff0000, v20
    v_lshlrev_b32 v60, 16, v32
    v_and_b32 v61, 0xffff0000, v32
    v_lshlrev_b32 v62, 16, v33
    v_and_b32 v63, 0xffff0000, v33
    v_lshlrev_b32 v64, 16, v34
    v_and_b32 v65, 0xffff0000, v34
    v_lshlrev_b32 v66, 16, v35
    v_and_b32 v67, 0xffff0000, v35
    v_lshlrev_b32 v68, 16, v36
    v_and_b32 v69, 0xffff0000, v36
    v_add_f32 v70, v40, v41
    v_mul_f32 v72, v40, v60
    v_add_f32 v70, v70, v42
    v_add_f32 v70, v70, v43
    v_add_f32 v70, v70, v44
    v_add_f32 v70, v70, v45
    v_add_f32 v70, v70, v46
    v_add_f32 v70, v70, v47
    v_add_f32 v70, v70, v48
    v_add_f32 v70, v70, v49
    v_fmac_f32 v72, v41, v61
    v_fmac_f32 v72, v42, v62
    v_fmac_f32 v72, v43, v63
    v_fmac_f32 v72, v44, v64
    v_fmac_f32 v72, v45, v65
    v_fmac_f32 v72, v46, v66
    v_fmac_f32 v72, v47, v67
    v_fmac_f32 v72, v48, v68
    v_fmac_f32 v72, v49, v69
    s_nop 0
    v_add_f32_dpp v70, v70, v70 row_ror:8 row_mask:0xf bank_mask:0xf
    v_add_f32_dpp v72, v72, v72 row_ror:8 row_mask:0xf bank_mask:0xf
    s_nop 0
    v_add_f32_dpp v70, v70, v70 row_ror:4 row_mask:0xf bank_mask:0xf
    v_add_f32_dpp v72, v72, v72 row_ror:4 row_mask:0xf bank_mask:0xf
    s_nop 0
    v_add_f32_dpp v70, v70, v70 row_ror:2 row_mask:0xf bank_mask:0xf
    v_add_f32_dpp v72, v72, v72 row_ror:2 row_mask:0xf bank_mask:0xf
    s_nop 0
    v_add_f32_dpp v70, v70, v70 row_ror:1 row_mask:0xf bank_mask:0xf
    v_add_f32_dpp v72, v72, v72 row_ror:1 row_mask:0xf bank_mask:0xf
    v_mov_b32 v74, v70
    v_mov_b32 v76, v72
    s_nop 0
    s_nop 0
    v_permlane16_swap_b32 v70, v74
    v_permlane16_swap_b32 v72, v76
    s_nop 0
    v_add_f32 v70, v70, v74
    v_add_f32 v72, v72, v76
    v_mov_b32 v74, v70
    v_mov_b32 v76, v72
    s_nop 0
    s_nop 0
    v_permlane32_swap_b32 v70, v74
    v_permlane32_swap_b32 v72, v76
    s_nop 0
    v_add_f32 v70, v70, v74
    v_add_f32 v72, v72, v76
    s_mov_b32 s26, 0x3acccccd
    v_mul_f32 v70, s26, v70
    v_sub_f32 v40, v40, v70
    v_sub_f32 v41, v41, v70
    v_sub_f32 v42, v42, v70
    v_sub_f32 v43, v43, v70
    v_sub_f32 v44, v44, v70
    v_sub_f32 v45, v45, v70
    v_sub_f32 v46, v46, v70
    v_sub_f32 v47, v47, v70
    v_sub_f32 v48, v48, v70
    v_sub_f32 v49, v49, v70
    v_mul_f32 v74, v40, v40
    v_fmac_f32 v74, v41, v41
    v_fmac_f32 v74, v42, v42
    v_fmac_f32 v74, v43, v43
    v_fmac_f32 v74, v44, v44
    v_fmac_f32 v74, v45, v45
    v_fmac_f32 v74, v46, v46
    v_fmac_f32 v74, v47, v47
    v_fmac_f32 v74, v48, v48
    v_fmac_f32 v74, v49, v49
    s_nop 1
    v_add_f32_dpp v74, v74, v74 row_ror:8 row_mask:0xf bank_mask:0xf
    s_nop 1
    v_add_f32_dpp v74, v74, v74 row_ror:4 row_mask:0xf bank_mask:0xf
    s_nop 1
    v_add_f32_dpp v74, v74, v74 row_ror:2 row_mask:0xf bank_mask:0xf
    s_nop 1
    v_add_f32_dpp v74, v74, v74 row_ror:1 row_mask:0xf bank_mask:0xf
    v_mov_b32 v76, v74
    s_nop 1
    s_nop 0
    v_permlane16_swap_b32 v74, v76
    s_nop 0
    s_nop 0
    v_add_f32 v74, v74, v76
    v_mov_b32 v76, v74
    s_nop 1
    s_nop 0
    v_permlane32_swap_b32 v74, v76
    s_nop 0
    s_nop 0
    v_add_f32 v74, v74, v76
    s_mov_b32 s27, 0x3727c5ac
    s_mov_b32 s28, 0xbfb8aa3b
    v_mov_b32 v78, s27
    v_fmac_f32 v78, s26, v74
    v_rsq_f32 v78, v78
    v_mul_f32 v72, s28, v72
    v_exp_f32 v72, v72
    v_mul_f32 v40, v40, v78
    v_mul_f32 v41, v41, v78
    v_mul_f32 v42, v42, v78
    v_mul_f32 v43, v43, v78
    v_mul_f32 v44, v44, v78
    v_mul_f32 v45, v45, v78
    v_mul_f32 v46, v46, v78
    v_mul_f32 v47, v47, v78
    v_mul_f32 v48, v48, v78
    v_mul_f32 v49, v49, v78
    v_add_f32 v72, 1.0, v72
    v_rcp_f32 v72, v72
    v_cvt_pk_bf16_f32 v80, v40, v41
    v_cvt_pk_bf16_f32 v81, v42, v43
    v_cvt_pk_bf16_f32 v82, v44, v45
    v_cvt_pk_bf16_f32 v83, v46, v47
    v_cvt_pk_bf16_f32 v84, v48, v49
    s_add_u32 s25, s25, 0x900000
    v_add_u32 v12, s25, v10
    v_add_u32 v13, s25, v11
    global_store_dwordx4 v12, v[80:83], s[10:11] sc1
    global_store_dword v13, v84, s[10:11] offset:1024 sc1
    s_lshl_b32 s24, s24, 2
    s_add_u32 s24, s24, 0xc00000
    v_mov_b32 v14, s24
    s_mov_b64 exec, 1
    global_store_dword v14, v72, s[10:11] sc1
    s_mov_b64 exec, -1
    s_cmp_lg_u32 s97, 0
    s_cbranch_scc1 nofetch_4
    s_load_dwordx2 s[8:9], s[0:1], 80
    v_mov_b32 v2, 0
    s_mov_b32 s56, 0
    s_waitcnt lgkmcnt(0)
ng_5:
    global_load_dword v3, v2, s[8:9] sc1
    s_add_u32 s56, s56, 1
    s_waitcnt vmcnt(0)
    v_readfirstlane_b32 s100, v3
    s_nop 3
    s_cmp_lg_u32 s100, 0
    s_cbranch_scc1 ngok_6
    s_sleep 4
    s_cmp_lt_u32 s56, 0x8000
    s_cbranch_scc1 ng_5
ngok_6:
nofetch_4:
    s_waitcnt vmcnt(0)
    s_barrier
    s_cmp_lg_u32 s97, 0
    s_cbranch_scc1 lnsig_7
    s_lshr_b32 s24, s96, 4
    s_and_b32 s25, s96, 15
    s_lshl_b32 s56, s24, 7
    s_lshl_b32 s57, s25, 2
    s_add_u32 s56, s56, s57
    s_add_u32 s56, s56, 0x1f00000
    v_mov_b32 v2, s56
    v_mov_b32 v3, s100
    s_mov_b64 exec, 1
    global_store_dword v2, v3, s[10:11] sc1
    s_mov_b64 exec, -1
lnsig_7:
    s_mov_b32 s12, s97
    s_and_b32 s13, s96, 7
    s_lshr_b32 s14, s96, 3
    s_and_b32 s14, s14, 3
    s_lshl_b32 s14, s14, 3
    s_add_u32 s13, s13, s14
    s_lshr_b32 s14, s96, 5
    v_lshlrev_b32 v1, 4, v0
    s_and_b32 s20, s12, 3
    s_lshr_b32 s21, s12, 2
    s_lshl_b32 s15, s14, 3
    s_lshl_b32 s22, s20, 1
    s_add_u32 s15, s15, s22
    s_mov_b32 s16, s10
    s_mov_b32 s17, s11
    s_mov_b32 s18, 0x600000
    s_mov_b32 s19, 0x20000
    s_mul_i32 s42, s13, 5
    s_and_b32 s43, s42, 1
    s_lshr_b32 s42, s42, 1
    s_lshl_b32 s27, s42, 11
    s_add_u32 s27, s27, 0x0
    s_mul_i32 s28, s13, 1280
    s_add_u32 s28, s28, 0x300000
    s_add_u32 s44, s12, 0
    s_lshl_b32 s47, s44, 10
    s_cmp_ge_u32 s44, 12
    s_cbranch_scc1 dv_8
    s_mov_b32 s50, 327680
    s_lshr_b32 s29, s44, 2
    s_lshl_b32 s29, s29, 11
    s_add_u32 s29, s29, s27
    s_and_b32 s40, s44, 1
    s_lshl_b32 s40, s40, 10
    s_add_u32 s29, s29, s40
    s_bfe_u32 s40, s44, 0x10001
    s_mul_i32 s40, s40, 163840
    s_add_u32 s29, s29, s40
    v_add_u32 v124, s29, v1
    s_branch de_9
dv_8:
    s_mov_b32 s50, 327680
    s_sub_u32 s29, s44, 12
    s_lshl_b32 s29, s29, 6
    v_add_u32 v6, s29, v0
    v_mul_u32_u24 v7, 1986, v6
    v_lshrrev_b32 v7, 16, v7
    v_mul_u32_u24 v2, 33, v7
    v_sub_u32 v6, v6, v2
    v_min_u32 v6, 31, v6
    v_min_u32 v7, 19, v7
    v_lshlrev_b32 v7, 6, v7
    v_lshrrev_b32 v2, 2, v6
    v_mul_u32_u24 v2, 40960, v2
    v_and_b32 v6, 3, v6
    v_lshl_add_u32 v7, v6, 4, v7
    v_add3_u32 v124, s28, v7, v2
de_9:
    s_add_u32 s45, s12, 8
    s_lshl_b32 s48, s45, 10
    s_cmp_ge_u32 s45, 12
    s_cbranch_scc1 dv_10
    s_mov_b32 s51, 327680
    s_lshr_b32 s29, s45, 2
    s_lshl_b32 s29, s29, 11
    s_add_u32 s29, s29, s27
    s_and_b32 s40, s45, 1
    s_lshl_b32 s40, s40, 10
    s_add_u32 s29, s29, s40
    s_bfe_u32 s40, s45, 0x10001
    s_mul_i32 s40, s40, 163840
    s_add_u32 s29, s29, s40
    v_add_u32 v125, s29, v1
    s_branch de_11
dv_10:
    s_mov_b32 s51, 327680
    s_sub_u32 s29, s45, 12
    s_lshl_b32 s29, s29, 6
    v_add_u32 v6, s29, v0
    v_mul_u32_u24 v7, 1986, v6
    v_lshrrev_b32 v7, 16, v7
    v_mul_u32_u24 v2, 33, v7
    v_sub_u32 v6, v6, v2
    v_min_u32 v6, 31, v6
    v_min_u32 v7, 19, v7
    v_lshlrev_b32 v7, 6, v7
    v_lshrrev_b32 v2, 2, v6
    v_mul_u32_u24 v2, 40960, v2
    v_and_b32 v6, 3, v6
    v_lshl_add_u32 v7, v6, 4, v7
    v_add3_u32 v125, s28, v7, v2
de_11:
    s_add_u32 s46, s12, 16
    s_cmp_lt_u32 s12, 7
    s_cselect_b32 s46, s46, s45
    s_lshl_b32 s49, s46, 10
    s_cmp_ge_u32 s46, 12
    s_cbranch_scc1 dv_12
    s_mov_b32 s52, 327680
    s_lshr_b32 s29, s46, 2
    s_lshl_b32 s29, s29, 11
    s_add_u32 s29, s29, s27
    s_and_b32 s40, s46, 1
    s_lshl_b32 s40, s40, 10
    s_add_u32 s29, s29, s40
    s_bfe_u32 s40, s46, 0x10001
    s_mul_i32 s40, s40, 163840
    s_add_u32 s29, s29, s40
    v_add_u32 v126, s29, v1
    s_branch de_13
dv_12:
    s_mov_b32 s52, 327680
    s_sub_u32 s29, s46, 12
    s_lshl_b32 s29, s29, 6
    v_add_u32 v6, s29, v0
    v_mul_u32_u24 v7, 1986, v6
    v_lshrrev_b32 v7, 16, v7
    v_mul_u32_u24 v2, 33, v7
    v_sub_u32 v6, v6, v2
    v_min_u32 v6, 31, v6
    v_min_u32 v7, 19, v7
    v_lshlrev_b32 v7, 6, v7
    v_lshrrev_b32 v2, 2, v6
    v_mul_u32_u24 v2, 40960, v2
    v_and_b32 v6, 3, v6
    v_lshl_add_u32 v7, v6, 4, v7
    v_add3_u32 v126, s28, v7, v2
de_13:
    s_cmp_eq_u32 s12, 6
    s_cselect_b32 s54, 0x000fffff, -1
    s_cselect_b32 s55, 0, -1
    s_cmp_lg_u32 s97, 0
    s_cbranch_scc1 kvw_14
    s_lshl_b32 s56, s96, 7
    s_add_u32 s56, s56, 0x1f08000
    v_mov_b32 v2, s56
    s_mov_b32 s57, 0
hw_15:
    global_load_dword v3, v2, s[10:11] sc1
    s_add_u32 s57, s57, 1
    s_waitcnt vmcnt(0)
    v_readfirstlane_b32 s56, v3
    s_nop 3
    s_cmp_eq_u32 s56, s100
    s_cbranch_scc1 hwok_16
    s_sleep 4
    s_cmp_lt_u32 s57, 28
    s_cbranch_scc1 hw_15
hwok_16:
    s_mul_i32 s27, s13, 20
    s_lshr_b32 s28, s27, 7
    s_add_u32 s27, s27, 19
    s_lshr_b32 s27, s27, 7
    v_mbcnt_lo_u32_b32 v2, -1, 0
    v_mbcnt_hi_u32_b32 v2, -1, v2
    v_and_b32 v3, 15, v2
    v_bfe_u32 v4, v2, 4, 1
    v_lshrrev_b32 v5, 5, v2
    v_mov_b32 v6, s28
    v_mov_b32 v7, s27
    v_cmp_eq_u32 vcc, 0, v4
    v_mul_u32_u24 v5, 5, v5
    s_nop 0
    v_cndmask_b32 v6, v7, v6, vcc
    v_add_u32 v5, v5, v6
    v_lshlrev_b32 v5, 7, v5
    v_lshl_add_u32 v5, v3, 2, v5
    v_add_u32 v5, 0x1f00800, v5
    v_add_u32 v6, 10, v6
    v_lshlrev_b32 v6, 7, v6
    v_lshl_add_u32 v6, v3, 2, v6
    v_add_u32 v6, 0x1f00800, v6
    s_mov_b32 s57, 0
qw_17:
    global_load_dword v3, v5, s[10:11] sc1
    global_load_dword v4, v6, s[10:11] sc1
    s_add_u32 s57, s57, 1
    s_waitcnt vmcnt(0)
    v_cmp_ne_u32 vcc, s100, v3
    v_cmp_ne_u32 s[40:41], s100, v4
    s_or_b64 vcc, vcc, s[40:41]
    s_cbranch_vccz qwok_18
    s_sleep 2
    s_cmp_lt_u32 s57, 0x8000
    s_cbranch_scc1 qw_17
qwok_18:
kvw_14:
    s_barrier
    s_lshl_b32 s27, s42, 11
    s_lshr_b32 s28, s15, 2
    s_mul_i32 s28, s28, 163840
    s_add_u32 s27, s27, s28
    s_and_b32 s28, s15, 3
    s_lshl_b32 s28, s28, 9
    s_add_u32 s27, s27, s28
    s_add_u32 s27, s27, 0x600000
    v_and_b32 v7, 31, v0
    v_lshrrev_b32 v6, 5, v0
    v_add_u32 v6, s43, v6
    v_lshrrev_b32 v2, 1, v6
    v_lshlrev_b32 v2, 11, v2
    v_and_b32 v6, 1, v6
    v_lshl_add_u32 v6, v6, 3, v2
    v_lshl_add_u32 v6, v7, 4, v6
    v_add_u32 v6, s27, v6
    v_add_u32 v2, 2048, v6
    s_lshl_b32 s28, s43, 3
    s_add_u32 s27, s27, s28
    s_add_u32 s27, s27, 4096
    v_lshl_add_u32 v7, v7, 4, s27
    global_load_dwordx2 v[8:9], v6, s[10:11] offset:0 sc1
    global_load_dwordx2 v[10:11], v2, s[10:11] offset:0 sc1
    global_load_dwordx2 v[12:13], v7, s[10:11] offset:0 sc1
    global_load_dwordx2 v[16:17], v6, s[10:11] offset:512 sc1
    global_load_dwordx2 v[18:19], v2, s[10:11] offset:512 sc1
    global_load_dwordx2 v[20:21], v7, s[10:11] offset:512 sc1
    s_mov_b32 s35, 0
    v_mov_b32 v7, 0
    v_mov_b32 v6, 71712
    ds_write_b32 v6, v7
pk_restart:
    s_add_u32 s34, s14, 1
    s_and_b32 s34, s34, 7
    s_add_u32 m0, s47, 0
    s_mul_i32 s28, s50, s14
    buffer_load_dwordx4 v124, s[16:19], s28 offen sc1 lds
    s_add_u32 m0, s48, 0
    s_mul_i32 s28, s51, s14
    buffer_load_dwordx4 v125, s[16:19], s28 offen sc1 lds
    s_add_u32 m0, s49, 0
    s_mul_i32 s28, s52, s14
    s_mov_b64 exec, s[54:55]
    buffer_load_dwordx4 v126, s[16:19], s28 offen sc1 lds
    s_mov_b64 exec, -1
    s_add_u32 m0, s47, 23904
    s_mul_i32 s28, s50, s34
    buffer_load_dwordx4 v124, s[16:19], s28 offen sc1 lds
    s_add_u32 m0, s48, 23904
    s_mul_i32 s28, s51, s34
    buffer_load_dwordx4 v125, s[16:19], s28 offen sc1 lds
    s_add_u32 m0, s49, 23904
    s_mul_i32 s28, s52, s34
    s_mov_b64 exec, s[54:55]
    buffer_load_dwordx4 v126, s[16:19], s28 offen sc1 lds
    s_mov_b64 exec, -1
    s_cmp_ge_u32 s12, 3
    s_cbranch_scc1 crow_19
    s_mul_i32 s29, s12, 23904
    s_add_u32 s29, s29, 22848
    v_add_u32 v6, s29, v1
    v_mov_b32 v112, 0x3f803f80
    v_mov_b32 v113, 0x3f803f80
    v_mov_b32 v114, 0x3f803f80
    v_mov_b32 v115, 0x3f803f80
    v_mov_b32 v116, 0
    v_mov_b32 v117, 0
    v_mov_b32 v118, 0
    v_mov_b32 v119, 0
    v_cmp_gt_u32 vcc, 33, v0
    s_and_saveexec_b64 s[40:41], vcc
    ds_write_b128 v6, v[112:115]
    ds_write_b128 v6, v[116:119] offset:528
    s_mov_b64 exec, s[40:41]
crow_19:
    s_mov_b32 s36, 0
    s_lshl_b32 s29, s36, 11
    v_and_b32 v7, 31, v0
    v_lshrrev_b32 v5, 5, v0
    v_add_u32 v2, s43, v5
    v_and_b32 v3, 1, v2
    v_lshrrev_b32 v2, 1, v2
    v_lshlrev_b32 v2, 12, v2
    v_lshl_add_u32 v2, v3, 3, v2
    v_lshl_add_u32 v3, v7, 4, s29
    v_add_u32 v2, v2, v3
    s_lshl_b32 s29, s43, 3
    s_add_u32 s29, s29, 8192
    v_add_u32 v3, s29, v3
    s_lshl_b32 s29, s36, 8
    s_add_u32 s29, s29, 12288
    v_min_u32 v4, 21, v7
    v_mul_u32_u24 v4, 528, v4
    v_lshlrev_b32 v5, 4, v5
    v_add3_u32 v4, v4, v5, s29
    v_mov_b32 v5, v4
    v_mov_b32 v30, 0x3f803f80
    v_mov_b32 v31, 0x00003f80
    v_mov_b32 v48, 0
    v_mov_b32 v49, 0
    v_mov_b32 v50, 0
    v_mov_b32 v51, 0
    v_mov_b32 v52, 0
    v_mov_b32 v53, 0
    v_mov_b32 v54, 0
    v_mov_b32 v55, 0
    v_mov_b32 v56, 0
    v_mov_b32 v57, 0
    v_mov_b32 v58, 0
    v_mov_b32 v59, 0
    v_mov_b32 v60, 0
    v_mov_b32 v61, 0
    v_mov_b32 v62, 0
    v_mov_b32 v63, 0
    v_mov_b32 v64, 0
    v_mov_b32 v65, 0
    v_mov_b32 v66, 0
    v_mov_b32 v67, 0
    v_mov_b32 v68, 0
    v_mov_b32 v69, 0
    v_mov_b32 v70, 0
    v_mov_b32 v71, 0
    v_mov_b32 v72, 0
    v_mov_b32 v73, 0
    v_mov_b32 v74, 0
    v_mov_b32 v75, 0
    v_mov_b32 v76, 0
    v_mov_b32 v77, 0
    v_mov_b32 v78, 0
    v_mov_b32 v79, 0
    v_mov_b32 v44, 0
    v_mov_b32 v45, 0
    v_mov_b32 v46, 0
    v_mov_b32 v47, 0
    s_mov_b32 s30, 0
    s_mov_b32 s31, 2
    s_mov_b32 s32, 47808
    s_mov_b32 s33, 0
    s_mov_b32 s38, 0xffff4540
    s_mov_b32 s39, 23904
    s_cmp_lg_u32 s35, 0
    s_cbranch_scc1 pk_second
    s_waitcnt vmcnt(6)
    v_cmp_gt_u32 vcc, 32, v0
    s_nop 1
    v_cndmask_b32 v12, 0, v12, vcc
    v_cndmask_b32 v13, 0, v13, vcc
    v_mov_b32 v14, 0
    v_mov_b32 v15, 0
    v_cndmask_b32 v20, 0, v20, vcc
    v_cndmask_b32 v21, 0, v21, vcc
    v_mov_b32 v22, 0
    v_mov_b32 v23, 0
pk_second:
    s_waitcnt vmcnt(3) lgkmcnt(0)
    s_barrier
    s_cmp_lg_u32 s35, 0
    s_cbranch_scc1 pk_havec
    ds_read_b64 v[24:25], v2
    ds_read_b64 v[26:27], v2 offset:4096
    ds_read_b64 v[28:29], v3
    s_waitcnt lgkmcnt(0)
    v_mfma_f32_32x32x16_bf16 v[80:95], v[24:27], v[8:11], 0
    v_mfma_f32_32x32x16_bf16 v[96:111], v[24:27], v[16:19], 0
    v_mfma_f32_32x32x16_bf16 v[80:95], v[28:31], v[12:15], v[80:95]
    v_mfma_f32_32x32x16_bf16 v[96:111], v[28:31], v[20:23], v[96:111]
    s_nop 15
    v_max3_f32 v112, v80, v81, v82
    v_max3_f32 v112, v112, v83, v84
    v_max3_f32 v112, v112, v85, v86
    v_max3_f32 v112, v112, v87, v88
    v_max3_f32 v112, v112, v89, v90
    v_max3_f32 v112, v112, v91, v92
    v_max3_f32 v112, v112, v93, v94
    v_max_f32 v112, v112, v95
    v_max3_f32 v113, v96, v97, v98
    v_max3_f32 v113, v113, v99, v100
    v_max3_f32 v113, v113, v101, v102
    v_max3_f32 v113, v113, v103, v104
    v_max3_f32 v113, v113, v105, v106
    v_max3_f32 v113, v113, v107, v108
    v_max3_f32 v113, v113, v109, v110
    v_max_f32 v113, v113, v111
    v_mov_b32 v120, v112
    s_nop 1
    v_permlane32_swap_b32 v112, v120
    s_nop 0
    v_max_f32 v112, v112, v120
    v_sub_f32 v112, 0, v112
    v_cvt_pk_bf16_f32 v120, v112, v112
    v_lshlrev_b32 v120, 16, v120
    v_sub_f32 v121, v112, v120
    v_cvt_pk_bf16_f32 v122, v121, v121
    v_lshlrev_b32 v122, 16, v122
    v_sub_f32 v121, v121, v122
    v_cmp_gt_u32 vcc, 32, v0
    v_cvt_pk_bf16_f32 v14, v120, v122
    v_mov_b32 v123, 0
    v_cvt_pk_bf16_f32 v15, v121, v123
    v_cndmask_b32 v14, 0, v14, vcc
    v_cndmask_b32 v15, 0, v15, vcc
    v_mov_b32 v120, v113
    s_nop 1
    v_permlane32_swap_b32 v113, v120
    s_nop 0
    v_max_f32 v113, v113, v120
    v_sub_f32 v113, 0, v113
    v_cvt_pk_bf16_f32 v120, v113, v113
    v_lshlrev_b32 v120, 16, v120
    v_sub_f32 v121, v113, v120
    v_cvt_pk_bf16_f32 v122, v121, v121
    v_lshlrev_b32 v122, 16, v122
    v_sub_f32 v121, v121, v122
    v_cmp_gt_u32 vcc, 32, v0
    v_cvt_pk_bf16_f32 v22, v120, v122
    v_mov_b32 v123, 0
    v_cvt_pk_bf16_f32 v23, v121, v123
    v_cndmask_b32 v22, 0, v22, vcc
    v_cndmask_b32 v23, 0, v23, vcc
pk_havec:
    s_lshl_b32 s29, s21, 11
    v_and_b32 v7, 31, v0
    v_lshrrev_b32 v5, 5, v0
    v_add_u32 v2, s43, v5
    v_and_b32 v3, 1, v2
    v_lshrrev_b32 v2, 1, v2
    v_lshlrev_b32 v2, 12, v2
    v_lshl_add_u32 v2, v3, 3, v2
    v_lshl_add_u32 v3, v7, 4, s29
    v_add_u32 v2, v2, v3
    s_lshl_b32 s29, s43, 3
    s_add_u32 s29, s29, 8192
    v_add_u32 v3, s29, v3
    s_lshl_b32 s29, s21, 8
    s_add_u32 s29, s29, 12288
    v_min_u32 v4, 21, v7
    v_mul_u32_u24 v4, 528, v4
    v_lshlrev_b32 v5, 4, v5
    v_add3_u32 v4, v4, v5, s29
    v_mov_b32 v5, v4
    ds_read_b64 v[24:25], v2
    ds_read_b64 v[26:27], v2 offset:4096
    ds_read_b64 v[28:29], v3
    ds_read_b128 v[36:39], v5 offset:32
    ds_read_b128 v[32:35], v4
    s_waitcnt lgkmcnt(0)
    v_mfma_f32_32x32x16_bf16 v[80:95], v[24:27], v[8:11], 0
    v_mfma_f32_32x32x16_bf16 v[80:95], v[28:31], v[12:15], v[80:95]
    s_nop 7
    s_nop 3
    .p2align 6
pk_loop:
    s_setprio 1
    v_mfma_f32_32x32x16_bf16 v[96:111], v[24:27], v[16:19], 0
    ds_read_b64 v[24:25], v2 offset:512
    ds_read_b64 v[26:27], v2 offset:4608
    v_exp_f32 v80, v80
    v_exp_f32 v81, v81
    v_exp_f32 v82, v82
    v_exp_f32 v83, v83
    v_cvt_pk_bf16_f32 v40, v80, v81
    v_cvt_pk_bf16_f32 v41, v82, v83
    v_mfma_f32_32x32x16_bf16 v[96:111], v[28:31], v[20:23], v[96:111]
    ds_read_b64 v[28:29], v3 offset:512
    v_exp_f32 v84, v84
    v_exp_f32 v85, v85
    v_exp_f32 v86, v86
    v_exp_f32 v87, v87
    v_cvt_pk_bf16_f32 v42, v84, v85
    v_cvt_pk_bf16_f32 v43, v86, v87
    v_mfma_f32_32x32x16_bf16 v[64:79], v[36:39], v[44:47], v[64:79]
    ds_read_b128 v[36:39], v5 offset:32
    v_exp_f32 v88, v88
    v_exp_f32 v89, v89
    v_exp_f32 v90, v90
    v_exp_f32 v91, v91
    v_cvt_pk_bf16_f32 v44, v88, v89
    v_cvt_pk_bf16_f32 v45, v90, v91
    s_waitcnt lgkmcnt(4)
    v_mfma_f32_32x32x16_bf16 v[48:63], v[32:35], v[40:43], v[48:63]
    v_exp_f32 v92, v92
    v_exp_f32 v93, v93
    v_exp_f32 v94, v94
    v_exp_f32 v95, v95
    v_cvt_pk_bf16_f32 v46, v92, v93
    v_cvt_pk_bf16_f32 v47, v94, v95
    s_waitcnt lgkmcnt(0)
    v_mfma_f32_32x32x16_bf16 v[80:95], v[24:27], v[8:11], 0
    v_exp_f32 v96, v96
    v_exp_f32 v97, v97
    v_exp_f32 v98, v98
    v_exp_f32 v99, v99
    v_cvt_pk_bf16_f32 v40, v96, v97
    v_cvt_pk_bf16_f32 v41, v98, v99
    v_mfma_f32_32x32x16_bf16 v[80:95], v[28:31], v[12:15], v[80:95]
    v_exp_f32 v100, v100
    v_exp_f32 v101, v101
    v_exp_f32 v102, v102
    v_exp_f32 v103, v103
    v_cvt_pk_bf16_f32 v42, v100, v101
    v_cvt_pk_bf16_f32 v43, v102, v103
    v_mfma_f32_32x32x16_bf16 v[48:63], v[36:39], v[44:47], v[48:63]
    v_exp_f32 v104, v104
    v_exp_f32 v105, v105
    v_exp_f32 v106, v106
    v_exp_f32 v107, v107
    v_cvt_pk_bf16_f32 v44, v104, v105
    v_cvt_pk_bf16_f32 v45, v106, v107
    v_mfma_f32_32x32x16_bf16 v[64:79], v[32:35], v[40:43], v[64:79]
    ds_read_b128 v[32:35], v4 offset:64
    v_exp_f32 v108, v108
    v_exp_f32 v109, v109
    v_exp_f32 v110, v110
    v_exp_f32 v111, v111
    v_cvt_pk_bf16_f32 v46, v108, v109
    v_cvt_pk_bf16_f32 v47, v110, v111
    v_mfma_f32_32x32x16_bf16 v[96:111], v[24:27], v[16:19], 0
    ds_read_b64 v[24:25], v2 offset:1024
    ds_read_b64 v[26:27], v2 offset:5120
    v_exp_f32 v80, v80
    v_exp_f32 v81, v81
    v_exp_f32 v82, v82
    v_exp_f32 v83, v83
    v_cvt_pk_bf16_f32 v40, v80, v81
    v_cvt_pk_bf16_f32 v41, v82, v83
    v_mfma_f32_32x32x16_bf16 v[96:111], v[28:31], v[20:23], v[96:111]
    ds_read_b64 v[28:29], v3 offset:1024
    v_exp_f32 v84, v84
    v_exp_f32 v85, v85
    v_exp_f32 v86, v86
    v_exp_f32 v87, v87
    v_cvt_pk_bf16_f32 v42, v84, v85
    v_cvt_pk_bf16_f32 v43, v86, v87
    v_mfma_f32_32x32x16_bf16 v[64:79], v[36:39], v[44:47], v[64:79]
    ds_read_b128 v[36:39], v5 offset:96
    v_exp_f32 v88, v88
    v_exp_f32 v89, v89
    v_exp_f32 v90, v90
    v_exp_f32 v91, v91
    v_cvt_pk_bf16_f32 v44, v88, v89
    v_cvt_pk_bf16_f32 v45, v90, v91
    s_waitcnt lgkmcnt(4)
    v_mfma_f32_32x32x16_bf16 v[48:63], v[32:35], v[40:43], v[48:63]
    v_exp_f32 v92, v92
    v_exp_f32 v93, v93
    v_exp_f32 v94, v94
    v_exp_f32 v95, v95
    v_cvt_pk_bf16_f32 v46, v92, v93
    v_cvt_pk_bf16_f32 v47, v94, v95
    s_waitcnt lgkmcnt(0)
    s_setprio 0
    v_mfma_f32_32x32x16_bf16 v[80:95], v[24:27], v[8:11], 0
    v_exp_f32 v96, v96
    v_exp_f32 v97, v97
    v_exp_f32 v98, v98
    v_exp_f32 v99, v99
    v_cvt_pk_bf16_f32 v40, v96, v97
    v_cvt_pk_bf16_f32 v41, v98, v99
    v_mfma_f32_32x32x16_bf16 v[80:95], v[28:31], v[12:15], v[80:95]
    v_exp_f32 v100, v100
    v_exp_f32 v101, v101
    v_exp_f32 v102, v102
    v_exp_f32 v103, v103
    v_cvt_pk_bf16_f32 v42, v100, v101
    v_cvt_pk_bf16_f32 v43, v102, v103
    v_mfma_f32_32x32x16_bf16 v[48:63], v[36:39], v[44:47], v[48:63]
    v_exp_f32 v104, v104
    v_exp_f32 v105, v105
    v_exp_f32 v106, v106
    v_exp_f32 v107, v107
    v_cvt_pk_bf16_f32 v44, v104, v105
    v_cvt_pk_bf16_f32 v45, v106, v107
    v_mfma_f32_32x32x16_bf16 v[64:79], v[32:35], v[40:43], v[64:79]
    ds_read_b128 v[32:35], v4 offset:128
    v_exp_f32 v108, v108
    v_exp_f32 v109, v109
    v_exp_f32 v110, v110
    v_exp_f32 v111, v111
    v_cvt_pk_bf16_f32 v46, v108, v109
    v_cvt_pk_bf16_f32 v47, v110, v111
    v_mfma_f32_32x32x16_bf16 v[96:111], v[24:27], v[16:19], 0
    ds_read_b64 v[24:25], v2 offset:1536
    ds_read_b64 v[26:27], v2 offset:5632
    v_exp_f32 v80, v80
    v_exp_f32 v81, v81
    v_exp_f32 v82, v82
    v_exp_f32 v83, v83
    v_cvt_pk_bf16_f32 v40, v80, v81
    v_cvt_pk_bf16_f32 v41, v82, v83
    v_mfma_f32_32x32x16_bf16 v[96:111], v[28:31], v[20:23], v[96:111]
    ds_read_b64 v[28:29], v3 offset:1536
    v_exp_f32 v84, v84
    v_exp_f32 v85, v85
    v_exp_f32 v86, v86
    v_exp_f32 v87, v87
    v_cvt_pk_bf16_f32 v42, v84, v85
    v_cvt_pk_bf16_f32 v43, v86, v87
    v_mfma_f32_32x32x16_bf16 v[64:79], v[36:39], v[44:47], v[64:79]
    ds_read_b128 v[36:39], v5 offset:160
    v_exp_f32 v88, v88
    v_exp_f32 v89, v89
    v_exp_f32 v90, v90
    v_exp_f32 v91, v91
    v_cvt_pk_bf16_f32 v44, v88, v89
    v_cvt_pk_bf16_f32 v45, v90, v91
    s_waitcnt lgkmcnt(4)
    v_mfma_f32_32x32x16_bf16 v[48:63], v[32:35], v[40:43], v[48:63]
    v_exp_f32 v92, v92
    v_exp_f32 v93, v93
    v_exp_f32 v94, v94
    v_exp_f32 v95, v95
    v_cvt_pk_bf16_f32 v46, v92, v93
    v_cvt_pk_bf16_f32 v47, v94, v95
    s_waitcnt lgkmcnt(0)
    v_mfma_f32_32x32x16_bf16 v[80:95], v[24:27], v[8:11], 0
    v_exp_f32 v96, v96
    v_exp_f32 v97, v97
    v_exp_f32 v98, v98
    v_exp_f32 v99, v99
    v_cvt_pk_bf16_f32 v40, v96, v97
    v_cvt_pk_bf16_f32 v41, v98, v99
    v_mfma_f32_32x32x16_bf16 v[80:95], v[28:31], v[12:15], v[80:95]
    v_exp_f32 v100, v100
    v_exp_f32 v101, v101
    v_exp_f32 v102, v102
    v_exp_f32 v103, v103
    v_cvt_pk_bf16_f32 v42, v100, v101
    v_cvt_pk_bf16_f32 v43, v102, v103
    v_mfma_f32_32x32x16_bf16 v[48:63], v[36:39], v[44:47], v[48:63]
    v_exp_f32 v104, v104
    v_exp_f32 v105, v105
    v_exp_f32 v106, v106
    v_exp_f32 v107, v107
    v_cvt_pk_bf16_f32 v44, v104, v105
    v_cvt_pk_bf16_f32 v45, v106, v107
    v_mfma_f32_32x32x16_bf16 v[64:79], v[32:35], v[40:43], v[64:79]
    ds_read_b128 v[32:35], v4 offset:192
    v_exp_f32 v108, v108
    v_exp_f32 v109, v109
    v_exp_f32 v110, v110
    v_exp_f32 v111, v111
    v_cvt_pk_bf16_f32 v46, v108, v109
    v_cvt_pk_bf16_f32 v47, v110, v111
    s_waitcnt vmcnt(0)
    s_barrier
    s_cmp_ge_u32 s31, 8
    s_cbranch_scc1 nodma_20
    s_add_u32 s34, s31, s14
    s_and_b32 s34, s34, 7
    s_add_u32 m0, s47, s32
    s_mul_i32 s28, s50, s34
    buffer_load_dwordx4 v124, s[16:19], s28 offen sc1 lds
    s_add_u32 m0, s48, s32
    s_mul_i32 s28, s51, s34
    buffer_load_dwordx4 v125, s[16:19], s28 offen sc1 lds
    s_add_u32 m0, s49, s32
    s_mul_i32 s28, s52, s34
    s_mov_b64 exec, s[54:55]
    buffer_load_dwordx4 v126, s[16:19], s28 offen sc1 lds
    s_mov_b64 exec, -1
nodma_20:
    s_add_u32 s31, s31, 1
    s_add_u32 s32, s32, 23904
    s_cmp_eq_u32 s32, 71712
    s_cselect_b32 s32, 0, s32
    s_add_u32 s33, s33, 1
    s_cmp_eq_u32 s33, 3
    s_cselect_b32 s33, 0, s33
    s_cselect_b32 s34, s38, s39
    v_add_u32 v2, s34, v2
    v_add_u32 v3, s34, v3
    s_setprio 2
    v_mfma_f32_32x32x16_bf16 v[96:111], v[24:27], v[16:19], 0
    ds_read_b64 v[24:25], v2 offset:0
    ds_read_b64 v[26:27], v2 offset:4096
    v_exp_f32 v80, v80
    v_exp_f32 v81, v81
    v_exp_f32 v82, v82
    v_exp_f32 v83, v83
    v_cvt_pk_bf16_f32 v40, v80, v81
    v_cvt_pk_bf16_f32 v41, v82, v83
    v_mfma_f32_32x32x16_bf16 v[96:111], v[28:31], v[20:23], v[96:111]
    ds_read_b64 v[28:29], v3 offset:0
    v_exp_f32 v84, v84
    v_exp_f32 v85, v85
    v_exp_f32 v86, v86
    v_exp_f32 v87, v87
    v_cvt_pk_bf16_f32 v42, v84, v85
    v_cvt_pk_bf16_f32 v43, v86, v87
    v_mfma_f32_32x32x16_bf16 v[64:79], v[36:39], v[44:47], v[64:79]
    ds_read_b128 v[36:39], v5 offset:224
    v_add_u32 v5, s34, v5
    v_exp_f32 v88, v88
    v_exp_f32 v89, v89
    v_exp_f32 v90, v90
    v_exp_f32 v91, v91
    v_cvt_pk_bf16_f32 v44, v88, v89
    v_cvt_pk_bf16_f32 v45, v90, v91
    s_waitcnt lgkmcnt(4)
    v_mfma_f32_32x32x16_bf16 v[48:63], v[32:35], v[40:43], v[48:63]
    v_exp_f32 v92, v92
    v_exp_f32 v93, v93
    v_exp_f32 v94, v94
    v_exp_f32 v95, v95
    v_cvt_pk_bf16_f32 v46, v92, v93
    v_cvt_pk_bf16_f32 v47, v94, v95
    s_waitcnt lgkmcnt(0)
    v_mfma_f32_32x32x16_bf16 v[80:95], v[24:27], v[8:11], 0
    v_exp_f32 v96, v96
    v_exp_f32 v97, v97
    v_exp_f32 v98, v98
    v_exp_f32 v99, v99
    v_cvt_pk_bf16_f32 v40, v96, v97
    v_cvt_pk_bf16_f32 v41, v98, v99
    v_mfma_f32_32x32x16_bf16 v[80:95], v[28:31], v[12:15], v[80:95]
    v_exp_f32 v100, v100
    v_exp_f32 v101, v101
    v_exp_f32 v102, v102
    v_exp_f32 v103, v103
    v_cvt_pk_bf16_f32 v42, v100, v101
    v_cvt_pk_bf16_f32 v43, v102, v103
    v_mfma_f32_32x32x16_bf16 v[48:63], v[36:39], v[44:47], v[48:63]
    v_exp_f32 v104, v104
    v_exp_f32 v105, v105
    v_exp_f32 v106, v106
    v_exp_f32 v107, v107
    v_cvt_pk_bf16_f32 v44, v104, v105
    v_cvt_pk_bf16_f32 v45, v106, v107
    v_mfma_f32_32x32x16_bf16 v[64:79], v[32:35], v[40:43], v[64:79]
    v_add_u32 v4, s34, v4
    ds_read_b128 v[32:35], v4 offset:0
    v_exp_f32 v108, v108
    v_exp_f32 v109, v109
    v_exp_f32 v110, v110
    v_exp_f32 v111, v111
    v_cvt_pk_bf16_f32 v46, v108, v109
    v_cvt_pk_bf16_f32 v47, v110, v111
    s_add_u32 s30, s30, 1
    s_cmp_lt_u32 s30, 8
    s_cbranch_scc1 pk_loop
    v_mfma_f32_32x32x16_bf16 v[64:79], v[36:39], v[44:47], v[64:79]
    s_mul_i32 s27, s20, 3072
    s_mul_i32 s28, s21, 47808
    s_add_u32 s28, s28, s27
    v_add_u32 v6, s28, v1
    s_xor_b32 s28, s21, 1
    s_mul_i32 s28, s28, 47808
    s_add_u32 s28, s28, s27
    v_add_u32 v7, s28, v1
    s_cmp_eq_u32 s21, 0
    s_nop 7
    s_cbranch_scc1 pk_give1
    ds_write_b128 v6, v[48:51] offset:0
    ds_write_b128 v6, v[52:55] offset:1024
    ds_write_b128 v6, v[56:59] offset:2048
    s_waitcnt lgkmcnt(0)
    s_barrier
    ds_read_b128 v[80:83], v7 offset:0
    ds_read_b128 v[84:87], v7 offset:1024
    ds_read_b128 v[88:91], v7 offset:2048
    s_waitcnt lgkmcnt(0)
    v_add_f32 v80, v80, v64
    v_add_f32 v81, v81, v65
    v_add_f32 v82, v82, v66
    v_add_f32 v83, v83, v67
    v_add_f32 v84, v84, v68
    v_add_f32 v85, v85, v69
    v_add_f32 v86, v86, v70
    v_add_f32 v87, v87, v71
    v_add_f32 v88, v88, v72
    v_add_f32 v89, v89, v73
    v_add_f32 v90, v90, v74
    v_add_f32 v91, v91, v75
    s_branch pk_fin
pk_give1:
    ds_write_b128 v6, v[64:67] offset:0
    ds_write_b128 v6, v[68:71] offset:1024
    ds_write_b128 v6, v[72:75] offset:2048
    s_waitcnt lgkmcnt(0)
    s_barrier
    ds_read_b128 v[80:83], v7 offset:0
    ds_read_b128 v[84:87], v7 offset:1024
    ds_read_b128 v[88:91], v7 offset:2048
    s_waitcnt lgkmcnt(0)
    v_add_f32 v80, v80, v48
    v_add_f32 v81, v81, v49
    v_add_f32 v82, v82, v50
    v_add_f32 v83, v83, v51
    v_add_f32 v84, v84, v52
    v_add_f32 v85, v85, v53
    v_add_f32 v86, v86, v54
    v_add_f32 v87, v87, v55
    v_add_f32 v88, v88, v56
    v_add_f32 v89, v89, v57
    v_add_f32 v90, v90, v58
    v_add_f32 v91, v91, v59
pk_fin:
    s_mul_i32 s27, s20, 2560
    s_lshl_b32 s28, s21, 6
    s_add_u32 s27, s27, s28
    s_add_u32 s27, s27, 60096
    v_and_b32 v7, 31, v0
    v_lshrrev_b32 v6, 5, v0
    v_lshlrev_b32 v6, 9, v6
    v_lshl_add_u32 v6, v7, 1, v6
    v_add_u32 v6, s27, v6
    v_mov_b32 v112, v88
    v_mov_b32 v113, v88
    s_nop 1
    v_permlane32_swap_b32 v112, v113
    s_nop 0
    v_rcp_f32 v114, v113
    v_add_f32 v115, abs(v80), abs(v81)
    v_add_f32 v115, v115, abs(v82)
    v_add_f32 v115, v115, abs(v83)
    v_add_f32 v115, v115, abs(v84)
    v_add_f32 v115, v115, abs(v85)
    v_add_f32 v115, v115, abs(v86)
    v_add_f32 v115, v115, abs(v87)
    v_add_f32 v115, v115, abs(v88)
    v_add_f32 v115, v115, abs(v89)
    v_add_f32 v115, v115, abs(v90)
    v_add_f32 v115, v115, abs(v91)
    v_mul_f32 v80, v114, v80
    v_mul_f32 v81, v114, v81
    v_mul_f32 v82, v114, v82
    v_mul_f32 v83, v114, v83
    v_mul_f32 v84, v114, v84
    v_mul_f32 v85, v114, v85
    v_mul_f32 v86, v114, v86
    v_mul_f32 v87, v114, v87
    v_mul_f32 v88, v114, v88
    v_mul_f32 v89, v114, v89
    v_mul_f32 v90, v114, v90
    v_mul_f32 v91, v114, v91
    v_cvt_pk_bf16_f32 v40, v80, v81
    v_cvt_pk_bf16_f32 v41, v82, v83
    v_cvt_pk_bf16_f32 v42, v84, v85
    v_cvt_pk_bf16_f32 v43, v86, v87
    v_cvt_pk_bf16_f32 v44, v88, v89
    v_cvt_pk_bf16_f32 v45, v90, v91
    ds_write_b16 v6, v40 offset:0
    ds_write_b16_d16_hi v6, v40 offset:128
    ds_write_b16 v6, v41 offset:256
    ds_write_b16_d16_hi v6, v41 offset:384
    ds_write_b16 v6, v42 offset:1024
    ds_write_b16_d16_hi v6, v42 offset:1152
    ds_write_b16 v6, v43 offset:1280
    ds_write_b16_d16_hi v6, v43 offset:1408
    v_cmp_gt_u32 vcc, 32, v0
    s_and_saveexec_b64 s[40:41], vcc
    ds_write_b16 v6, v44 offset:2048
    ds_write_b16_d16_hi v6, v44 offset:2176
    ds_write_b16 v6, v45 offset:2304
    ds_write_b16_d16_hi v6, v45 offset:2432
    s_mov_b64 exec, s[40:41]
    s_waitcnt lgkmcnt(0)
    s_barrier
    s_lshl_b32 s27, s12, 6
    v_add_u32 v6, s27, v0
    v_lshlrev_b32 v7, 4, v6
    v_add_u32 v7, 60096, v7
    ds_read_b128 v[96:99], v7
    v_mul_u32_u24 v7, 52429, v6
    v_lshrrev_b32 v7, 23, v7
    v_mul_u32_u24 v2, 160, v7
    v_sub_u32 v6, v6, v2
    s_lshl_b32 s27, s14, 2
    v_add_u32 v7, s27, v7
    v_mul_u32_u24 v7, 81920, v7
    s_mul_i32 s27, s13, 2560
    s_add_u32 s27, s27, 0x1400000
    v_lshl_add_u32 v6, v6, 4, v7
    v_add_u32 v6, s27, v6
    s_waitcnt lgkmcnt(0)
    global_store_dwordx4 v6, v[96:99], s[10:11] sc1
    s_cmp_ge_u32 s12, 2
    s_cbranch_scc1 oc2_21
    s_add_u32 s28, s12, 8
    s_nop 1
    s_lshl_b32 s27, s28, 6
    v_add_u32 v6, s27, v0
    v_lshlrev_b32 v7, 4, v6
    v_add_u32 v7, 60096, v7
    ds_read_b128 v[100:103], v7
    v_mul_u32_u24 v7, 52429, v6
    v_lshrrev_b32 v7, 23, v7
    v_mul_u32_u24 v2, 160, v7
    v_sub_u32 v6, v6, v2
    s_lshl_b32 s27, s14, 2
    v_add_u32 v7, s27, v7
    v_mul_u32_u24 v7, 81920, v7
    s_mul_i32 s27, s13, 2560
    s_add_u32 s27, s27, 0x1400000
    v_lshl_add_u32 v6, v6, 4, v7
    v_add_u32 v6, s27, v6
    s_waitcnt lgkmcnt(0)
    global_store_dwordx4 v6, v[100:103], s[10:11] sc1
oc2_21:
    s_cmp_lg_u32 s35, 0
    s_cbranch_scc1 pk_done
    v_mov_b32 v7, 0x7f800000
    v_cmp_nlt_f32 vcc, v115, v7
    v_mov_b32 v6, 71712
    v_mov_b32 v7, 1
    s_and_saveexec_b64 s[40:41], vcc
    s_cbranch_execz pk_noflag
    ds_write_b32 v6, v7
pk_noflag:
    s_mov_b64 exec, s[40:41]
    s_waitcnt lgkmcnt(0)
    s_barrier
    ds_read_b32 v7, v6
    s_waitcnt lgkmcnt(0)
    v_readfirstlane_b32 s36, v7
    s_nop 3
    s_cmp_eq_u32 s36, 0
    s_cbranch_scc1 pk_done
    s_mov_b32 s35, 1
    v_mov_b32 v14, 0
    v_mov_b32 v15, 0
    v_mov_b32 v112, 0xff800000
    v_mov_b32 v22, 0
    v_mov_b32 v23, 0
    v_mov_b32 v113, 0xff800000
    s_mov_b32 s30, 0
    s_mov_b32 s31, 0
    s_waitcnt vmcnt(0)
pk_fb_chunk:
    s_barrier
    s_add_u32 m0, s47, 0
    s_mul_i32 s28, s50, s31
    buffer_load_dwordx4 v124, s[16:19], s28 offen sc1 lds
    s_add_u32 m0, s48, 0
    s_mul_i32 s28, s51, s31
    buffer_load_dwordx4 v125, s[16:19], s28 offen sc1 lds
    s_add_u32 m0, s49, 0
    s_mul_i32 s28, s52, s31
    s_mov_b64 exec, s[54:55]
    buffer_load_dwordx4 v126, s[16:19], s28 offen sc1 lds
    s_mov_b64 exec, -1
    s_waitcnt vmcnt(0)
    s_barrier
    s_mov_b32 s36, 0
    s_lshl_b32 s29, s36, 11
    v_and_b32 v7, 31, v0
    v_lshrrev_b32 v5, 5, v0
    v_add_u32 v2, s43, v5
    v_and_b32 v3, 1, v2
    v_lshrrev_b32 v2, 1, v2
    v_lshlrev_b32 v2, 12, v2
    v_lshl_add_u32 v2, v3, 3, v2
    v_lshl_add_u32 v3, v7, 4, s29
    v_add_u32 v2, v2, v3
    s_lshl_b32 s29, s43, 3
    s_add_u32 s29, s29, 8192
    v_add_u32 v3, s29, v3
    s_lshl_b32 s29, s36, 8
    s_add_u32 s29, s29, 12288
    v_min_u32 v4, 21, v7
    v_mul_u32_u24 v4, 528, v4
    v_lshlrev_b32 v5, 4, v5
    v_add3_u32 v4, v4, v5, s29
    v_mov_b32 v5, v4
    s_mov_b32 s37, 0
pk_fb_tile:
    ds_read_b64 v[24:25], v2
    ds_read_b64 v[26:27], v2 offset:4096
    ds_read_b64 v[28:29], v3
    v_add_u32 v2, 512, v2
    v_add_u32 v3, 512, v3
    s_waitcnt lgkmcnt(0)
    v_mfma_f32_32x32x16_bf16 v[80:95], v[24:27], v[8:11], 0
    v_mfma_f32_32x32x16_bf16 v[96:111], v[24:27], v[16:19], 0
    v_mfma_f32_32x32x16_bf16 v[80:95], v[28:31], v[12:15], v[80:95]
    v_mfma_f32_32x32x16_bf16 v[96:111], v[28:31], v[20:23], v[96:111]
    s_nop 15
    v_max3_f32 v114, v80, v81, v82
    v_max3_f32 v114, v114, v83, v84
    v_max3_f32 v114, v114, v85, v86
    v_max3_f32 v114, v114, v87, v88
    v_max3_f32 v114, v114, v89, v90
    v_max3_f32 v114, v114, v91, v92
    v_max3_f32 v114, v114, v93, v94
    v_max_f32 v114, v114, v95
    v_max3_f32 v115, v96, v97, v98
    v_max3_f32 v115, v115, v99, v100
    v_max3_f32 v115, v115, v101, v102
    v_max3_f32 v115, v115, v103, v104
    v_max3_f32 v115, v115, v105, v106
    v_max3_f32 v115, v115, v107, v108
    v_max3_f32 v115, v115, v109, v110
    v_max_f32 v115, v115, v111
    v_max_f32 v112, v112, v114
    v_max_f32 v113, v113, v115
    s_add_u32 s37, s37, 1
    s_cmp_lt_u32 s37, 8
    s_cbranch_scc1 pk_fb_tile
    s_add_u32 s31, s31, 1
    s_add_u32 s30, s30, 1
    s_cmp_lt_u32 s30, 8
    s_cbranch_scc1 pk_fb_chunk
    v_mov_b32 v120, v112
    s_nop 1
    v_permlane32_swap_b32 v112, v120
    s_nop 0
    v_max_f32 v112, v112, v120
    v_sub_f32 v112, 0, v112
    v_cvt_pk_bf16_f32 v120, v112, v112
    v_lshlrev_b32 v120, 16, v120
    v_sub_f32 v121, v112, v120
    v_cvt_pk_bf16_f32 v122, v121, v121
    v_lshlrev_b32 v122, 16, v122
    v_sub_f32 v121, v121, v122
    v_cmp_gt_u32 vcc, 32, v0
    v_cvt_pk_bf16_f32 v14, v120, v122
    v_mov_b32 v123, 0
    v_cvt_pk_bf16_f32 v15, v121, v123
    v_cndmask_b32 v14, 0, v14, vcc
    v_cndmask_b32 v15, 0, v15, vcc
    v_mov_b32 v120, v113
    s_nop 1
    v_permlane32_swap_b32 v113, v120
    s_nop 0
    v_max_f32 v113, v113, v120
    v_sub_f32 v113, 0, v113
    v_cvt_pk_bf16_f32 v120, v113, v113
    v_lshlrev_b32 v120, 16, v120
    v_sub_f32 v121, v113, v120
    v_cvt_pk_bf16_f32 v122, v121, v121
    v_lshlrev_b32 v122, 16, v122
    v_sub_f32 v121, v121, v122
    v_cmp_gt_u32 vcc, 32, v0
    v_cvt_pk_bf16_f32 v22, v120, v122
    v_mov_b32 v123, 0
    v_cvt_pk_bf16_f32 v23, v121, v123
    v_cndmask_b32 v22, 0, v22, vcc
    v_cndmask_b32 v23, 0, v23, vcc
    s_barrier
    s_branch pk_restart
pk_done:
    s_waitcnt vmcnt(0)
    s_barrier
    s_cmp_lg_u32 s97, 0
    s_cbranch_scc1 osig_22
    s_lshl_b32 s56, s14, 7
    s_lshl_b32 s57, s13, 2
    s_add_u32 s56, s56, s57
    s_add_u32 s56, s56, 0x1f01800
    v_mov_b32 v2, s56
    v_mov_b32 v3, s100
    s_mov_b64 exec, 1
    global_store_dword v2, v3, s[10:11] sc1
    s_mov_b64 exec, -1
osig_22:
    s_endpgm
pk_grole:
    s_load_dwordx4 s[4:7], s[0:1], 0
    s_and_b32 s3, s96, 7
    s_lshr_b32 s15, s96, 3
    s_and_b32 s13, s3, 3
    s_lshl_b32 s13, s13, 2
    s_and_b32 s24, s15, 3
    s_add_u32 s13, s13, s24
    s_lshr_b32 s14, s3, 2
    s_lshl_b32 s14, s14, 3
    s_lshr_b32 s24, s15, 2
    s_add_u32 s14, s14, s24
    s_waitcnt lgkmcnt(0)
    s_cmp_ge_u32 s14, 15
    s_cbranch_scc1 qidle_23
    s_cmp_ge_u32 s97, 4
    s_cbranch_scc1 pk_qkv_loader
    s_and_b32 s24, s97, 1
    s_lshr_b32 s25, s97, 1
    v_and_b32 v14, 31, v0
    v_lshrrev_b32 v15, 5, v0
    v_lshrrev_b32 v16, 1, v14
    v_and_b32 v16, 7, v16
    v_xor_b32 v16, v15, v16
    s_lshl_b32 s26, s24, 13
    v_lshlrev_b32 v17, 7, v14
    v_add_u32 v17, s26, v17
    v_xor_b32 v18, 0, v16
    v_lshl_add_u32 v2, v18, 4, v17
    v_xor_b32 v18, 2, v16
    v_lshl_add_u32 v3, v18, 4, v17
    v_xor_b32 v18, 4, v16
    v_lshl_add_u32 v4, v18, 4, v17
    v_xor_b32 v18, 6, v16
    v_lshl_add_u32 v5, v18, 4, v17
    s_load_dwordx2 s[40:41], s[0:1], 40
    s_mul_i32 s42, s14, 192
    v_lshlrev_b32 v12, 2, v0
    v_min_u32 v12, 188, v12
    v_add_u32 v12, s42, v12
    s_waitcnt lgkmcnt(0)
    global_load_dword v13, v12, s[40:41]
    v_lshrrev_b32 v18, 4, v0
    v_and_b32 v19, 15, v0
    v_and_b32 v20, 1, v18
    v_lshlrev_b32 v20, 2, v20
    v_and_b32 v21, 3, v19
    v_add_u32 v20, v20, v21
    v_lshrrev_b32 v21, 2, v19
    v_lshrrev_b32 v22, 1, v18
    v_lshl_add_u32 v22, v22, 3, v21
    v_lshlrev_b32 v22, 8, v22
    v_add_u32 v22, 49152, v22
    v_lshlrev_b32 v21, 2, v21
    s_lshl_b32 s26, s25, 3
    s_mul_i32 s28, s14, 52
    s_lshr_b32 s28, s28, 8
    s_mul_i32 s29, s28, 5
    s_sub_u32 s29, s14, s29
    s_cmp_eq_u32 s28, 2
    s_cbranch_scc1 pk_qkv_v
    v_lshlrev_b32 v20, 2, v20
    s_mov_b32 s27, 0x75643120
    v_lshrrev_b32 v20, v20, s27
    v_and_b32 v20, 7, v20
    v_and_b32 v23, 1, v20
    v_lshl_add_u32 v22, v23, 3, v22
    v_lshrrev_b32 v20, 1, v20
    s_add_u32 s27, s26, 0
    v_add_u32 v23, s27, v20
    v_xor_b32 v23, v23, v21
    v_lshl_add_u32 v6, v23, 4, v22
    s_add_u32 s27, s26, 4
    v_add_u32 v23, s27, v20
    v_xor_b32 v23, v23, v21
    v_lshl_add_u32 v7, v23, 4, v22
    s_barrier
    ds_read_b128 v[16:19], v2 offset:0
    ds_read_b64_tr_b16 v[24:25], v6 offset:0
    ds_read_b64_tr_b16 v[26:27], v6 offset:1024
    ds_read_b64_tr_b16 v[28:29], v7 offset:0
    ds_read_b64_tr_b16 v[30:31], v7 offset:1024
    ds_read_b128 v[20:23], v2 offset:4096
    ds_read_b128 v[32:35], v3 offset:0
    ds_read_b64_tr_b16 v[40:41], v6 offset:4096
    ds_read_b64_tr_b16 v[42:43], v6 offset:5120
    ds_read_b64_tr_b16 v[44:45], v7 offset:4096
    ds_read_b64_tr_b16 v[46:47], v7 offset:5120
    ds_read_b128 v[36:39], v3 offset:4096
    s_waitcnt lgkmcnt(0)
    v_mfma_f32_32x32x16_bf16 v[64:79], v[24:27], v[16:19], 0
    s_barrier
    ds_read_b128 v[48:51], v4 offset:0
    ds_read_b64_tr_b16 v[56:57], v6 offset:8192
    ds_read_b64_tr_b16 v[58:59], v6 offset:9216
    v_mfma_f32_32x32x16_bf16 v[80:95], v[28:31], v[16:19], 0
    ds_read_b64_tr_b16 v[60:61], v7 offset:8192
    ds_read_b64_tr_b16 v[62:63], v7 offset:9216
    ds_read_b128 v[52:55], v4 offset:4096
    v_mfma_f32_32x32x16_bf16 v[96:111], v[24:27], v[20:23], 0
    v_mfma_f32_32x32x16_bf16 v[112:127], v[28:31], v[20:23], 0
    v_mfma_f32_32x32x16_bf16 v[64:79], v[40:43], v[32:35], v[64:79]
    ds_read_b128 v[16:19], v5 offset:0
    ds_read_b64_tr_b16 v[24:25], v6 offset:12288
    ds_read_b64_tr_b16 v[26:27], v6 offset:13312
    v_mfma_f32_32x32x16_bf16 v[80:95], v[44:47], v[32:35], v[80:95]
    ds_read_b64_tr_b16 v[28:29], v7 offset:12288
    ds_read_b64_tr_b16 v[30:31], v7 offset:13312
    ds_read_b128 v[20:23], v5 offset:4096
    v_mfma_f32_32x32x16_bf16 v[96:111], v[40:43], v[36:39], v[96:111]
    v_mfma_f32_32x32x16_bf16 v[112:127], v[44:47], v[36:39], v[112:127]
    s_waitcnt lgkmcnt(0)
    v_mfma_f32_32x32x16_bf16 v[64:79], v[56:59], v[48:51], v[64:79]
    s_barrier
    ds_read_b128 v[32:35], v2 offset:16384
    ds_read_b64_tr_b16 v[40:41], v6 offset:16384
    ds_read_b64_tr_b16 v[42:43], v6 offset:17408
    v_mfma_f32_32x32x16_bf16 v[80:95], v[60:63], v[48:51], v[80:95]
    ds_read_b64_tr_b16 v[44:45], v7 offset:16384
    ds_read_b64_tr_b16 v[46:47], v7 offset:17408
    ds_read_b128 v[36:39], v2 offset:20480
    v_mfma_f32_32x32x16_bf16 v[96:111], v[56:59], v[52:55], v[96:111]
    v_mfma_f32_32x32x16_bf16 v[112:127], v[60:63], v[52:55], v[112:127]
    v_mfma_f32_32x32x16_bf16 v[64:79], v[24:27], v[16:19], v[64:79]
    ds_read_b128 v[48:51], v3 offset:16384
    ds_read_b64_tr_b16 v[56:57], v6 offset:20480
    ds_read_b64_tr_b16 v[58:59], v6 offset:21504
    v_mfma_f32_32x32x16_bf16 v[80:95], v[28:31], v[16:19], v[80:95]
    ds_read_b64_tr_b16 v[60:61], v7 offset:20480
    ds_read_b64_tr_b16 v[62:63], v7 offset:21504
    ds_read_b128 v[52:55], v3 offset:20480
    v_mfma_f32_32x32x16_bf16 v[96:111], v[24:27], v[20:23], v[96:111]
    v_mfma_f32_32x32x16_bf16 v[112:127], v[28:31], v[20:23], v[112:127]
    s_waitcnt lgkmcnt(0)
    v_mfma_f32_32x32x16_bf16 v[64:79], v[40:43], v[32:35], v[64:79]
    s_barrier
    ds_read_b128 v[16:19], v4 offset:16384
    ds_read_b64_tr_b16 v[24:25], v6 offset:24576
    ds_read_b64_tr_b16 v[26:27], v6 offset:25600
    v_mfma_f32_32x32x16_bf16 v[80:95], v[44:47], v[32:35], v[80:95]
    ds_read_b64_tr_b16 v[28:29], v7 offset:24576
    ds_read_b64_tr_b16 v[30:31], v7 offset:25600
    ds_read_b128 v[20:23], v4 offset:20480
    v_mfma_f32_32x32x16_bf16 v[96:111], v[40:43], v[36:39], v[96:111]
    v_mfma_f32_32x32x16_bf16 v[112:127], v[44:47], v[36:39], v[112:127]
    v_mfma_f32_32x32x16_bf16 v[64:79], v[56:59], v[48:51], v[64:79]
    ds_read_b128 v[32:35], v5 offset:16384
    ds_read_b64_tr_b16 v[40:41], v6 offset:28672
    ds_read_b64_tr_b16 v[42:43], v6 offset:29696
    v_mfma_f32_32x32x16_bf16 v[80:95], v[60:63], v[48:51], v[80:95]
    ds_read_b64_tr_b16 v[44:45], v7 offset:28672
    ds_read_b64_tr_b16 v[46:47], v7 offset:29696
    ds_read_b128 v[36:39], v5 offset:20480
    v_mfma_f32_32x32x16_bf16 v[96:111], v[56:59], v[52:55], v[96:111]
    v_mfma_f32_32x32x16_bf16 v[112:127], v[60:63], v[52:55], v[112:127]
    s_waitcnt lgkmcnt(0)
    v_mfma_f32_32x32x16_bf16 v[64:79], v[24:27], v[16:19], v[64:79]
    s_barrier
    ds_read_b128 v[48:51], v2 offset:32768
    ds_read_b64_tr_b16 v[56:57], v6 offset:0
    ds_read_b64_tr_b16 v[58:59], v6 offset:1024
    v_mfma_f32_32x32x16_bf16 v[80:95], v[28:31], v[16:19], v[80:95]
    ds_read_b64_tr_b16 v[60:61], v7 offset:0
    ds_read_b64_tr_b16 v[62:63], v7 offset:1024
    ds_read_b128 v[52:55], v2 offset:36864
    v_mfma_f32_32x32x16_bf16 v[96:111], v[24:27], v[20:23], v[96:111]
    v_mfma_f32_32x32x16_bf16 v[112:127], v[28:31], v[20:23], v[112:127]
    v_mfma_f32_32x32x16_bf16 v[64:79], v[40:43], v[32:35], v[64:79]
    ds_read_b128 v[16:19], v3 offset:32768
    ds_read_b64_tr_b16 v[24:25], v6 offset:4096
    ds_read_b64_tr_b16 v[26:27], v6 offset:5120
    v_mfma_f32_32x32x16_bf16 v[80:95], v[44:47], v[32:35], v[80:95]
    ds_read_b64_tr_b16 v[28:29], v7 offset:4096
    ds_read_b64_tr_b16 v[30:31], v7 offset:5120
    ds_read_b128 v[20:23], v3 offset:36864
    v_mfma_f32_32x32x16_bf16 v[96:111], v[40:43], v[36:39], v[96:111]
    v_mfma_f32_32x32x16_bf16 v[112:127], v[44:47], v[36:39], v[112:127]
    s_waitcnt lgkmcnt(0)
    v_mfma_f32_32x32x16_bf16 v[64:79], v[56:59], v[48:51], v[64:79]
    s_barrier
    ds_read_b128 v[32:35], v4 offset:32768
    ds_read_b64_tr_b16 v[40:41], v6 offset:8192
    ds_read_b64_tr_b16 v[42:43], v6 offset:9216
    v_mfma_f32_32x32x16_bf16 v[80:95], v[60:63], v[48:51], v[80:95]
    ds_read_b64_tr_b16 v[44:45], v7 offset:8192
    ds_read_b64_tr_b16 v[46:47], v7 offset:9216
    ds_read_b128 v[36:39], v4 offset:36864
    v_mfma_f32_32x32x16_bf16 v[96:111], v[56:59], v[52:55], v[96:111]
    v_mfma_f32_32x32x16_bf16 v[112:127], v[60:63], v[52:55], v[112:127]
    v_mfma_f32_32x32x16_bf16 v[64:79], v[24:27], v[16:19], v[64:79]
    ds_read_b128 v[48:51], v5 offset:32768
    ds_read_b64_tr_b16 v[56:57], v6 offset:12288
    ds_read_b64_tr_b16 v[58:59], v6 offset:13312
    v_mfma_f32_32x32x16_bf16 v[80:95], v[28:31], v[16:19], v[80:95]
    ds_read_b64_tr_b16 v[60:61], v7 offset:12288
    ds_read_b64_tr_b16 v[62:63], v7 offset:13312
    ds_read_b128 v[52:55], v5 offset:36864
    v_mfma_f32_32x32x16_bf16 v[96:111], v[24:27], v[20:23], v[96:111]
    v_mfma_f32_32x32x16_bf16 v[112:127], v[28:31], v[20:23], v[112:127]
    s_waitcnt lgkmcnt(0)
    v_mfma_f32_32x32x16_bf16 v[64:79], v[40:43], v[32:35], v[64:79]
    s_barrier
    ds_read_b128 v[16:19], v2 offset:0
    ds_read_b64_tr_b16 v[24:25], v6 offset:16384
    ds_read_b64_tr_b16 v[26:27], v6 offset:17408
    v_mfma_f32_32x32x16_bf16 v[80:95], v[44:47], v[32:35], v[80:95]
    ds_read_b64_tr_b16 v[28:29], v7 offset:16384
    ds_read_b64_tr_b16 v[30:31], v7 offset:17408
    ds_read_b128 v[20:23], v2 offset:4096
    v_mfma_f32_32x32x16_bf16 v[96:111], v[40:43], v[36:39], v[96:111]
    v_mfma_f32_32x32x16_bf16 v[112:127], v[44:47], v[36:39], v[112:127]
    v_mfma_f32_32x32x16_bf16 v[64:79], v[56:59], v[48:51], v[64:79]
    ds_read_b128 v[32:35], v3 offset:0
    ds_read_b64_tr_b16 v[40:41], v6 offset:20480
    ds_read_b64_tr_b16 v[42:43], v6 offset:21504
    v_mfma_f32_32x32x16_bf16 v[80:95], v[60:63], v[48:51], v[80:95]
    ds_read_b64_tr_b16 v[44:45], v7 offset:20480
    ds_read_b64_tr_b16 v[46:47], v7 offset:21504
    ds_read_b128 v[36:39], v3 offset:4096
    v_mfma_f32_32x32x16_bf16 v[96:111], v[56:59], v[52:55], v[96:111]
    v_mfma_f32_32x32x16_bf16 v[112:127], v[60:63], v[52:55], v[112:127]
    s_waitcnt lgkmcnt(0)
    v_mfma_f32_32x32x16_bf16 v[64:79], v[24:27], v[16:19], v[64:79]
    s_barrier
    ds_read_b128 v[48:51], v4 offset:0
    ds_read_b64_tr_b16 v[56:57], v6 offset:24576
    ds_read_b64_tr_b16 v[58:59], v6 offset:25600
    v_mfma_f32_32x32x16_bf16 v[80:95], v[28:31], v[16:19], v[80:95]
    ds_read_b64_tr_b16 v[60:61], v7 offset:24576
    ds_read_b64_tr_b16 v[62:63], v7 offset:25600
    ds_read_b128 v[52:55], v4 offset:4096
    v_mfma_f32_32x32x16_bf16 v[96:111], v[24:27], v[20:23], v[96:111]
    v_mfma_f32_32x32x16_bf16 v[112:127], v[28:31], v[20:23], v[112:127]
    v_mfma_f32_32x32x16_bf16 v[64:79], v[40:43], v[32:35], v[64:79]
    ds_read_b128 v[16:19], v5 offset:0
    ds_read_b64_tr_b16 v[24:25], v6 offset:28672
    ds_read_b64_tr_b16 v[26:27], v6 offset:29696
    v_mfma_f32_32x32x16_bf16 v[80:95], v[44:47], v[32:35], v[80:95]
    ds_read_b64_tr_b16 v[28:29], v7 offset:28672
    ds_read_b64_tr_b16 v[30:31], v7 offset:29696
    ds_read_b128 v[20:23], v5 offset:4096
    v_mfma_f32_32x32x16_bf16 v[96:111], v[40:43], v[36:39], v[96:111]
    v_mfma_f32_32x32x16_bf16 v[112:127], v[44:47], v[36:39], v[112:127]
    s_waitcnt lgkmcnt(0)
    v_mfma_f32_32x32x16_bf16 v[64:79], v[56:59], v[48:51], v[64:79]
    s_barrier
    ds_read_b128 v[32:35], v2 offset:16384
    ds_read_b64_tr_b16 v[40:41], v6 offset:0
    ds_read_b64_tr_b16 v[42:43], v6 offset:1024
    v_mfma_f32_32x32x16_bf16 v[80:95], v[60:63], v[48:51], v[80:95]
    ds_read_b64_tr_b16 v[44:45], v7 offset:0
    ds_read_b64_tr_b16 v[46:47], v7 offset:1024
    ds_read_b128 v[36:39], v2 offset:20480
    v_mfma_f32_32x32x16_bf16 v[96:111], v[56:59], v[52:55], v[96:111]
    v_mfma_f32_32x32x16_bf16 v[112:127], v[60:63], v[52:55], v[112:127]
    v_mfma_f32_32x32x16_bf16 v[64:79], v[24:27], v[16:19], v[64:79]
    ds_read_b128 v[48:51], v3 offset:16384
    ds_read_b64_tr_b16 v[56:57], v6 offset:4096
    ds_read_b64_tr_b16 v[58:59], v6 offset:5120
    v_mfma_f32_32x32x16_bf16 v[80:95], v[28:31], v[16:19], v[80:95]
    ds_read_b64_tr_b16 v[60:61], v7 offset:4096
    ds_read_b64_tr_b16 v[62:63], v7 offset:5120
    ds_read_b128 v[52:55], v3 offset:20480
    v_mfma_f32_32x32x16_bf16 v[96:111], v[24:27], v[20:23], v[96:111]
    v_mfma_f32_32x32x16_bf16 v[112:127], v[28:31], v[20:23], v[112:127]
    s_waitcnt lgkmcnt(0)
    v_mfma_f32_32x32x16_bf16 v[64:79], v[40:43], v[32:35], v[64:79]
    s_barrier
    ds_read_b128 v[16:19], v4 offset:16384
    ds_read_b64_tr_b16 v[24:25], v6 offset:8192
    ds_read_b64_tr_b16 v[26:27], v6 offset:9216
    v_mfma_f32_32x32x16_bf16 v[80:95], v[44:47], v[32:35], v[80:95]
    ds_read_b64_tr_b16 v[28:29], v7 offset:8192
    ds_read_b64_tr_b16 v[30:31], v7 offset:9216
    ds_read_b128 v[20:23], v4 offset:20480
    v_mfma_f32_32x32x16_bf16 v[96:111], v[40:43], v[36:39], v[96:111]
    v_mfma_f32_32x32x16_bf16 v[112:127], v[44:47], v[36:39], v[112:127]
    v_mfma_f32_32x32x16_bf16 v[64:79], v[56:59], v[48:51], v[64:79]
    ds_read_b128 v[32:35], v5 offset:16384
    ds_read_b64_tr_b16 v[40:41], v6 offset:12288
    ds_read_b64_tr_b16 v[42:43], v6 offset:13312
    v_mfma_f32_32x32x16_bf16 v[80:95], v[60:63], v[48:51], v[80:95]
    ds_read_b64_tr_b16 v[44:45], v7 offset:12288
    ds_read_b64_tr_b16 v[46:47], v7 offset:13312
    ds_read_b128 v[36:39], v5 offset:20480
    v_mfma_f32_32x32x16_bf16 v[96:111], v[56:59], v[52:55], v[96:111]
    v_mfma_f32_32x32x16_bf16 v[112:127], v[60:63], v[52:55], v[112:127]
    s_waitcnt lgkmcnt(0)
    v_mfma_f32_32x32x16_bf16 v[64:79], v[24:27], v[16:19], v[64:79]
    s_barrier
    ds_read_b128 v[48:51], v2 offset:32768
    ds_read_b64_tr_b16 v[56:57], v6 offset:16384
    ds_read_b64_tr_b16 v[58:59], v6 offset:17408
    v_mfma_f32_32x32x16_bf16 v[80:95], v[28:31], v[16:19], v[80:95]
    ds_read_b64_tr_b16 v[60:61], v7 offset:16384
    ds_read_b64_tr_b16 v[62:63], v7 offset:17408
    ds_read_b128 v[52:55], v2 offset:36864
    v_mfma_f32_32x32x16_bf16 v[96:111], v[24:27], v[20:23], v[96:111]
    v_mfma_f32_32x32x16_bf16 v[112:127], v[28:31], v[20:23], v[112:127]
    v_mfma_f32_32x32x16_bf16 v[64:79], v[40:43], v[32:35], v[64:79]
    ds_read_b128 v[16:19], v3 offset:32768
    ds_read_b64_tr_b16 v[24:25], v6 offset:20480
    ds_read_b64_tr_b16 v[26:27], v6 offset:21504
    v_mfma_f32_32x32x16_bf16 v[80:95], v[44:47], v[32:35], v[80:95]
    ds_read_b64_tr_b16 v[28:29], v7 offset:20480
    ds_read_b64_tr_b16 v[30:31], v7 offset:21504
    ds_read_b128 v[20:23], v3 offset:36864
    v_mfma_f32_32x32x16_bf16 v[96:111], v[40:43], v[36:39], v[96:111]
    v_mfma_f32_32x32x16_bf16 v[112:127], v[44:47], v[36:39], v[112:127]
    s_waitcnt lgkmcnt(0)
    v_mfma_f32_32x32x16_bf16 v[64:79], v[56:59], v[48:51], v[64:79]
    s_barrier
    ds_read_b128 v[32:35], v4 offset:32768
    ds_read_b64_tr_b16 v[40:41], v6 offset:24576
    ds_read_b64_tr_b16 v[42:43], v6 offset:25600
    v_mfma_f32_32x32x16_bf16 v[80:95], v[60:63], v[48:51], v[80:95]
    ds_read_b64_tr_b16 v[44:45], v7 offset:24576
    ds_read_b64_tr_b16 v[46:47], v7 offset:25600
    ds_read_b128 v[36:39], v4 offset:36864
    v_mfma_f32_32x32x16_bf16 v[96:111], v[56:59], v[52:55], v[96:111]
    v_mfma_f32_32x32x16_bf16 v[112:127], v[60:63], v[52:55], v[112:127]
    v_mfma_f32_32x32x16_bf16 v[64:79], v[24:27], v[16:19], v[64:79]
    ds_read_b128 v[48:51], v5 offset:32768
    ds_read_b64_tr_b16 v[56:57], v6 offset:28672
    ds_read_b64_tr_b16 v[58:59], v6 offset:29696
    v_mfma_f32_32x32x16_bf16 v[80:95], v[28:31], v[16:19], v[80:95]
    ds_read_b64_tr_b16 v[60:61], v7 offset:28672
    ds_read_b64_tr_b16 v[62:63], v7 offset:29696
    ds_read_b128 v[52:55], v5 offset:36864
    v_mfma_f32_32x32x16_bf16 v[96:111], v[24:27], v[20:23], v[96:111]
    v_mfma_f32_32x32x16_bf16 v[112:127], v[28:31], v[20:23], v[112:127]
    s_waitcnt lgkmcnt(0)
    v_mfma_f32_32x32x16_bf16 v[64:79], v[40:43], v[32:35], v[64:79]
    s_barrier
    ds_read_b128 v[16:19], v2 offset:0
    ds_read_b64_tr_b16 v[24:25], v6 offset:0
    ds_read_b64_tr_b16 v[26:27], v6 offset:1024
    v_mfma_f32_32x32x16_bf16 v[80:95], v[44:47], v[32:35], v[80:95]
    ds_read_b64_tr_b16 v[28:29], v7 offset:0
    ds_read_b64_tr_b16 v[30:31], v7 offset:1024
    ds_read_b128 v[20:23], v2 offset:4096
    v_mfma_f32_32x32x16_bf16 v[96:111], v[40:43], v[36:39], v[96:111]
    v_mfma_f32_32x32x16_bf16 v[112:127], v[44:47], v[36:39], v[112:127]
    v_mfma_f32_32x32x16_bf16 v[64:79], v[56:59], v[48:51], v[64:79]
    ds_read_b128 v[32:35], v3 offset:0
    ds_read_b64_tr_b16 v[40:41], v6 offset:4096
    ds_read_b64_tr_b16 v[42:43], v6 offset:5120
    v_mfma_f32_32x32x16_bf16 v[80:95], v[60:63], v[48:51], v[80:95]
    ds_read_b64_tr_b16 v[44:45], v7 offset:4096
    ds_read_b64_tr_b16 v[46:47], v7 offset:5120
    ds_read_b128 v[36:39], v3 offset:4096
    v_mfma_f32_32x32x16_bf16 v[96:111], v[56:59], v[52:55], v[96:111]
    v_mfma_f32_32x32x16_bf16 v[112:127], v[60:63], v[52:55], v[112:127]
    s_waitcnt lgkmcnt(0)
    v_mfma_f32_32x32x16_bf16 v[64:79], v[24:27], v[16:19], v[64:79]
    s_barrier
    ds_read_b128 v[48:51], v4 offset:0
    ds_read_b64_tr_b16 v[56:57], v6 offset:8192
    ds_read_b64_tr_b16 v[58:59], v6 offset:9216
    v_mfma_f32_32x32x16_bf16 v[80:95], v[28:31], v[16:19], v[80:95]
    ds_read_b64_tr_b16 v[60:61], v7 offset:8192
    ds_read_b64_tr_b16 v[62:63], v7 offset:9216
    ds_read_b128 v[52:55], v4 offset:4096
    v_mfma_f32_32x32x16_bf16 v[96:111], v[24:27], v[20:23], v[96:111]
    v_mfma_f32_32x32x16_bf16 v[112:127], v[28:31], v[20:23], v[112:127]
    v_mfma_f32_32x32x16_bf16 v[64:79], v[40:43], v[32:35], v[64:79]
    ds_read_b128 v[16:19], v5 offset:0
    ds_read_b64_tr_b16 v[24:25], v6 offset:12288
    ds_read_b64_tr_b16 v[26:27], v6 offset:13312
    v_mfma_f32_32x32x16_bf16 v[80:95], v[44:47], v[32:35], v[80:95]
    ds_read_b64_tr_b16 v[28:29], v7 offset:12288
    ds_read_b64_tr_b16 v[30:31], v7 offset:13312
    ds_read_b128 v[20:23], v5 offset:4096
    v_mfma_f32_32x32x16_bf16 v[96:111], v[40:43], v[36:39], v[96:111]
    v_mfma_f32_32x32x16_bf16 v[112:127], v[44:47], v[36:39], v[112:127]
    s_waitcnt lgkmcnt(0)
    v_mfma_f32_32x32x16_bf16 v[64:79], v[56:59], v[48:51], v[64:79]
    s_barrier
    ds_read_b128 v[32:35], v2 offset:16384
    ds_read_b64_tr_b16 v[40:41], v6 offset:16384
    ds_read_b64_tr_b16 v[42:43], v6 offset:17408
    v_mfma_f32_32x32x16_bf16 v[80:95], v[60:63], v[48:51], v[80:95]
    ds_read_b64_tr_b16 v[44:45], v7 offset:16384
    ds_read_b64_tr_b16 v[46:47], v7 offset:17408
    ds_read_b128 v[36:39], v2 offset:20480
    v_mfma_f32_32x32x16_bf16 v[96:111], v[56:59], v[52:55], v[96:111]
    v_mfma_f32_32x32x16_bf16 v[112:127], v[60:63], v[52:55], v[112:127]
    v_mfma_f32_32x32x16_bf16 v[64:79], v[24:27], v[16:19], v[64:79]
    ds_read_b128 v[48:51], v3 offset:16384
    ds_read_b64_tr_b16 v[56:57], v6 offset:20480
    ds_read_b64_tr_b16 v[58:59], v6 offset:21504
    v_mfma_f32_32x32x16_bf16 v[80:95], v[28:31], v[16:19], v[80:95]
    ds_read_b64_tr_b16 v[60:61], v7 offset:20480
    ds_read_b64_tr_b16 v[62:63], v7 offset:21504
    ds_read_b128 v[52:55], v3 offset:20480
    v_mfma_f32_32x32x16_bf16 v[96:111], v[24:27], v[20:23], v[96:111]
    v_mfma_f32_32x32x16_bf16 v[112:127], v[28:31], v[20:23], v[112:127]
    s_waitcnt lgkmcnt(0)
    v_mfma_f32_32x32x16_bf16 v[64:79], v[40:43], v[32:35], v[64:79]
    s_barrier
    ds_read_b128 v[16:19], v4 offset:16384
    ds_read_b64_tr_b16 v[24:25], v6 offset:24576
    ds_read_b64_tr_b16 v[26:27], v6 offset:25600
    v_mfma_f32_32x32x16_bf16 v[80:95], v[44:47], v[32:35], v[80:95]
    ds_read_b64_tr_b16 v[28:29], v7 offset:24576
    ds_read_b64_tr_b16 v[30:31], v7 offset:25600
    ds_read_b128 v[20:23], v4 offset:20480
    v_mfma_f32_32x32x16_bf16 v[96:111], v[40:43], v[36:39], v[96:111]
    v_mfma_f32_32x32x16_bf16 v[112:127], v[44:47], v[36:39], v[112:127]
    v_mfma_f32_32x32x16_bf16 v[64:79], v[56:59], v[48:51], v[64:79]
    ds_read_b128 v[32:35], v5 offset:16384
    ds_read_b64_tr_b16 v[40:41], v6 offset:28672
    ds_read_b64_tr_b16 v[42:43], v6 offset:29696
    v_mfma_f32_32x32x16_bf16 v[80:95], v[60:63], v[48:51], v[80:95]
    ds_read_b64_tr_b16 v[44:45], v7 offset:28672
    ds_read_b64_tr_b16 v[46:47], v7 offset:29696
    ds_read_b128 v[36:39], v5 offset:20480
    v_mfma_f32_32x32x16_bf16 v[96:111], v[56:59], v[52:55], v[96:111]
    v_mfma_f32_32x32x16_bf16 v[112:127], v[60:63], v[52:55], v[112:127]
    s_waitcnt lgkmcnt(0)
    v_mfma_f32_32x32x16_bf16 v[64:79], v[24:27], v[16:19], v[64:79]
    s_barrier
    ds_read_b128 v[48:51], v2 offset:32768
    ds_read_b64_tr_b16 v[56:57], v6 offset:0
    ds_read_b64_tr_b16 v[58:59], v6 offset:1024
    v_mfma_f32_32x32x16_bf16 v[80:95], v[28:31], v[16:19], v[80:95]
    ds_read_b64_tr_b16 v[60:61], v7 offset:0
    ds_read_b64_tr_b16 v[62:63], v7 offset:1024
    ds_read_b128 v[52:55], v2 offset:36864
    v_mfma_f32_32x32x16_bf16 v[96:111], v[24:27], v[20:23], v[96:111]
    v_mfma_f32_32x32x16_bf16 v[112:127], v[28:31], v[20:23], v[112:127]
    v_mfma_f32_32x32x16_bf16 v[64:79], v[40:43], v[32:35], v[64:79]
    ds_read_b128 v[16:19], v3 offset:32768
    ds_read_b64_tr_b16 v[24:25], v6 offset:4096
    ds_read_b64_tr_b16 v[26:27], v6 offset:5120
    v_mfma_f32_32x32x16_bf16 v[80:95], v[44:47], v[32:35], v[80:95]
    ds_read_b64_tr_b16 v[28:29], v7 offset:4096
    ds_read_b64_tr_b16 v[30:31], v7 offset:5120
    ds_read_b128 v[20:23], v3 offset:36864
    v_mfma_f32_32x32x16_bf16 v[96:111], v[40:43], v[36:39], v[96:111]
    v_mfma_f32_32x32x16_bf16 v[112:127], v[44:47], v[36:39], v[112:127]
    s_waitcnt lgkmcnt(0)
    v_mfma_f32_32x32x16_bf16 v[64:79], v[56:59], v[48:51], v[64:79]
    s_barrier
    ds_read_b128 v[32:35], v4 offset:32768
    ds_read_b64_tr_b16 v[40:41], v6 offset:8192
    ds_read_b64_tr_b16 v[42:43], v6 offset:9216
    v_mfma_f32_32x32x16_bf16 v[80:95], v[60:63], v[48:51], v[80:95]
    ds_read_b64_tr_b16 v[44:45], v7 offset:8192
    ds_read_b64_tr_b16 v[46:47], v7 offset:9216
    ds_read_b128 v[36:39], v4 offset:36864
    v_mfma_f32_32x32x16_bf16 v[96:111], v[56:59], v[52:55], v[96:111]
    v_mfma_f32_32x32x16_bf16 v[112:127], v[60:63], v[52:55], v[112:127]
    v_mfma_f32_32x32x16_bf16 v[64:79], v[24:27], v[16:19], v[64:79]
    ds_read_b128 v[48:51], v5 offset:32768
    ds_read_b64_tr_b16 v[56:57], v6 offset:12288
    ds_read_b64_tr_b16 v[58:59], v6 offset:13312
    v_mfma_f32_32x32x16_bf16 v[80:95], v[28:31], v[16:19], v[80:95]
    ds_read_b64_tr_b16 v[60:61], v7 offset:12288
    ds_read_b64_tr_b16 v[62:63], v7 offset:13312
    ds_read_b128 v[52:55], v5 offset:36864
    v_mfma_f32_32x32x16_bf16 v[96:111], v[24:27], v[20:23], v[96:111]
    v_mfma_f32_32x32x16_bf16 v[112:127], v[28:31], v[20:23], v[112:127]
    s_waitcnt lgkmcnt(0)
    v_mfma_f32_32x32x16_bf16 v[64:79], v[40:43], v[32:35], v[64:79]
    s_barrier
    ds_read_b128 v[16:19], v2 offset:0
    ds_read_b64_tr_b16 v[24:25], v6 offset:16384
    ds_read_b64_tr_b16 v[26:27], v6 offset:17408
    v_mfma_f32_32x32x16_bf16 v[80:95], v[44:47], v[32:35], v[80:95]
    ds_read_b64_tr_b16 v[28:29], v7 offset:16384
    ds_read_b64_tr_b16 v[30:31], v7 offset:17408
    ds_read_b128 v[20:23], v2 offset:4096
    v_mfma_f32_32x32x16_bf16 v[96:111], v[40:43], v[36:39], v[96:111]
    v_mfma_f32_32x32x16_bf16 v[112:127], v[44:47], v[36:39], v[112:127]
    v_mfma_f32_32x32x16_bf16 v[64:79], v[56:59], v[48:51], v[64:79]
    ds_read_b128 v[32:35], v3 offset:0
    ds_read_b64_tr_b16 v[40:41], v6 offset:20480
    ds_read_b64_tr_b16 v[42:43], v6 offset:21504
    v_mfma_f32_32x32x16_bf16 v[80:95], v[60:63], v[48:51], v[80:95]
    ds_read_b64_tr_b16 v[44:45], v7 offset:20480
    ds_read_b64_tr_b16 v[46:47], v7 offset:21504
    ds_read_b128 v[36:39], v3 offset:4096
    v_mfma_f32_32x32x16_bf16 v[96:111], v[56:59], v[52:55], v[96:111]
    v_mfma_f32_32x32x16_bf16 v[112:127], v[60:63], v[52:55], v[112:127]
    s_waitcnt lgkmcnt(0)
    v_mfma_f32_32x32x16_bf16 v[64:79], v[24:27], v[16:19], v[64:79]
    s_barrier
    ds_read_b128 v[48:51], v4 offset:0
    ds_read_b64_tr_b16 v[56:57], v6 offset:24576
    ds_read_b64_tr_b16 v[58:59], v6 offset:25600
    v_mfma_f32_32x32x16_bf16 v[80:95], v[28:31], v[16:19], v[80:95]
    ds_read_b64_tr_b16 v[60:61], v7 offset:24576
    ds_read_b64_tr_b16 v[62:63], v7 offset:25600
    ds_read_b128 v[52:55], v4 offset:4096
    v_mfma_f32_32x32x16_bf16 v[96:111], v[24:27], v[20:23], v[96:111]
    v_mfma_f32_32x32x16_bf16 v[112:127], v[28:31], v[20:23], v[112:127]
    v_mfma_f32_32x32x16_bf16 v[64:79], v[40:43], v[32:35], v[64:79]
    ds_read_b128 v[16:19], v5 offset:0
    ds_read_b64_tr_b16 v[24:25], v6 offset:28672
    ds_read_b64_tr_b16 v[26:27], v6 offset:29696
    v_mfma_f32_32x32x16_bf16 v[80:95], v[44:47], v[32:35], v[80:95]
    ds_read_b64_tr_b16 v[28:29], v7 offset:28672
    ds_read_b64_tr_b16 v[30:31], v7 offset:29696
    ds_read_b128 v[20:23], v5 offset:4096
    v_mfma_f32_32x32x16_bf16 v[96:111], v[40:43], v[36:39], v[96:111]
    v_mfma_f32_32x32x16_bf16 v[112:127], v[44:47], v[36:39], v[112:127]
    s_waitcnt lgkmcnt(0)
    v_mfma_f32_32x32x16_bf16 v[64:79], v[56:59], v[48:51], v[64:79]
    v_mfma_f32_32x32x16_bf16 v[80:95], v[60:63], v[48:51], v[80:95]
    v_mfma_f32_32x32x16_bf16 v[96:111], v[56:59], v[52:55], v[96:111]
    v_mfma_f32_32x32x16_bf16 v[112:127], v[60:63], v[52:55], v[112:127]
    v_mfma_f32_32x32x16_bf16 v[64:79], v[24:27], v[16:19], v[64:79]
    v_mfma_f32_32x32x16_bf16 v[80:95], v[28:31], v[16:19], v[80:95]
    v_mfma_f32_32x32x16_bf16 v[96:111], v[24:27], v[20:23], v[96:111]
    v_mfma_f32_32x32x16_bf16 v[112:127], v[28:31], v[20:23], v[112:127]
    s_lshl_b32 s30, s13, 2
    s_lshl_b32 s31, s24, 1
    s_add_u32 s30, s30, s31
    s_lshl_b32 s31, s29, 4
    s_lshl_b32 s32, s25, 3
    s_add_u32 s31, s31, s32
    v_add_u32 v8, s31, v15
    v_lshlrev_b32 v8, 11, v8
    s_cmp_eq_u32 s28, 0
    s_cselect_b32 s36, 0x3ea52b5c, 1.0
    s_cselect_b32 s33, 0x600000, 0
    s_mul_i32 s34, s13, 163840
    s_add_u32 s34, s34, s33
    s_lshl_b32 s33, s24, 10
    s_add_u32 s34, s34, s33
    s_add_u32 s34, s34, 0x0
    v_lshl_add_u32 v9, v14, 4, s34
    v_add_u32 v8, v8, v9
    v_add_u32 v16, 0x0, v8
    v_add_u32 v17, 0x1000, v8
    v_add_u32 v18, 0x2000, v8
    v_add_u32 v19, 0x3000, v8
    s_nop 7
    v_mul_f32 v64, s36, v64
    v_mul_f32 v65, s36, v65
    v_mul_f32 v66, s36, v66
    v_mul_f32 v67, s36, v67
    v_mul_f32 v68, s36, v68
    v_mul_f32 v69, s36, v69
    v_mul_f32 v70, s36, v70
    v_mul_f32 v71, s36, v71
    v_mul_f32 v72, s36, v72
    v_mul_f32 v73, s36, v73
    v_mul_f32 v74, s36, v74
    v_mul_f32 v75, s36, v75
    v_mul_f32 v76, s36, v76
    v_mul_f32 v77, s36, v77
    v_mul_f32 v78, s36, v78
    v_mul_f32 v79, s36, v79
    v_cvt_pk_bf16_f32 v32, v64, v65
    v_cvt_pk_bf16_f32 v33, v66, v67
    v_cvt_pk_bf16_f32 v34, v68, v69
    v_cvt_pk_bf16_f32 v35, v70, v71
    v_cvt_pk_bf16_f32 v36, v72, v73
    v_cvt_pk_bf16_f32 v37, v74, v75
    v_cvt_pk_bf16_f32 v38, v76, v77
    v_cvt_pk_bf16_f32 v39, v78, v79
    global_store_dwordx4 v16, v[32:35], s[10:11] offset:0 sc1
    global_store_dwordx4 v17, v[36:39], s[10:11] offset:0 sc1
    v_mul_f32 v80, s36, v80
    v_mul_f32 v81, s36, v81
    v_mul_f32 v82, s36, v82
    v_mul_f32 v83, s36, v83
    v_mul_f32 v84, s36, v84
    v_mul_f32 v85, s36, v85
    v_mul_f32 v86, s36, v86
    v_mul_f32 v87, s36, v87
    v_mul_f32 v88, s36, v88
    v_mul_f32 v89, s36, v89
    v_mul_f32 v90, s36, v90
    v_mul_f32 v91, s36, v91
    v_mul_f32 v92, s36, v92
    v_mul_f32 v93, s36, v93
    v_mul_f32 v94, s36, v94
    v_mul_f32 v95, s36, v95
    v_cvt_pk_bf16_f32 v40, v80, v81
    v_cvt_pk_bf16_f32 v41, v82, v83
    v_cvt_pk_bf16_f32 v42, v84, v85
    v_cvt_pk_bf16_f32 v43, v86, v87
    v_cvt_pk_bf16_f32 v44, v88, v89
    v_cvt_pk_bf16_f32 v45, v90, v91
    v_cvt_pk_bf16_f32 v46, v92, v93
    v_cvt_pk_bf16_f32 v47, v94, v95
    global_store_dwordx4 v18, v[40:43], s[10:11] offset:0 sc1
    global_store_dwordx4 v19, v[44:47], s[10:11] offset:0 sc1
    v_mul_f32 v96, s36, v96
    v_mul_f32 v97, s36, v97
    v_mul_f32 v98, s36, v98
    v_mul_f32 v99, s36, v99
    v_mul_f32 v100, s36, v100
    v_mul_f32 v101, s36, v101
    v_mul_f32 v102, s36, v102
    v_mul_f32 v103, s36, v103
    v_mul_f32 v104, s36, v104
    v_mul_f32 v105, s36, v105
    v_mul_f32 v106, s36, v106
    v_mul_f32 v107, s36, v107
    v_mul_f32 v108, s36, v108
    v_mul_f32 v109, s36, v109
    v_mul_f32 v110, s36, v110
    v_mul_f32 v111, s36, v111
    v_cvt_pk_bf16_f32 v48, v96, v97
    v_cvt_pk_bf16_f32 v49, v98, v99
    v_cvt_pk_bf16_f32 v50, v100, v101
    v_cvt_pk_bf16_f32 v51, v102, v103
    v_cvt_pk_bf16_f32 v52, v104, v105
    v_cvt_pk_bf16_f32 v53, v106, v107
    v_cvt_pk_bf16_f32 v54, v108, v109
    v_cvt_pk_bf16_f32 v55, v110, v111
    global_store_dwordx4 v16, v[48:51], s[10:11] offset:512 sc1
    global_store_dwordx4 v17, v[52:55], s[10:11] offset:512 sc1
    v_mul_f32 v112, s36, v112
    v_mul_f32 v113, s36, v113
    v_mul_f32 v114, s36, v114
    v_mul_f32 v115, s36, v115
    v_mul_f32 v116, s36, v116
    v_mul_f32 v117, s36, v117
    v_mul_f32 v118, s36, v118
    v_mul_f32 v119, s36, v119
    v_mul_f32 v120, s36, v120
    v_mul_f32 v121, s36, v121
    v_mul_f32 v122, s36, v122
    v_mul_f32 v123, s36, v123
    v_mul_f32 v124, s36, v124
    v_mul_f32 v125, s36, v125
    v_mul_f32 v126, s36, v126
    v_mul_f32 v127, s36, v127
    v_cvt_pk_bf16_f32 v56, v112, v113
    v_cvt_pk_bf16_f32 v57, v114, v115
    v_cvt_pk_bf16_f32 v58, v116, v117
    v_cvt_pk_bf16_f32 v59, v118, v119
    v_cvt_pk_bf16_f32 v60, v120, v121
    v_cvt_pk_bf16_f32 v61, v122, v123
    v_cvt_pk_bf16_f32 v62, v124, v125
    v_cvt_pk_bf16_f32 v63, v126, v127
    global_store_dwordx4 v18, v[56:59], s[10:11] offset:512 sc1
    global_store_dwordx4 v19, v[60:63], s[10:11] offset:512 sc1
    s_branch pk_qkv_done
pk_qkv_v:
    v_and_b32 v23, 1, v20
    v_lshl_add_u32 v22, v23, 3, v22
    v_lshrrev_b32 v20, 1, v20
    s_add_u32 s27, s26, 0
    v_add_u32 v23, s27, v20
    v_xor_b32 v23, v23, v21
    v_lshl_add_u32 v6, v23, 4, v22
    s_add_u32 s27, s26, 4
    v_add_u32 v23, s27, v20
    v_xor_b32 v23, v23, v21
    v_lshl_add_u32 v7, v23, 4, v22
    s_barrier
    ds_read_b128 v[16:19], v2 offset:0
    ds_read_b64_tr_b16 v[24:25], v6 offset:0
    ds_read_b64_tr_b16 v[26:27], v6 offset:1024
    ds_read_b64_tr_b16 v[28:29], v7 offset:0
    ds_read_b64_tr_b16 v[30:31], v7 offset:1024
    ds_read_b128 v[20:23], v2 offset:4096
    ds_read_b128 v[32:35], v3 offset:0
    ds_read_b64_tr_b16 v[40:41], v6 offset:4096
    ds_read_b64_tr_b16 v[42:43], v6 offset:5120
    ds_read_b64_tr_b16 v[44:45], v7 offset:4096
    ds_read_b64_tr_b16 v[46:47], v7 offset:5120
    ds_read_b128 v[36:39], v3 offset:4096
    s_waitcnt lgkmcnt(0)
    v_mfma_f32_32x32x16_bf16 v[64:79], v[16:19], v[24:27], 0
    s_barrier
    ds_read_b128 v[48:51], v4 offset:0
    ds_read_b64_tr_b16 v[56:57], v6 offset:8192
    ds_read_b64_tr_b16 v[58:59], v6 offset:9216
    v_mfma_f32_32x32x16_bf16 v[80:95], v[16:19], v[28:31], 0
    ds_read_b64_tr_b16 v[60:61], v7 offset:8192
    ds_read_b64_tr_b16 v[62:63], v7 offset:9216
    ds_read_b128 v[52:55], v4 offset:4096
    v_mfma_f32_32x32x16_bf16 v[96:111], v[20:23], v[24:27], 0
    v_mfma_f32_32x32x16_bf16 v[112:127], v[20:23], v[28:31], 0
    v_mfma_f32_32x32x16_bf16 v[64:79], v[32:35], v[40:43], v[64:79]
    ds_read_b128 v[16:19], v5 offset:0
    ds_read_b64_tr_b16 v[24:25], v6 offset:12288
    ds_read_b64_tr_b16 v[26:27], v6 offset:13312
    v_mfma_f32_32x32x16_bf16 v[80:95], v[32:35], v[44:47], v[80:95]
    ds_read_b64_tr_b16 v[28:29], v7 offset:12288
    ds_read_b64_tr_b16 v[30:31], v7 offset:13312
    ds_read_b128 v[20:23], v5 offset:4096
    v_mfma_f32_32x32x16_bf16 v[96:111], v[36:39], v[40:43], v[96:111]
    v_mfma_f32_32x32x16_bf16 v[112:127], v[36:39], v[44:47], v[112:127]
    s_waitcnt lgkmcnt(0)
    v_mfma_f32_32x32x16_bf16 v[64:79], v[48:51], v[56:59], v[64:79]
    s_barrier
    ds_read_b128 v[32:35], v2 offset:16384
    ds_read_b64_tr_b16 v[40:41], v6 offset:16384
    ds_read_b64_tr_b16 v[42:43], v6 offset:17408
    v_mfma_f32_32x32x16_bf16 v[80:95], v[48:51], v[60:63], v[80:95]
    ds_read_b64_tr_b16 v[44:45], v7 offset:16384
    ds_read_b64_tr_b16 v[46:47], v7 offset:17408
    ds_read_b128 v[36:39], v2 offset:20480
    v_mfma_f32_32x32x16_bf16 v[96:111], v[52:55], v[56:59], v[96:111]
    v_mfma_f32_32x32x16_bf16 v[112:127], v[52:55], v[60:63], v[112:127]
    v_mfma_f32_32x32x16_bf16 v[64:79], v[16:19], v[24:27], v[64:79]
    ds_read_b128 v[48:51], v3 offset:16384
    ds_read_b64_tr_b16 v[56:57], v6 offset:20480
    ds_read_b64_tr_b16 v[58:59], v6 offset:21504
    v_mfma_f32_32x32x16_bf16 v[80:95], v[16:19], v[28:31], v[80:95]
    ds_read_b64_tr_b16 v[60:61], v7 offset:20480
    ds_read_b64_tr_b16 v[62:63], v7 offset:21504
    ds_read_b128 v[52:55], v3 offset:20480
    v_mfma_f32_32x32x16_bf16 v[96:111], v[20:23], v[24:27], v[96:111]
    v_mfma_f32_32x32x16_bf16 v[112:127], v[20:23], v[28:31], v[112:127]
    s_waitcnt lgkmcnt(0)
    v_mfma_f32_32x32x16_bf16 v[64:79], v[32:35], v[40:43], v[64:79]
    s_barrier
    ds_read_b128 v[16:19], v4 offset:16384
    ds_read_b64_tr_b16 v[24:25], v6 offset:24576
    ds_read_b64_tr_b16 v[26:27], v6 offset:25600
    v_mfma_f32_32x32x16_bf16 v[80:95], v[32:35], v[44:47], v[80:95]
    ds_read_b64_tr_b16 v[28:29], v7 offset:24576
    ds_read_b64_tr_b16 v[30:31], v7 offset:25600
    ds_read_b128 v[20:23], v4 offset:20480
    v_mfma_f32_32x32x16_bf16 v[96:111], v[36:39], v[40:43], v[96:111]
    v_mfma_f32_32x32x16_bf16 v[112:127], v[36:39], v[44:47], v[112:127]
    v_mfma_f32_32x32x16_bf16 v[64:79], v[48:51], v[56:59], v[64:79]
    ds_read_b128 v[32:35], v5 offset:16384
    ds_read_b64_tr_b16 v[40:41], v6 offset:28672
    ds_read_b64_tr_b16 v[42:43], v6 offset:29696
    v_mfma_f32_32x32x16_bf16 v[80:95], v[48:51], v[60:63], v[80:95]
    ds_read_b64_tr_b16 v[44:45], v7 offset:28672
    ds_read_b64_tr_b16 v[46:47], v7 offset:29696
    ds_read_b128 v[36:39], v5 offset:20480
    v_mfma_f32_32x32x16_bf16 v[96:111], v[52:55], v[56:59], v[96:111]
    v_mfma_f32_32x32x16_bf16 v[112:127], v[52:55], v[60:63], v[112:127]
    s_waitcnt lgkmcnt(0)
    v_mfma_f32_32x32x16_bf16 v[64:79], v[16:19], v[24:27], v[64:79]
    s_barrier
    ds_read_b128 v[48:51], v2 offset:32768
    ds_read_b64_tr_b16 v[56:57], v6 offset:0
    ds_read_b64_tr_b16 v[58:59], v6 offset:1024
    v_mfma_f32_32x32x16_bf16 v[80:95], v[16:19], v[28:31], v[80:95]
    ds_read_b64_tr_b16 v[60:61], v7 offset:0
    ds_read_b64_tr_b16 v[62:63], v7 offset:1024
    ds_read_b128 v[52:55], v2 offset:36864
    v_mfma_f32_32x32x16_bf16 v[96:111], v[20:23], v[24:27], v[96:111]
    v_mfma_f32_32x32x16_bf16 v[112:127], v[20:23], v[28:31], v[112:127]
    v_mfma_f32_32x32x16_bf16 v[64:79], v[32:35], v[40:43], v[64:79]
    ds_read_b128 v[16:19], v3 offset:32768
    ds_read_b64_tr_b16 v[24:25], v6 offset:4096
    ds_read_b64_tr_b16 v[26:27], v6 offset:5120
    v_mfma_f32_32x32x16_bf16 v[80:95], v[32:35], v[44:47], v[80:95]
    ds_read_b64_tr_b16 v[28:29], v7 offset:4096
    ds_read_b64_tr_b16 v[30:31], v7 offset:5120
    ds_read_b128 v[20:23], v3 offset:36864
    v_mfma_f32_32x32x16_bf16 v[96:111], v[36:39], v[40:43], v[96:111]
    v_mfma_f32_32x32x16_bf16 v[112:127], v[36:39], v[44:47], v[112:127]
    s_waitcnt lgkmcnt(0)
    v_mfma_f32_32x32x16_bf16 v[64:79], v[48:51], v[56:59], v[64:79]
    s_barrier
    ds_read_b128 v[32:35], v4 offset:32768
    ds_read_b64_tr_b16 v[40:41], v6 offset:8192
    ds_read_b64_tr_b16 v[42:43], v6 offset:9216
    v_mfma_f32_32x32x16_bf16 v[80:95], v[48:51], v[60:63], v[80:95]
    ds_read_b64_tr_b16 v[44:45], v7 offset:8192
    ds_read_b64_tr_b16 v[46:47], v7 offset:9216
    ds_read_b128 v[36:39], v4 offset:36864
    v_mfma_f32_32x32x16_bf16 v[96:111], v[52:55], v[56:59], v[96:111]
    v_mfma_f32_32x32x16_bf16 v[112:127], v[52:55], v[60:63], v[112:127]
    v_mfma_f32_32x32x16_bf16 v[64:79], v[16:19], v[24:27], v[64:79]
    ds_read_b128 v[48:51], v5 offset:32768
    ds_read_b64_tr_b16 v[56:57], v6 offset:12288
    ds_read_b64_tr_b16 v[58:59], v6 offset:13312
    v_mfma_f32_32x32x16_bf16 v[80:95], v[16:19], v[28:31], v[80:95]
    ds_read_b64_tr_b16 v[60:61], v7 offset:12288
    ds_read_b64_tr_b16 v[62:63], v7 offset:13312
    ds_read_b128 v[52:55], v5 offset:36864
    v_mfma_f32_32x32x16_bf16 v[96:111], v[20:23], v[24:27], v[96:111]
    v_mfma_f32_32x32x16_bf16 v[112:127], v[20:23], v[28:31], v[112:127]
    s_waitcnt lgkmcnt(0)
    v_mfma_f32_32x32x16_bf16 v[64:79], v[32:35], v[40:43], v[64:79]
    s_barrier
    ds_read_b128 v[16:19], v2 offset:0
    ds_read_b64_tr_b16 v[24:25], v6 offset:16384
    ds_read_b64_tr_b16 v[26:27], v6 offset:17408
    v_mfma_f32_32x32x16_bf16 v[80:95], v[32:35], v[44:47], v[80:95]
    ds_read_b64_tr_b16 v[28:29], v7 offset:16384
    ds_read_b64_tr_b16 v[30:31], v7 offset:17408
    ds_read_b128 v[20:23], v2 offset:4096
    v_mfma_f32_32x32x16_bf16 v[96:111], v[36:39], v[40:43], v[96:111]
    v_mfma_f32_32x32x16_bf16 v[112:127], v[36:39], v[44:47], v[112:127]
    v_mfma_f32_32x32x16_bf16 v[64:79], v[48:51], v[56:59], v[64:79]
    ds_read_b128 v[32:35], v3 offset:0
    ds_read_b64_tr_b16 v[40:41], v6 offset:20480
    ds_read_b64_tr_b16 v[42:43], v6 offset:21504
    v_mfma_f32_32x32x16_bf16 v[80:95], v[48:51], v[60:63], v[80:95]
    ds_read_b64_tr_b16 v[44:45], v7 offset:20480
    ds_read_b64_tr_b16 v[46:47], v7 offset:21504
    ds_read_b128 v[36:39], v3 offset:4096
    v_mfma_f32_32x32x16_bf16 v[96:111], v[52:55], v[56:59], v[96:111]
    v_mfma_f32_32x32x16_bf16 v[112:127], v[52:55], v[60:63], v[112:127]
    s_waitcnt lgkmcnt(0)
    v_mfma_f32_32x32x16_bf16 v[64:79], v[16:19], v[24:27], v[64:79]
    s_barrier
    ds_read_b128 v[48:51], v4 offset:0
    ds_read_b64_tr_b16 v[56:57], v6 offset:24576
    ds_read_b64_tr_b16 v[58:59], v6 offset:25600
    v_mfma_f32_32x32x16_bf16 v[80:95], v[16:19], v[28:31], v[80:95]
    ds_read_b64_tr_b16 v[60:61], v7 offset:24576
    ds_read_b64_tr_b16 v[62:63], v7 offset:25600
    ds_read_b128 v[52:55], v4 offset:4096
    v_mfma_f32_32x32x16_bf16 v[96:111], v[20:23], v[24:27], v[96:111]
    v_mfma_f32_32x32x16_bf16 v[112:127], v[20:23], v[28:31], v[112:127]
    v_mfma_f32_32x32x16_bf16 v[64:79], v[32:35], v[40:43], v[64:79]
    ds_read_b128 v[16:19], v5 offset:0
    ds_read_b64_tr_b16 v[24:25], v6 offset:28672
    ds_read_b64_tr_b16 v[26:27], v6 offset:29696
    v_mfma_f32_32x32x16_bf16 v[80:95], v[32:35], v[44:47], v[80:95]
    ds_read_b64_tr_b16 v[28:29], v7 offset:28672
    ds_read_b64_tr_b16 v[30:31], v7 offset:29696
    ds_read_b128 v[20:23], v5 offset:4096
    v_mfma_f32_32x32x16_bf16 v[96:111], v[36:39], v[40:43], v[96:111]
    v_mfma_f32_32x32x16_bf16 v[112:127], v[36:39], v[44:47], v[112:127]
    s_waitcnt lgkmcnt(0)
    v_mfma_f32_32x32x16_bf16 v[64:79], v[48:51], v[56:59], v[64:79]
    s_barrier
    ds_read_b128 v[32:35], v2 offset:16384
    ds_read_b64_tr_b16 v[40:41], v6 offset:0
    ds_read_b64_tr_b16 v[42:43], v6 offset:1024
    v_mfma_f32_32x32x16_bf16 v[80:95], v[48:51], v[60:63], v[80:95]
    ds_read_b64_tr_b16 v[44:45], v7 offset:0
    ds_read_b64_tr_b16 v[46:47], v7 offset:1024
    ds_read_b128 v[36:39], v2 offset:20480
    v_mfma_f32_32x32x16_bf16 v[96:111], v[52:55], v[56:59], v[96:111]
    v_mfma_f32_32x32x16_bf16 v[112:127], v[52:55], v[60:63], v[112:127]
    v_mfma_f32_32x32x16_bf16 v[64:79], v[16:19], v[24:27], v[64:79]
    ds_read_b128 v[48:51], v3 offset:16384
    ds_read_b64_tr_b16 v[56:57], v6 offset:4096
    ds_read_b64_tr_b16 v[58:59], v6 offset:5120
    v_mfma_f32_32x32x16_bf16 v[80:95], v[16:19], v[28:31], v[80:95]
    ds_read_b64_tr_b16 v[60:61], v7 offset:4096
    ds_read_b64_tr_b16 v[62:63], v7 offset:5120
    ds_read_b128 v[52:55], v3 offset:20480
    v_mfma_f32_32x32x16_bf16 v[96:111], v[20:23], v[24:27], v[96:111]
    v_mfma_f32_32x32x16_bf16 v[112:127], v[20:23], v[28:31], v[112:127]
    s_waitcnt lgkmcnt(0)
    v_mfma_f32_32x32x16_bf16 v[64:79], v[32:35], v[40:43], v[64:79]
    s_barrier
    ds_read_b128 v[16:19], v4 offset:16384
    ds_read_b64_tr_b16 v[24:25], v6 offset:8192
    ds_read_b64_tr_b16 v[26:27], v6 offset:9216
    v_mfma_f32_32x32x16_bf16 v[80:95], v[32:35], v[44:47], v[80:95]
    ds_read_b64_tr_b16 v[28:29], v7 offset:8192
    ds_read_b64_tr_b16 v[30:31], v7 offset:9216
    ds_read_b128 v[20:23], v4 offset:20480
    v_mfma_f32_32x32x16_bf16 v[96:111], v[36:39], v[40:43], v[96:111]
    v_mfma_f32_32x32x16_bf16 v[112:127], v[36:39], v[44:47], v[112:127]
    v_mfma_f32_32x32x16_bf16 v[64:79], v[48:51], v[56:59], v[64:79]
    ds_read_b128 v[32:35], v5 offset:16384
    ds_read_b64_tr_b16 v[40:41], v6 offset:12288
    ds_read_b64_tr_b16 v[42:43], v6 offset:13312
    v_mfma_f32_32x32x16_bf16 v[80:95], v[48:51], v[60:63], v[80:95]
    ds_read_b64_tr_b16 v[44:45], v7 offset:12288
    ds_read_b64_tr_b16 v[46:47], v7 offset:13312
    ds_read_b128 v[36:39], v5 offset:20480
    v_mfma_f32_32x32x16_bf16 v[96:111], v[52:55], v[56:59], v[96:111]
    v_mfma_f32_32x32x16_bf16 v[112:127], v[52:55], v[60:63], v[112:127]
    s_waitcnt lgkmcnt(0)
    v_mfma_f32_32x32x16_bf16 v[64:79], v[16:19], v[24:27], v[64:79]
    s_barrier
    ds_read_b128 v[48:51], v2 offset:32768
    ds_read_b64_tr_b16 v[56:57], v6 offset:16384
    ds_read_b64_tr_b16 v[58:59], v6 offset:17408
    v_mfma_f32_32x32x16_bf16 v[80:95], v[16:19], v[28:31], v[80:95]
    ds_read_b64_tr_b16 v[60:61], v7 offset:16384
    ds_read_b64_tr_b16 v[62:63], v7 offset:17408
    ds_read_b128 v[52:55], v2 offset:36864
    v_mfma_f32_32x32x16_bf16 v[96:111], v[20:23], v[24:27], v[96:111]
    v_mfma_f32_32x32x16_bf16 v[112:127], v[20:23], v[28:31], v[112:127]
    v_mfma_f32_32x32x16_bf16 v[64:79], v[32:35], v[40:43], v[64:79]
    ds_read_b128 v[16:19], v3 offset:32768
    ds_read_b64_tr_b16 v[24:25], v6 offset:20480
    ds_read_b64_tr_b16 v[26:27], v6 offset:21504
    v_mfma_f32_32x32x16_bf16 v[80:95], v[32:35], v[44:47], v[80:95]
    ds_read_b64_tr_b16 v[28:29], v7 offset:20480
    ds_read_b64_tr_b16 v[30:31], v7 offset:21504
    ds_read_b128 v[20:23], v3 offset:36864
    v_mfma_f32_32x32x16_bf16 v[96:111], v[36:39], v[40:43], v[96:111]
    v_mfma_f32_32x32x16_bf16 v[112:127], v[36:39], v[44:47], v[112:127]
    s_waitcnt lgkmcnt(0)
    v_mfma_f32_32x32x16_bf16 v[64:79], v[48:51], v[56:59], v[64:79]
    s_barrier
    ds_read_b128 v[32:35], v4 offset:32768
    ds_read_b64_tr_b16 v[40:41], v6 offset:24576
    ds_read_b64_tr_b16 v[42:43], v6 offset:25600
    v_mfma_f32_32x32x16_bf16 v[80:95], v[48:51], v[60:63], v[80:95]
    ds_read_b64_tr_b16 v[44:45], v7 offset:24576
    ds_read_b64_tr_b16 v[46:47], v7 offset:25600
    ds_read_b128 v[36:39], v4 offset:36864
    v_mfma_f32_32x32x16_bf16 v[96:111], v[52:55], v[56:59], v[96:111]
    v_mfma_f32_32x32x16_bf16 v[112:127], v[52:55], v[60:63], v[112:127]
    v_mfma_f32_32x32x16_bf16 v[64:79], v[16:19], v[24:27], v[64:79]
    ds_read_b128 v[48:51], v5 offset:32768
    ds_read_b64_tr_b16 v[56:57], v6 offset:28672
    ds_read_b64_tr_b16 v[58:59], v6 offset:29696
    v_mfma_f32_32x32x16_bf16 v[80:95], v[16:19], v[28:31], v[80:95]
    ds_read_b64_tr_b16 v[60:61], v7 offset:28672
    ds_read_b64_tr_b16 v[62:63], v7 offset:29696
    ds_read_b128 v[52:55], v5 offset:36864
    v_mfma_f32_32x32x16_bf16 v[96:111], v[20:23], v[24:27], v[96:111]
    v_mfma_f32_32x32x16_bf16 v[112:127], v[20:23], v[28:31], v[112:127]
    s_waitcnt lgkmcnt(0)
    v_mfma_f32_32x32x16_bf16 v[64:79], v[32:35], v[40:43], v[64:79]
    s_barrier
    ds_read_b128 v[16:19], v2 offset:0
    ds_read_b64_tr_b16 v[24:25], v6 offset:0
    ds_read_b64_tr_b16 v[26:27], v6 offset:1024
    v_mfma_f32_32x32x16_bf16 v[80:95], v[32:35], v[44:47], v[80:95]
    ds_read_b64_tr_b16 v[28:29], v7 offset:0
    ds_read_b64_tr_b16 v[30:31], v7 offset:1024
    ds_read_b128 v[20:23], v2 offset:4096
    v_mfma_f32_32x32x16_bf16 v[96:111], v[36:39], v[40:43], v[96:111]
    v_mfma_f32_32x32x16_bf16 v[112:127], v[36:39], v[44:47], v[112:127]
    v_mfma_f32_32x32x16_bf16 v[64:79], v[48:51], v[56:59], v[64:79]
    ds_read_b128 v[32:35], v3 offset:0
    ds_read_b64_tr_b16 v[40:41], v6 offset:4096
    ds_read_b64_tr_b16 v[42:43], v6 offset:5120
    v_mfma_f32_32x32x16_bf16 v[80:95], v[48:51], v[60:63], v[80:95]
    ds_read_b64_tr_b16 v[44:45], v7 offset:4096
    ds_read_b64_tr_b16 v[46:47], v7 offset:5120
    ds_read_b128 v[36:39], v3 offset:4096
    v_mfma_f32_32x32x16_bf16 v[96:111], v[52:55], v[56:59], v[96:111]
    v_mfma_f32_32x32x16_bf16 v[112:127], v[52:55], v[60:63], v[112:127]
    s_waitcnt lgkmcnt(0)
    v_mfma_f32_32x32x16_bf16 v[64:79], v[16:19], v[24:27], v[64:79]
    s_barrier
    ds_read_b128 v[48:51], v4 offset:0
    ds_read_b64_tr_b16 v[56:57], v6 offset:8192
    ds_read_b64_tr_b16 v[58:59], v6 offset:9216
    v_mfma_f32_32x32x16_bf16 v[80:95], v[16:19], v[28:31], v[80:95]
    ds_read_b64_tr_b16 v[60:61], v7 offset:8192
    ds_read_b64_tr_b16 v[62:63], v7 offset:9216
    ds_read_b128 v[52:55], v4 offset:4096
    v_mfma_f32_32x32x16_bf16 v[96:111], v[20:23], v[24:27], v[96:111]
    v_mfma_f32_32x32x16_bf16 v[112:127], v[20:23], v[28:31], v[112:127]
    v_mfma_f32_32x32x16_bf16 v[64:79], v[32:35], v[40:43], v[64:79]
    ds_read_b128 v[16:19], v5 offset:0
    ds_read_b64_tr_b16 v[24:25], v6 offset:12288
    ds_read_b64_tr_b16 v[26:27], v6 offset:13312
    v_mfma_f32_32x32x16_bf16 v[80:95], v[32:35], v[44:47], v[80:95]
    ds_read_b64_tr_b16 v[28:29], v7 offset:12288
    ds_read_b64_tr_b16 v[30:31], v7 offset:13312
    ds_read_b128 v[20:23], v5 offset:4096
    v_mfma_f32_32x32x16_bf16 v[96:111], v[36:39], v[40:43], v[96:111]
    v_mfma_f32_32x32x16_bf16 v[112:127], v[36:39], v[44:47], v[112:127]
    s_waitcnt lgkmcnt(0)
    v_mfma_f32_32x32x16_bf16 v[64:79], v[48:51], v[56:59], v[64:79]
    s_barrier
    ds_read_b128 v[32:35], v2 offset:16384
    ds_read_b64_tr_b16 v[40:41], v6 offset:16384
    ds_read_b64_tr_b16 v[42:43], v6 offset:17408
    v_mfma_f32_32x32x16_bf16 v[80:95], v[48:51], v[60:63], v[80:95]
    ds_read_b64_tr_b16 v[44:45], v7 offset:16384
    ds_read_b64_tr_b16 v[46:47], v7 offset:17408
    ds_read_b128 v[36:39], v2 offset:20480
    v_mfma_f32_32x32x16_bf16 v[96:111], v[52:55], v[56:59], v[96:111]
    v_mfma_f32_32x32x16_bf16 v[112:127], v[52:55], v[60:63], v[112:127]
    v_mfma_f32_32x32x16_bf16 v[64:79], v[16:19], v[24:27], v[64:79]
    ds_read_b128 v[48:51], v3 offset:16384
    ds_read_b64_tr_b16 v[56:57], v6 offset:20480
    ds_read_b64_tr_b16 v[58:59], v6 offset:21504
    v_mfma_f32_32x32x16_bf16 v[80:95], v[16:19], v[28:31], v[80:95]
    ds_read_b64_tr_b16 v[60:61], v7 offset:20480
    ds_read_b64_tr_b16 v[62:63], v7 offset:21504
    ds_read_b128 v[52:55], v3 offset:20480
    v_mfma_f32_32x32x16_bf16 v[96:111], v[20:23], v[24:27], v[96:111]
    v_mfma_f32_32x32x16_bf16 v[112:127], v[20:23], v[28:31], v[112:127]
    s_waitcnt lgkmcnt(0)
    v_mfma_f32_32x32x16_bf16 v[64:79], v[32:35], v[40:43], v[64:79]
    s_barrier
    ds_read_b128 v[16:19], v4 offset:16384
    ds_read_b64_tr_b16 v[24:25], v6 offset:24576
    ds_read_b64_tr_b16 v[26:27], v6 offset:25600
    v_mfma_f32_32x32x16_bf16 v[80:95], v[32:35], v[44:47], v[80:95]
    ds_read_b64_tr_b16 v[28:29], v7 offset:24576
    ds_read_b64_tr_b16 v[30:31], v7 offset:25600
    ds_read_b128 v[20:23], v4 offset:20480
    v_mfma_f32_32x32x16_bf16 v[96:111], v[36:39], v[40:43], v[96:111]
    v_mfma_f32_32x32x16_bf16 v[112:127], v[36:39], v[44:47], v[112:127]
    v_mfma_f32_32x32x16_bf16 v[64:79], v[48:51], v[56:59], v[64:79]
    ds_read_b128 v[32:35], v5 offset:16384
    ds_read_b64_tr_b16 v[40:41], v6 offset:28672
    ds_read_b64_tr_b16 v[42:43], v6 offset:29696
    v_mfma_f32_32x32x16_bf16 v[80:95], v[48:51], v[60:63], v[80:95]
    ds_read_b64_tr_b16 v[44:45], v7 offset:28672
    ds_read_b64_tr_b16 v[46:47], v7 offset:29696
    ds_read_b128 v[36:39], v5 offset:20480
    v_mfma_f32_32x32x16_bf16 v[96:111], v[52:55], v[56:59], v[96:111]
    v_mfma_f32_32x32x16_bf16 v[112:127], v[52:55], v[60:63], v[112:127]
    s_waitcnt lgkmcnt(0)
    v_mfma_f32_32x32x16_bf16 v[64:79], v[16:19], v[24:27], v[64:79]
    s_barrier
    ds_read_b128 v[48:51], v2 offset:32768
    ds_read_b64_tr_b16 v[56:57], v6 offset:0
    ds_read_b64_tr_b16 v[58:59], v6 offset:1024
    v_mfma_f32_32x32x16_bf16 v[80:95], v[16:19], v[28:31], v[80:95]
    ds_read_b64_tr_b16 v[60:61], v7 offset:0
    ds_read_b64_tr_b16 v[62:63], v7 offset:1024
    ds_read_b128 v[52:55], v2 offset:36864
    v_mfma_f32_32x32x16_bf16 v[96:111], v[20:23], v[24:27], v[96:111]
    v_mfma_f32_32x32x16_bf16 v[112:127], v[20:23], v[28:31], v[112:127]
    v_mfma_f32_32x32x16_bf16 v[64:79], v[32:35], v[40:43], v[64:79]
    ds_read_b128 v[16:19], v3 offset:32768
    ds_read_b64_tr_b16 v[24:25], v6 offset:4096
    ds_read_b64_tr_b16 v[26:27], v6 offset:5120
    v_mfma_f32_32x32x16_bf16 v[80:95], v[32:35], v[44:47], v[80:95]
    ds_read_b64_tr_b16 v[28:29], v7 offset:4096
    ds_read_b64_tr_b16 v[30:31], v7 offset:5120
    ds_read_b128 v[20:23], v3 offset:36864
    v_mfma_f32_32x32x16_bf16 v[96:111], v[36:39], v[40:43], v[96:111]
    v_mfma_f32_32x32x16_bf16 v[112:127], v[36:39], v[44:47], v[112:127]
    s_waitcnt lgkmcnt(0)
    v_mfma_f32_32x32x16_bf16 v[64:79], v[48:51], v[56:59], v[64:79]
    s_barrier
    ds_read_b128 v[32:35], v4 offset:32768
    ds_read_b64_tr_b16 v[40:41], v6 offset:8192
    ds_read_b64_tr_b16 v[42:43], v6 offset:9216
    v_mfma_f32_32x32x16_bf16 v[80:95], v[48:51], v[60:63], v[80:95]
    ds_read_b64_tr_b16 v[44:45], v7 offset:8192
    ds_read_b64_tr_b16 v[46:47], v7 offset:9216
    ds_read_b128 v[36:39], v4 offset:36864
    v_mfma_f32_32x32x16_bf16 v[96:111], v[52:55], v[56:59], v[96:111]
    v_mfma_f32_32x32x16_bf16 v[112:127], v[52:55], v[60:63], v[112:127]
    v_mfma_f32_32x32x16_bf16 v[64:79], v[16:19], v[24:27], v[64:79]
    ds_read_b128 v[48:51], v5 offset:32768
    ds_read_b64_tr_b16 v[56:57], v6 offset:12288
    ds_read_b64_tr_b16 v[58:59], v6 offset:13312
    v_mfma_f32_32x32x16_bf16 v[80:95], v[16:19], v[28:31], v[80:95]
    ds_read_b64_tr_b16 v[60:61], v7 offset:12288
    ds_read_b64_tr_b16 v[62:63], v7 offset:13312
    ds_read_b128 v[52:55], v5 offset:36864
    v_mfma_f32_32x32x16_bf16 v[96:111], v[20:23], v[24:27], v[96:111]
    v_mfma_f32_32x32x16_bf16 v[112:127], v[20:23], v[28:31], v[112:127]
    s_waitcnt lgkmcnt(0)
    v_mfma_f32_32x32x16_bf16 v[64:79], v[32:35], v[40:43], v[64:79]
    s_barrier
    ds_read_b128 v[16:19], v2 offset:0
    ds_read_b64_tr_b16 v[24:25], v6 offset:16384
    ds_read_b64_tr_b16 v[26:27], v6 offset:17408
    v_mfma_f32_32x32x16_bf16 v[80:95], v[32:35], v[44:47], v[80:95]
    ds_read_b64_tr_b16 v[28:29], v7 offset:16384
    ds_read_b64_tr_b16 v[30:31], v7 offset:17408
    ds_read_b128 v[20:23], v2 offset:4096
    v_mfma_f32_32x32x16_bf16 v[96:111], v[36:39], v[40:43], v[96:111]
    v_mfma_f32_32x32x16_bf16 v[112:127], v[36:39], v[44:47], v[112:127]
    v_mfma_f32_32x32x16_bf16 v[64:79], v[48:51], v[56:59], v[64:79]
    ds_read_b128 v[32:35], v3 offset:0
    ds_read_b64_tr_b16 v[40:41], v6 offset:20480
    ds_read_b64_tr_b16 v[42:43], v6 offset:21504
    v_mfma_f32_32x32x16_bf16 v[80:95], v[48:51], v[60:63], v[80:95]
    ds_read_b64_tr_b16 v[44:45], v7 offset:20480
    ds_read_b64_tr_b16 v[46:47], v7 offset:21504
    ds_read_b128 v[36:39], v3 offset:4096
    v_mfma_f32_32x32x16_bf16 v[96:111], v[52:55], v[56:59], v[96:111]
    v_mfma_f32_32x32x16_bf16 v[112:127], v[52:55], v[60:63], v[112:127]
    s_waitcnt lgkmcnt(0)
    v_mfma_f32_32x32x16_bf16 v[64:79], v[16:19], v[24:27], v[64:79]
    s_barrier
    ds_read_b128 v[48:51], v4 offset:0
    ds_read_b64_tr_b16 v[56:57], v6 offset:24576
    ds_read_b64_tr_b16 v[58:59], v6 offset:25600
    v_mfma_f32_32x32x16_bf16 v[80:95], v[16:19], v[28:31], v[80:95]
    ds_read_b64_tr_b16 v[60:61], v7 offset:24576
    ds_read_b64_tr_b16 v[62:63], v7 offset:25600
    ds_read_b128 v[52:55], v4 offset:4096
    v_mfma_f32_32x32x16_bf16 v[96:111], v[20:23], v[24:27], v[96:111]
    v_mfma_f32_32x32x16_bf16 v[112:127], v[20:23], v[28:31], v[112:127]
    v_mfma_f32_32x32x16_bf16 v[64:79], v[32:35], v[40:43], v[64:79]
    ds_read_b128 v[16:19], v5 offset:0
    ds_read_b64_tr_b16 v[24:25], v6 offset:28672
    ds_read_b64_tr_b16 v[26:27], v6 offset:29696
    v_mfma_f32_32x32x16_bf16 v[80:95], v[32:35], v[44:47], v[80:95]
    ds_read_b64_tr_b16 v[28:29], v7 offset:28672
    ds_read_b64_tr_b16 v[30:31], v7 offset:29696
    ds_read_b128 v[20:23], v5 offset:4096
    v_mfma_f32_32x32x16_bf16 v[96:111], v[36:39], v[40:43], v[96:111]
    v_mfma_f32_32x32x16_bf16 v[112:127], v[36:39], v[44:47], v[112:127]
    s_waitcnt lgkmcnt(0)
    v_mfma_f32_32x32x16_bf16 v[64:79], v[48:51], v[56:59], v[64:79]
    v_mfma_f32_32x32x16_bf16 v[80:95], v[48:51], v[60:63], v[80:95]
    v_mfma_f32_32x32x16_bf16 v[96:111], v[52:55], v[56:59], v[96:111]
    v_mfma_f32_32x32x16_bf16 v[112:127], v[52:55], v[60:63], v[112:127]
    v_mfma_f32_32x32x16_bf16 v[64:79], v[16:19], v[24:27], v[64:79]
    v_mfma_f32_32x32x16_bf16 v[80:95], v[16:19], v[28:31], v[80:95]
    v_mfma_f32_32x32x16_bf16 v[96:111], v[20:23], v[24:27], v[96:111]
    v_mfma_f32_32x32x16_bf16 v[112:127], v[20:23], v[28:31], v[112:127]
    s_lshl_b32 s30, s13, 2
    s_lshl_b32 s31, s24, 1
    s_add_u32 s30, s30, s31
    s_lshl_b32 s31, s29, 7
    s_lshl_b32 s32, s25, 6
    s_add_u32 s31, s31, s32
    v_and_b32 v8, 15, v0
    v_add_u32 v8, s31, v8
    v_lshlrev_b32 v8, 6, v8
    v_bfe_u32 v9, v0, 4, 1
    v_lshlrev_b32 v9, 5, v9
    v_lshl_add_u32 v9, v15, 4, v9
    s_mul_i32 s32, s30, 40960
    s_add_u32 s32, s32, 0x300000
    v_add3_u32 v16, v8, v9, s32
    v_add_u32 v17, 40960, v16
    s_nop 7
    v_cvt_pk_bf16_f32 v32, v64, v65
    v_cvt_pk_bf16_f32 v33, v66, v67
    v_cvt_pk_bf16_f32 v34, v68, v69
    v_cvt_pk_bf16_f32 v35, v70, v71
    v_cvt_pk_bf16_f32 v36, v72, v73
    v_cvt_pk_bf16_f32 v37, v74, v75
    v_cvt_pk_bf16_f32 v38, v76, v77
    v_cvt_pk_bf16_f32 v39, v78, v79
    s_nop 1
    v_permlane16_swap_b32 v32, v36
    v_permlane16_swap_b32 v33, v37
    v_permlane16_swap_b32 v34, v38
    v_permlane16_swap_b32 v35, v39
    global_store_dwordx4 v16, v[32:35], s[10:11] offset:0 sc1
    global_store_dwordx4 v16, v[36:39], s[10:11] offset:1024 sc1
    v_cvt_pk_bf16_f32 v40, v80, v81
    v_cvt_pk_bf16_f32 v41, v82, v83
    v_cvt_pk_bf16_f32 v42, v84, v85
    v_cvt_pk_bf16_f32 v43, v86, v87
    v_cvt_pk_bf16_f32 v44, v88, v89
    v_cvt_pk_bf16_f32 v45, v90, v91
    v_cvt_pk_bf16_f32 v46, v92, v93
    v_cvt_pk_bf16_f32 v47, v94, v95
    s_nop 1
    v_permlane16_swap_b32 v40, v44
    v_permlane16_swap_b32 v41, v45
    v_permlane16_swap_b32 v42, v46
    v_permlane16_swap_b32 v43, v47
    global_store_dwordx4 v16, v[40:43], s[10:11] offset:2048 sc1
    global_store_dwordx4 v16, v[44:47], s[10:11] offset:3072 sc1
    v_cvt_pk_bf16_f32 v48, v96, v97
    v_cvt_pk_bf16_f32 v49, v98, v99
    v_cvt_pk_bf16_f32 v50, v100, v101
    v_cvt_pk_bf16_f32 v51, v102, v103
    v_cvt_pk_bf16_f32 v52, v104, v105
    v_cvt_pk_bf16_f32 v53, v106, v107
    v_cvt_pk_bf16_f32 v54, v108, v109
    v_cvt_pk_bf16_f32 v55, v110, v111
    s_nop 1
    v_permlane16_swap_b32 v48, v52
    v_permlane16_swap_b32 v49, v53
    v_permlane16_swap_b32 v50, v54
    v_permlane16_swap_b32 v51, v55
    global_store_dwordx4 v17, v[48:51], s[10:11] offset:0 sc1
    global_store_dwordx4 v17, v[52:55], s[10:11] offset:1024 sc1
    v_cvt_pk_bf16_f32 v56, v112, v113
    v_cvt_pk_bf16_f32 v57, v114, v115
    v_cvt_pk_bf16_f32 v58, v116, v117
    v_cvt_pk_bf16_f32 v59, v118, v119
    v_cvt_pk_bf16_f32 v60, v120, v121
    v_cvt_pk_bf16_f32 v61, v122, v123
    v_cvt_pk_bf16_f32 v62, v124, v125
    v_cvt_pk_bf16_f32 v63, v126, v127
    s_nop 1
    v_permlane16_swap_b32 v56, v60
    v_permlane16_swap_b32 v57, v61
    v_permlane16_swap_b32 v58, v62
    v_permlane16_swap_b32 v59, v63
    global_store_dwordx4 v17, v[56:59], s[10:11] offset:2048 sc1
    global_store_dwordx4 v17, v[60:63], s[10:11] offset:3072 sc1
    s_branch pk_qkv_done
pk_qkv_loader:
    s_sub_u32 s12, s97, 4
    s_mov_b32 s16, s4
    s_mov_b32 s17, s5
    s_mov_b32 s18, 2621440
    s_mov_b32 s19, 0x20000
    s_mov_b32 s20, s6
    s_mov_b32 s21, s7
    s_mov_b32 s22, 2457600
    s_mov_b32 s23, 0x20000
    v_lshrrev_b32 v14, 3, v0
    v_mul_u32_u24 v14, 1280, v14
    v_lshrrev_b32 v15, 4, v0
    v_and_b32 v21, 7, v0
    v_add_u32 v22, 0, v15
    v_and_b32 v22, 7, v22
    v_xor_b32 v22, v21, v22
    v_lshl_add_u32 v2, v22, 4, v14
    v_add_u32 v22, 4, v15
    v_and_b32 v22, 7, v22
    v_xor_b32 v22, v21, v22
    v_lshl_add_u32 v3, v22, 4, v14
    v_add_u32 v3, 9216, v3
    v_add_u32 v22, 8, v15
    v_and_b32 v22, 7, v22
    v_xor_b32 v22, v21, v22
    v_lshl_add_u32 v4, v22, 4, v14
    v_add_u32 v4, 18432, v4
    v_add_u32 v22, 12, v15
    v_and_b32 v22, 7, v22
    v_xor_b32 v22, v21, v22
    v_lshl_add_u32 v5, v22, 4, v14
    v_add_u32 v5, 27648, v5
    v_and_b32 v21, 15, v0
    v_lshlrev_b32 v22, 2, v15
    v_xor_b32 v21, v21, v22
    v_lshlrev_b32 v21, 4, v21
    v_mul_u32_u24 v23, 3840, v15
    v_add_u32 v6, v21, v23
    v_add_u32 v7, 14336, v6
    s_lshl_b32 s30, s13, 7
    s_lshl_b32 s26, s12, 5
    s_add_u32 s30, s30, s26
    s_mul_i32 s30, s30, 1280
    s_mul_i32 s31, s12, 30720
    s_lshl_b32 s26, s14, 8
    s_add_u32 s31, s31, s26
    s_lshl_b32 s32, s12, 12
    s_lshl_b32 s33, s12, 11
    s_lshr_b32 s34, s96, 3
    s_and_b32 s35, s34, 3
    s_lshr_b32 s34, s34, 2
    s_mul_i32 s35, s35, 3
    s_add_u32 s34, s34, s35
    s_cmp_ge_u32 s34, 10
    s_cselect_b32 s35, 10, 0
    s_sub_u32 s34, s34, s35
    s_lshl_b32 s35, s34, 7
    s_add_u32 s36, s30, 1280
    s_add_u32 s30, s30, s35
    s_mul_i32 s35, s34, 245760
    s_add_u32 s37, s31, 2457600
    s_add_u32 s31, s31, s35
    s_add_u32 m0, s32, 0
    s_nop 0
    buffer_load_dwordx4 v2, s[16:19], s30 offen offset:0 lds
    buffer_load_dwordx4 v3, s[16:19], s30 offen offset:1024 lds
    buffer_load_dwordx4 v4, s[16:19], s30 offen offset:2048 lds
    buffer_load_dwordx4 v5, s[16:19], s30 offen offset:3072 lds
    s_add_u32 s30, s30, 128
    s_cmp_ge_u32 s30, s36
    s_cselect_b32 s35, 1280, 0
    s_sub_u32 s30, s30, s35
    s_add_u32 m0, s33, 49152
    s_nop 0
    buffer_load_dwordx4 v6, s[20:23], s31 offen offset:0 lds
    buffer_load_dwordx4 v7, s[20:23], s31 offen offset:1024 lds
    s_add_u32 s31, s31, 122880
    s_cmp_ge_u32 s31, s37
    s_cselect_b32 s35, 2457600, 0
    s_sub_u32 s31, s31, s35
    s_add_u32 m0, s33, 57344
    s_nop 0
    buffer_load_dwordx4 v6, s[20:23], s31 offen offset:0 lds
    buffer_load_dwordx4 v7, s[20:23], s31 offen offset:1024 lds
    s_add_u32 s31, s31, 122880
    s_cmp_ge_u32 s31, s37
    s_cselect_b32 s35, 2457600, 0
    s_sub_u32 s31, s31, s35
    s_waitcnt vmcnt(2)
    s_barrier
    s_add_u32 m0, s32, 16384
    s_nop 0
    buffer_load_dwordx4 v2, s[16:19], s30 offen offset:0 lds
    buffer_load_dwordx4 v3, s[16:19], s30 offen offset:1024 lds
    buffer_load_dwordx4 v4, s[16:19], s30 offen offset:2048 lds
    buffer_load_dwordx4 v5, s[16:19], s30 offen offset:3072 lds
    s_add_u32 s30, s30, 128
    s_cmp_ge_u32 s30, s36
    s_cselect_b32 s35, 1280, 0
    s_sub_u32 s30, s30, s35
    s_add_u32 m0, s33, 65536
    s_nop 0
    buffer_load_dwordx4 v6, s[20:23], s31 offen offset:0 lds
    buffer_load_dwordx4 v7, s[20:23], s31 offen offset:1024 lds
    s_add_u32 s31, s31, 122880
    s_cmp_ge_u32 s31, s37
    s_cselect_b32 s35, 2457600, 0
    s_sub_u32 s31, s31, s35
    s_add_u32 m0, s33, 73728
    s_nop 0
    buffer_load_dwordx4 v6, s[20:23], s31 offen offset:0 lds
    buffer_load_dwordx4 v7, s[20:23], s31 offen offset:1024 lds
    s_add_u32 s31, s31, 122880
    s_cmp_ge_u32 s31, s37
    s_cselect_b32 s35, 2457600, 0
    s_sub_u32 s31, s31, s35
    s_add_u32 m0, s32, 32768
    s_nop 0
    buffer_load_dwordx4 v2, s[16:19], s30 offen offset:0 lds
    buffer_load_dwordx4 v3, s[16:19], s30 offen offset:1024 lds
    buffer_load_dwordx4 v4, s[16:19], s30 offen offset:2048 lds
    buffer_load_dwordx4 v5, s[16:19], s30 offen offset:3072 lds
    s_add_u32 s30, s30, 128
    s_cmp_ge_u32 s30, s36
    s_cselect_b32 s35, 1280, 0
    s_sub_u32 s30, s30, s35
    s_waitcnt vmcnt(12)
    s_barrier
    s_add_u32 m0, s33, 49152
    s_nop 0
    buffer_load_dwordx4 v6, s[20:23], s31 offen offset:0 lds
    buffer_load_dwordx4 v7, s[20:23], s31 offen offset:1024 lds
    s_add_u32 s31, s31, 122880
    s_cmp_ge_u32 s31, s37
    s_cselect_b32 s35, 2457600, 0
    s_sub_u32 s31, s31, s35
    s_waitcnt vmcnt(8)
    s_barrier
    s_add_u32 m0, s33, 57344
    s_nop 0
    buffer_load_dwordx4 v6, s[20:23], s31 offen offset:0 lds
    buffer_load_dwordx4 v7, s[20:23], s31 offen offset:1024 lds
    s_add_u32 s31, s31, 122880
    s_cmp_ge_u32 s31, s37
    s_cselect_b32 s35, 2457600, 0
    s_sub_u32 s31, s31, s35
    s_add_u32 m0, s32, 0
    s_nop 0
    buffer_load_dwordx4 v2, s[16:19], s30 offen offset:0 lds
    buffer_load_dwordx4 v3, s[16:19], s30 offen offset:1024 lds
    buffer_load_dwordx4 v4, s[16:19], s30 offen offset:2048 lds
    buffer_load_dwordx4 v5, s[16:19], s30 offen offset:3072 lds
    s_add_u32 s30, s30, 128
    s_cmp_ge_u32 s30, s36
    s_cselect_b32 s35, 1280, 0
    s_sub_u32 s30, s30, s35
    s_waitcnt vmcnt(12)
    s_barrier
    s_add_u32 m0, s33, 65536
    s_nop 0
    buffer_load_dwordx4 v6, s[20:23], s31 offen offset:0 lds
    buffer_load_dwordx4 v7, s[20:23], s31 offen offset:1024 lds
    s_add_u32 s31, s31, 122880
    s_cmp_ge_u32 s31, s37
    s_cselect_b32 s35, 2457600, 0
    s_sub_u32 s31, s31, s35
    s_waitcnt vmcnt(8)
    s_barrier
    s_add_u32 m0, s33, 73728
    s_nop 0
    buffer_load_dwordx4 v6, s[20:23], s31 offen offset:0 lds
    buffer_load_dwordx4 v7, s[20:23], s31 offen offset:1024 lds
    s_add_u32 s31, s31, 122880
    s_cmp_ge_u32 s31, s37
    s_cselect_b32 s35, 2457600, 0
    s_sub_u32 s31, s31, s35
    s_add_u32 m0, s32, 16384
    s_nop 0
    buffer_load_dwordx4 v2, s[16:19], s30 offen offset:0 lds
    buffer_load_dwordx4 v3, s[16:19], s30 offen offset:1024 lds
    buffer_load_dwordx4 v4, s[16:19], s30 offen offset:2048 lds
    buffer_load_dwordx4 v5, s[16:19], s30 offen offset:3072 lds
    s_add_u32 s30, s30, 128
    s_cmp_ge_u32 s30, s36
    s_cselect_b32 s35, 1280, 0
    s_sub_u32 s30, s30, s35
    s_waitcnt vmcnt(12)
    s_barrier
    s_add_u32 m0, s33, 49152
    s_nop 0
    buffer_load_dwordx4 v6, s[20:23], s31 offen offset:0 lds
    buffer_load_dwordx4 v7, s[20:23], s31 offen offset:1024 lds
    s_add_u32 s31, s31, 122880
    s_cmp_ge_u32 s31, s37
    s_cselect_b32 s35, 2457600, 0
    s_sub_u32 s31, s31, s35
    s_waitcnt vmcnt(8)
    s_barrier
    s_add_u32 m0, s33, 57344
    s_nop 0
    buffer_load_dwordx4 v6, s[20:23], s31 offen offset:0 lds
    buffer_load_dwordx4 v7, s[20:23], s31 offen offset:1024 lds
    s_add_u32 s31, s31, 122880
    s_cmp_ge_u32 s31, s37
    s_cselect_b32 s35, 2457600, 0
    s_sub_u32 s31, s31, s35
    s_add_u32 m0, s32, 32768
    s_nop 0
    buffer_load_dwordx4 v2, s[16:19], s30 offen offset:0 lds
    buffer_load_dwordx4 v3, s[16:19], s30 offen offset:1024 lds
    buffer_load_dwordx4 v4, s[16:19], s30 offen offset:2048 lds
    buffer_load_dwordx4 v5, s[16:19], s30 offen offset:3072 lds
    s_add_u32 s30, s30, 128
    s_cmp_ge_u32 s30, s36
    s_cselect_b32 s35, 1280, 0
    s_sub_u32 s30, s30, s35
    s_waitcnt vmcnt(12)
    s_barrier
    s_add_u32 m0, s33, 65536
    s_nop 0
    buffer_load_dwordx4 v6, s[20:23], s31 offen offset:0 lds
    buffer_load_dwordx4 v7, s[20:23], s31 offen offset:1024 lds
    s_add_u32 s31, s31, 122880
    s_cmp_ge_u32 s31, s37
    s_cselect_b32 s35, 2457600, 0
    s_sub_u32 s31, s31, s35
    s_waitcnt vmcnt(8)
    s_barrier
    s_add_u32 m0, s33, 73728
    s_nop 0
    buffer_load_dwordx4 v6, s[20:23], s31 offen offset:0 lds
    buffer_load_dwordx4 v7, s[20:23], s31 offen offset:1024 lds
    s_add_u32 s31, s31, 122880
    s_cmp_ge_u32 s31, s37
    s_cselect_b32 s35, 2457600, 0
    s_sub_u32 s31, s31, s35
    s_add_u32 m0, s32, 0
    s_nop 0
    buffer_load_dwordx4 v2, s[16:19], s30 offen offset:0 lds
    buffer_load_dwordx4 v3, s[16:19], s30 offen offset:1024 lds
    buffer_load_dwordx4 v4, s[16:19], s30 offen offset:2048 lds
    buffer_load_dwordx4 v5, s[16:19], s30 offen offset:3072 lds
    s_add_u32 s30, s30, 128
    s_cmp_ge_u32 s30, s36
    s_cselect_b32 s35, 1280, 0
    s_sub_u32 s30, s30, s35
    s_waitcnt vmcnt(12)
    s_barrier
    s_add_u32 m0, s33, 49152
    s_nop 0
    buffer_load_dwordx4 v6, s[20:23], s31 offen offset:0 lds
    buffer_load_dwordx4 v7, s[20:23], s31 offen offset:1024 lds
    s_add_u32 s31, s31, 122880
    s_cmp_ge_u32 s31, s37
    s_cselect_b32 s35, 2457600, 0
    s_sub_u32 s31, s31, s35
    s_waitcnt vmcnt(8)
    s_barrier
    s_add_u32 m0, s33, 57344
    s_nop 0
    buffer_load_dwordx4 v6, s[20:23], s31 offen offset:0 lds
    buffer_load_dwordx4 v7, s[20:23], s31 offen offset:1024 lds
    s_add_u32 s31, s31, 122880
    s_cmp_ge_u32 s31, s37
    s_cselect_b32 s35, 2457600, 0
    s_sub_u32 s31, s31, s35
    s_add_u32 m0, s32, 16384
    s_nop 0
    buffer_load_dwordx4 v2, s[16:19], s30 offen offset:0 lds
    buffer_load_dwordx4 v3, s[16:19], s30 offen offset:1024 lds
    buffer_load_dwordx4 v4, s[16:19], s30 offen offset:2048 lds
    buffer_load_dwordx4 v5, s[16:19], s30 offen offset:3072 lds
    s_add_u32 s30, s30, 128
    s_cmp_ge_u32 s30, s36
    s_cselect_b32 s35, 1280, 0
    s_sub_u32 s30, s30, s35
    s_waitcnt vmcnt(12)
    s_barrier
    s_add_u32 m0, s33, 65536
    s_nop 0
    buffer_load_dwordx4 v6, s[20:23], s31 offen offset:0 lds
    buffer_load_dwordx4 v7, s[20:23], s31 offen offset:1024 lds
    s_add_u32 s31, s31, 122880
    s_cmp_ge_u32 s31, s37
    s_cselect_b32 s35, 2457600, 0
    s_sub_u32 s31, s31, s35
    s_waitcnt vmcnt(8)
    s_barrier
    s_add_u32 m0, s33, 73728
    s_nop 0
    buffer_load_dwordx4 v6, s[20:23], s31 offen offset:0 lds
    buffer_load_dwordx4 v7, s[20:23], s31 offen offset:1024 lds
    s_add_u32 s31, s31, 122880
    s_cmp_ge_u32 s31, s37
    s_cselect_b32 s35, 2457600, 0
    s_sub_u32 s31, s31, s35
    s_add_u32 m0, s32, 32768
    s_nop 0
    buffer_load_dwordx4 v2, s[16:19], s30 offen offset:0 lds
    buffer_load_dwordx4 v3, s[16:19], s30 offen offset:1024 lds
    buffer_load_dwordx4 v4, s[16:19], s30 offen offset:2048 lds
    buffer_load_dwordx4 v5, s[16:19], s30 offen offset:3072 lds
    s_add_u32 s30, s30, 128
    s_cmp_ge_u32 s30, s36
    s_cselect_b32 s35, 1280, 0
    s_sub_u32 s30, s30, s35
    s_waitcnt vmcnt(12)
    s_barrier
    s_add_u32 m0, s33, 49152
    s_nop 0
    buffer_load_dwordx4 v6, s[20:23], s31 offen offset:0 lds
    buffer_load_dwordx4 v7, s[20:23], s31 offen offset:1024 lds
    s_add_u32 s31, s31, 122880
    s_cmp_ge_u32 s31, s37
    s_cselect_b32 s35, 2457600, 0
    s_sub_u32 s31, s31, s35
    s_waitcnt vmcnt(8)
    s_barrier
    s_add_u32 m0, s33, 57344
    s_nop 0
    buffer_load_dwordx4 v6, s[20:23], s31 offen offset:0 lds
    buffer_load_dwordx4 v7, s[20:23], s31 offen offset:1024 lds
    s_add_u32 s31, s31, 122880
    s_cmp_ge_u32 s31, s37
    s_cselect_b32 s35, 2457600, 0
    s_sub_u32 s31, s31, s35
    s_add_u32 m0, s32, 0
    s_nop 0
    buffer_load_dwordx4 v2, s[16:19], s30 offen offset:0 lds
    buffer_load_dwordx4 v3, s[16:19], s30 offen offset:1024 lds
    buffer_load_dwordx4 v4, s[16:19], s30 offen offset:2048 lds
    buffer_load_dwordx4 v5, s[16:19], s30 offen offset:3072 lds
    s_add_u32 s30, s30, 128
    s_cmp_ge_u32 s30, s36
    s_cselect_b32 s35, 1280, 0
    s_sub_u32 s30, s30, s35
    s_waitcnt vmcnt(12)
    s_barrier
    s_add_u32 m0, s33, 65536
    s_nop 0
    buffer_load_dwordx4 v6, s[20:23], s31 offen offset:0 lds
    buffer_load_dwordx4 v7, s[20:23], s31 offen offset:1024 lds
    s_add_u32 s31, s31, 122880
    s_cmp_ge_u32 s31, s37
    s_cselect_b32 s35, 2457600, 0
    s_sub_u32 s31, s31, s35
    s_waitcnt vmcnt(8)
    s_barrier
    s_add_u32 m0, s33, 73728
    s_nop 0
    buffer_load_dwordx4 v6, s[20:23], s31 offen offset:0 lds
    buffer_load_dwordx4 v7, s[20:23], s31 offen offset:1024 lds
    s_add_u32 s31, s31, 122880
    s_cmp_ge_u32 s31, s37
    s_cselect_b32 s35, 2457600, 0
    s_sub_u32 s31, s31, s35
    s_waitcnt vmcnt(8)
    s_barrier
    s_waitcnt vmcnt(2)
    s_barrier
    s_waitcnt vmcnt(0)
    s_barrier
    s_cmp_lg_u32 s97, 4
    s_cbranch_scc1 qtail_25
    s_load_dwordx2 s[8:9], s[0:1], 80
    v_mov_b32 v2, 0
    s_mov_b32 s56, 0
    s_waitcnt lgkmcnt(0)
ng_26:
    global_load_dword v3, v2, s[8:9] sc1
    s_add_u32 s56, s56, 1
    s_waitcnt vmcnt(0)
    v_readfirstlane_b32 s100, v3
    s_nop 3
    s_cmp_lg_u32 s100, 0
    s_cbranch_scc1 ngok_27
    s_sleep 4
    s_cmp_lt_u32 s56, 0x8000
    s_cbranch_scc1 ng_26
ngok_27:
    s_lshl_b32 s56, s13, 7
    s_add_u32 s56, s56, 0x1f00000
    v_mbcnt_lo_u32_b32 v2, -1, 0
    v_mbcnt_hi_u32_b32 v2, -1, v2
    v_min_u32 v2, 15, v2
    v_lshl_add_u32 v2, v2, 2, s56
    s_mov_b32 s57, 0
fw_28:
    global_load_dword v3, v2, s[10:11] sc1
    s_add_u32 s57, s57, 1
    s_waitcnt vmcnt(0)
    v_cmp_ne_u32 vcc, s100, v3
    s_cbranch_vccz fwok_29
    s_sleep 2
    s_cmp_lt_u32 s57, 0x8000
    s_cbranch_scc1 fw_28
fwok_29:
qtail_25:
pk_qkv_done:
    s_branch qend_24
qidle_23:
    s_cmp_lg_u32 s97, 4
    s_cbranch_scc1 qtail_30
    s_load_dwordx2 s[8:9], s[0:1], 80
    v_mov_b32 v2, 0
    s_mov_b32 s56, 0
    s_waitcnt lgkmcnt(0)
ng_31:
    global_load_dword v3, v2, s[8:9] sc1
    s_add_u32 s56, s56, 1
    s_waitcnt vmcnt(0)
    v_readfirstlane_b32 s100, v3
    s_nop 3
    s_cmp_lg_u32 s100, 0
    s_cbranch_scc1 ngok_32
    s_sleep 4
    s_cmp_lt_u32 s56, 0x8000
    s_cbranch_scc1 ng_31
ngok_32:
    s_lshl_b32 s56, s13, 7
    s_add_u32 s56, s56, 0x1f00000
    v_mbcnt_lo_u32_b32 v2, -1, 0
    v_mbcnt_hi_u32_b32 v2, -1, v2
    v_min_u32 v2, 15, v2
    v_lshl_add_u32 v2, v2, 2, s56
    s_mov_b32 s57, 0
fw_33:
    global_load_dword v3, v2, s[10:11] sc1
    s_add_u32 s57, s57, 1
    s_waitcnt vmcnt(0)
    v_cmp_ne_u32 vcc, s100, v3
    s_cbranch_vccz fwok_34
    s_sleep 2
    s_cmp_lt_u32 s57, 0x8000
    s_cbranch_scc1 fw_33
fwok_34:
qtail_30:
qend_24:
    s_barrier
    s_load_dwordx4 s[4:7], s[0:1], 32
    s_setprio 3
    s_waitcnt lgkmcnt(0)
    s_mov_b32 s12, s97
    s_and_b32 s3, s96, 7
    s_lshr_b32 s15, s96, 3
    s_and_b32 s13, s3, 3
    s_lshl_b32 s13, s13, 2
    s_and_b32 s24, s15, 3
    s_add_u32 s13, s13, s24
    s_lshr_b32 s14, s3, 2
    s_lshl_b32 s14, s14, 3
    s_lshr_b32 s24, s15, 2
    s_add_u32 s14, s14, s24
    s_setprio 3
    s_cmp_ge_u32 s12, 4
    s_cbranch_scc1 pk_m1_loader
    v_and_b32 v14, 31, v0
    v_lshrrev_b32 v15, 5, v0
    v_lshrrev_b32 v16, 1, v14
    v_and_b32 v16, 7, v16
    v_xor_b32 v16, v15, v16
    s_lshl_b32 s26, s12, 12
    v_lshlrev_b32 v17, 7, v14
    v_add_u32 v17, s26, v17
    v_xor_b32 v18, 0, v16
    v_lshl_add_u32 v2, v18, 4, v17
    v_xor_b32 v18, 2, v16
    v_lshl_add_u32 v3, v18, 4, v17
    v_xor_b32 v18, 4, v16
    v_lshl_add_u32 v4, v18, 4, v17
    v_xor_b32 v18, 6, v16
    v_lshl_add_u32 v5, v18, 4, v17
    v_lshrrev_b32 v18, 4, v0
    v_and_b32 v19, 15, v0
    v_and_b32 v20, 1, v18
    v_lshlrev_b32 v20, 2, v20
    v_and_b32 v21, 3, v19
    v_add_u32 v20, v20, v21
    v_lshlrev_b32 v20, 2, v20
    s_mov_b32 s26, 0x75643120
    v_lshrrev_b32 v20, v20, s26
    v_and_b32 v20, 7, v20
    v_lshrrev_b32 v21, 2, v19
    v_lshrrev_b32 v22, 1, v18
    v_lshl_add_u32 v22, v22, 3, v21
    v_mul_u32_u24 v22, 192, v22
    v_lshl_add_u32 v22, v20, 3, v22
    v_add_u32 v6, 49152, v22
    s_mul_i32 s26, s14, 192
    v_lshlrev_b32 v12, 4, v15
    v_add_u32 v12, s26, v12
    global_load_dwordx4 v[64:67], v12, s[6:7] offset:0
    global_load_dwordx4 v[68:71], v12, s[6:7] offset:32
    global_load_dwordx4 v[72:75], v12, s[6:7] offset:64
    global_load_dwordx4 v[76:79], v12, s[6:7] offset:96
    global_load_dwordx4 v[80:83], v12, s[6:7] offset:128
    global_load_dwordx4 v[84:87], v12, s[6:7] offset:160
    s_waitcnt vmcnt(0)
    s_barrier
    v_lshlrev_b32 v16, 16, v64
    v_and_b32 v17, 0xffff0000, v64
    v_lshlrev_b32 v18, 16, v65
    v_and_b32 v19, 0xffff0000, v65
    v_lshlrev_b32 v20, 16, v66
    v_and_b32 v21, 0xffff0000, v66
    v_lshlrev_b32 v22, 16, v67
    v_and_b32 v23, 0xffff0000, v67
    v_lshlrev_b32 v24, 16, v68
    v_and_b32 v25, 0xffff0000, v68
    v_lshlrev_b32 v26, 16, v69
    v_and_b32 v27, 0xffff0000, v69
    v_lshlrev_b32 v28, 16, v70
    v_and_b32 v29, 0xffff0000, v70
    v_lshlrev_b32 v30, 16, v71
    v_and_b32 v31, 0xffff0000, v71
    v_lshlrev_b32 v32, 16, v72
    v_and_b32 v33, 0xffff0000, v72
    v_lshlrev_b32 v34, 16, v73
    v_and_b32 v35, 0xffff0000, v73
    v_lshlrev_b32 v36, 16, v74
    v_and_b32 v37, 0xffff0000, v74
    v_lshlrev_b32 v38, 16, v75
    v_and_b32 v39, 0xffff0000, v75
    v_lshlrev_b32 v40, 16, v76
    v_and_b32 v41, 0xffff0000, v76
    v_lshlrev_b32 v42, 16, v77
    v_and_b32 v43, 0xffff0000, v77
    v_lshlrev_b32 v44, 16, v78
    v_and_b32 v45, 0xffff0000, v78
    v_lshlrev_b32 v46, 16, v79
    v_and_b32 v47, 0xffff0000, v79
    v_lshlrev_b32 v48, 16, v80
    v_and_b32 v49, 0xffff0000, v80
    v_lshlrev_b32 v50, 16, v81
    v_and_b32 v51, 0xffff0000, v81
    v_lshlrev_b32 v52, 16, v82
    v_and_b32 v53, 0xffff0000, v82
    v_lshlrev_b32 v54, 16, v83
    v_and_b32 v55, 0xffff0000, v83
    v_lshlrev_b32 v56, 16, v84
    v_and_b32 v57, 0xffff0000, v84
    v_lshlrev_b32 v58, 16, v85
    v_and_b32 v59, 0xffff0000, v85
    v_lshlrev_b32 v60, 16, v86
    v_and_b32 v61, 0xffff0000, v86
    v_lshlrev_b32 v62, 16, v87
    v_and_b32 v63, 0xffff0000, v87
    s_setprio 0
    s_barrier
    ds_read_b128 v[64:67], v2 offset:0
    ds_read_b64_tr_b16 v[68:69], v6 offset:0
    ds_read_b64_tr_b16 v[70:71], v6 offset:768
    ds_read_b64_tr_b16 v[72:73], v6 offset:64
    ds_read_b64_tr_b16 v[74:75], v6 offset:832
    ds_read_b64_tr_b16 v[76:77], v6 offset:128
    ds_read_b64_tr_b16 v[78:79], v6 offset:896
    ds_read_b128 v[80:83], v3 offset:0
    ds_read_b64_tr_b16 v[84:85], v6 offset:3072
    ds_read_b64_tr_b16 v[86:87], v6 offset:3840
    ds_read_b64_tr_b16 v[88:89], v6 offset:3136
    ds_read_b64_tr_b16 v[90:91], v6 offset:3904
    ds_read_b64_tr_b16 v[92:93], v6 offset:3200
    ds_read_b64_tr_b16 v[94:95], v6 offset:3968
    s_waitcnt lgkmcnt(0)
    v_mfma_f32_32x32x16_bf16 v[16:31], v[68:71], v[64:67], v[16:31]
    s_barrier
    ds_read_b128 v[96:99], v4 offset:0
    ds_read_b64_tr_b16 v[100:101], v6 offset:6144
    ds_read_b64_tr_b16 v[102:103], v6 offset:6912
    ds_read_b64_tr_b16 v[104:105], v6 offset:6208
    v_mfma_f32_32x32x16_bf16 v[32:47], v[72:75], v[64:67], v[32:47]
    ds_read_b64_tr_b16 v[106:107], v6 offset:6976
    ds_read_b64_tr_b16 v[108:109], v6 offset:6272
    ds_read_b64_tr_b16 v[110:111], v6 offset:7040
    ds_read_b128 v[112:115], v5 offset:0
    v_mfma_f32_32x32x16_bf16 v[48:63], v[76:79], v[64:67], v[48:63]
    ds_read_b64_tr_b16 v[116:117], v6 offset:9216
    ds_read_b64_tr_b16 v[118:119], v6 offset:9984
    ds_read_b64_tr_b16 v[120:121], v6 offset:9280
    ds_read_b64_tr_b16 v[122:123], v6 offset:10048
    v_mfma_f32_32x32x16_bf16 v[16:31], v[84:87], v[80:83], v[16:31]
    ds_read_b64_tr_b16 v[124:125], v6 offset:9344
    ds_read_b64_tr_b16 v[126:127], v6 offset:10112
    v_mfma_f32_32x32x16_bf16 v[32:47], v[88:91], v[80:83], v[32:47]
    v_mfma_f32_32x32x16_bf16 v[48:63], v[92:95], v[80:83], v[48:63]
    s_waitcnt lgkmcnt(0)
    v_mfma_f32_32x32x16_bf16 v[16:31], v[100:103], v[96:99], v[16:31]
    s_barrier
    ds_read_b128 v[64:67], v2 offset:16384
    ds_read_b64_tr_b16 v[68:69], v6 offset:12288
    ds_read_b64_tr_b16 v[70:71], v6 offset:13056
    ds_read_b64_tr_b16 v[72:73], v6 offset:12352
    v_mfma_f32_32x32x16_bf16 v[32:47], v[104:107], v[96:99], v[32:47]
    ds_read_b64_tr_b16 v[74:75], v6 offset:13120
    ds_read_b64_tr_b16 v[76:77], v6 offset:12416
    ds_read_b64_tr_b16 v[78:79], v6 offset:13184
    ds_read_b128 v[80:83], v3 offset:16384
    v_mfma_f32_32x32x16_bf16 v[48:63], v[108:111], v[96:99], v[48:63]
    ds_read_b64_tr_b16 v[84:85], v6 offset:15360
    ds_read_b64_tr_b16 v[86:87], v6 offset:16128
    ds_read_b64_tr_b16 v[88:89], v6 offset:15424
    ds_read_b64_tr_b16 v[90:91], v6 offset:16192
    v_mfma_f32_32x32x16_bf16 v[16:31], v[116:119], v[112:115], v[16:31]
    ds_read_b64_tr_b16 v[92:93], v6 offset:15488
    ds_read_b64_tr_b16 v[94:95], v6 offset:16256
    v_mfma_f32_32x32x16_bf16 v[32:47], v[120:123], v[112:115], v[32:47]
    v_mfma_f32_32x32x16_bf16 v[48:63], v[124:127], v[112:115], v[48:63]
    s_waitcnt lgkmcnt(0)
    v_mfma_f32_32x32x16_bf16 v[16:31], v[68:71], v[64:67], v[16:31]
    s_barrier
    ds_read_b128 v[96:99], v4 offset:16384
    ds_read_b64_tr_b16 v[100:101], v6 offset:18432
    ds_read_b64_tr_b16 v[102:103], v6 offset:19200
    ds_read_b64_tr_b16 v[104:105], v6 offset:18496
    v_mfma_f32_32x32x16_bf16 v[32:47], v[72:75], v[64:67], v[32:47]
    ds_read_b64_tr_b16 v[106:107], v6 offset:19264
    ds_read_b64_tr_b16 v[108:109], v6 offset:18560
    ds_read_b64_tr_b16 v[110:111], v6 offset:19328
    ds_read_b128 v[112:115], v5 offset:16384
    v_mfma_f32_32x32x16_bf16 v[48:63], v[76:79], v[64:67], v[48:63]
    ds_read_b64_tr_b16 v[116:117], v6 offset:21504
    ds_read_b64_tr_b16 v[118:119], v6 offset:22272
    ds_read_b64_tr_b16 v[120:121], v6 offset:21568
    ds_read_b64_tr_b16 v[122:123], v6 offset:22336
    v_mfma_f32_32x32x16_bf16 v[16:31], v[84:87], v[80:83], v[16:31]
    ds_read_b64_tr_b16 v[124:125], v6 offset:21632
    ds_read_b64_tr_b16 v[126:127], v6 offset:22400
    v_mfma_f32_32x32x16_bf16 v[32:47], v[88:91], v[80:83], v[32:47]
    v_mfma_f32_32x32x16_bf16 v[48:63], v[92:95], v[80:83], v[48:63]
    s_waitcnt lgkmcnt(0)
    v_mfma_f32_32x32x16_bf16 v[16:31], v[100:103], v[96:99], v[16:31]
    s_barrier
    ds_read_b128 v[64:67], v2 offset:32768
    ds_read_b64_tr_b16 v[68:69], v6 offset:0
    ds_read_b64_tr_b16 v[70:71], v6 offset:768
    ds_read_b64_tr_b16 v[72:73], v6 offset:64
    v_mfma_f32_32x32x16_bf16 v[32:47], v[104:107], v[96:99], v[32:47]
    ds_read_b64_tr_b16 v[74:75], v6 offset:832
    ds_read_b64_tr_b16 v[76:77], v6 offset:128
    ds_read_b64_tr_b16 v[78:79], v6 offset:896
    ds_read_b128 v[80:83], v3 offset:32768
    v_mfma_f32_32x32x16_bf16 v[48:63], v[108:111], v[96:99], v[48:63]
    ds_read_b64_tr_b16 v[84:85], v6 offset:3072
    ds_read_b64_tr_b16 v[86:87], v6 offset:3840
    ds_read_b64_tr_b16 v[88:89], v6 offset:3136
    ds_read_b64_tr_b16 v[90:91], v6 offset:3904
    v_mfma_f32_32x32x16_bf16 v[16:31], v[116:119], v[112:115], v[16:31]
    ds_read_b64_tr_b16 v[92:93], v6 offset:3200
    ds_read_b64_tr_b16 v[94:95], v6 offset:3968
    v_mfma_f32_32x32x16_bf16 v[32:47], v[120:123], v[112:115], v[32:47]
    v_mfma_f32_32x32x16_bf16 v[48:63], v[124:127], v[112:115], v[48:63]
    s_waitcnt lgkmcnt(0)
    v_mfma_f32_32x32x16_bf16 v[16:31], v[68:71], v[64:67], v[16:31]
    s_barrier
    ds_read_b128 v[96:99], v4 offset:32768
    ds_read_b64_tr_b16 v[100:101], v6 offset:6144
    ds_read_b64_tr_b16 v[102:103], v6 offset:6912
    ds_read_b64_tr_b16 v[104:105], v6 offset:6208
    v_mfma_f32_32x32x16_bf16 v[32:47], v[72:75], v[64:67], v[32:47]
    ds_read_b64_tr_b16 v[106:107], v6 offset:6976
    ds_read_b64_tr_b16 v[108:109], v6 offset:6272
    ds_read_b64_tr_b16 v[110:111], v6 offset:7040
    ds_read_b128 v[112:115], v5 offset:32768
    v_mfma_f32_32x32x16_bf16 v[48:63], v[76:79], v[64:67], v[48:63]
    ds_read_b64_tr_b16 v[116:117], v6 offset:9216
    ds_read_b64_tr_b16 v[118:119], v6 offset:9984
    ds_read_b64_tr_b16 v[120:121], v6 offset:9280
    ds_read_b64_tr_b16 v[122:123], v6 offset:10048
    v_mfma_f32_32x32x16_bf16 v[16:31], v[84:87], v[80:83], v[16:31]
    ds_read_b64_tr_b16 v[124:125], v6 offset:9344
    ds_read_b64_tr_b16 v[126:127], v6 offset:10112
    v_mfma_f32_32x32x16_bf16 v[32:47], v[88:91], v[80:83], v[32:47]
    v_mfma_f32_32x32x16_bf16 v[48:63], v[92:95], v[80:83], v[48:63]
    s_waitcnt lgkmcnt(0)
    v_mfma_f32_32x32x16_bf16 v[16:31], v[100:103], v[96:99], v[16:31]
    s_barrier
    ds_read_b128 v[64:67], v2 offset:0
    ds_read_b64_tr_b16 v[68:69], v6 offset:12288
    ds_read_b64_tr_b16 v[70:71], v6 offset:13056
    ds_read_b64_tr_b16 v[72:73], v6 offset:12352
    v_mfma_f32_32x32x16_bf16 v[32:47], v[104:107], v[96:99], v[32:47]
    ds_read_b64_tr_b16 v[74:75], v6 offset:13120
    ds_read_b64_tr_b16 v[76:77], v6 offset:12416
    ds_read_b64_tr_b16 v[78:79], v6 offset:13184
    ds_read_b128 v[80:83], v3 offset:0
    v_mfma_f32_32x32x16_bf16 v[48:63], v[108:111], v[96:99], v[48:63]
    ds_read_b64_tr_b16 v[84:85], v6 offset:15360
    ds_read_b64_tr_b16 v[86:87], v6 offset:16128
    ds_read_b64_tr_b16 v[88:89], v6 offset:15424
    ds_read_b64_tr_b16 v[90:91], v6 offset:16192
    v_mfma_f32_32x32x16_bf16 v[16:31], v[116:119], v[112:115], v[16:31]
    ds_read_b64_tr_b16 v[92:93], v6 offset:15488
    ds_read_b64_tr_b16 v[94:95], v6 offset:16256
    v_mfma_f32_32x32x16_bf16 v[32:47], v[120:123], v[112:115], v[32:47]
    v_mfma_f32_32x32x16_bf16 v[48:63], v[124:127], v[112:115], v[48:63]
    s_waitcnt lgkmcnt(0)
    v_mfma_f32_32x32x16_bf16 v[16:31], v[68:71], v[64:67], v[16:31]
    s_barrier
    ds_read_b128 v[96:99], v4 offset:0
    ds_read_b64_tr_b16 v[100:101], v6 offset:18432
    ds_read_b64_tr_b16 v[102:103], v6 offset:19200
    ds_read_b64_tr_b16 v[104:105], v6 offset:18496
    v_mfma_f32_32x32x16_bf16 v[32:47], v[72:75], v[64:67], v[32:47]
    ds_read_b64_tr_b16 v[106:107], v6 offset:19264
    ds_read_b64_tr_b16 v[108:109], v6 offset:18560
    ds_read_b64_tr_b16 v[110:111], v6 offset:19328
    ds_read_b128 v[112:115], v5 offset:0
    v_mfma_f32_32x32x16_bf16 v[48:63], v[76:79], v[64:67], v[48:63]
    ds_read_b64_tr_b16 v[116:117], v6 offset:21504
    ds_read_b64_tr_b16 v[118:119], v6 offset:22272
    ds_read_b64_tr_b16 v[120:121], v6 offset:21568
    ds_read_b64_tr_b16 v[122:123], v6 offset:22336
    v_mfma_f32_32x32x16_bf16 v[16:31], v[84:87], v[80:83], v[16:31]
    ds_read_b64_tr_b16 v[124:125], v6 offset:21632
    ds_read_b64_tr_b16 v[126:127], v6 offset:22400
    v_mfma_f32_32x32x16_bf16 v[32:47], v[88:91], v[80:83], v[32:47]
    v_mfma_f32_32x32x16_bf16 v[48:63], v[92:95], v[80:83], v[48:63]
    s_waitcnt lgkmcnt(0)
    v_mfma_f32_32x32x16_bf16 v[16:31], v[100:103], v[96:99], v[16:31]
    s_barrier
    ds_read_b128 v[64:67], v2 offset:16384
    ds_read_b64_tr_b16 v[68:69], v6 offset:0
    ds_read_b64_tr_b16 v[70:71], v6 offset:768
    ds_read_b64_tr_b16 v[72:73], v6 offset:64
    v_mfma_f32_32x32x16_bf16 v[32:47], v[104:107], v[96:99], v[32:47]
    ds_read_b64_tr_b16 v[74:75], v6 offset:832
    ds_read_b64_tr_b16 v[76:77], v6 offset:128
    ds_read_b64_tr_b16 v[78:79], v6 offset:896
    ds_read_b128 v[80:83], v3 offset:16384
    v_mfma_f32_32x32x16_bf16 v[48:63], v[108:111], v[96:99], v[48:63]
    ds_read_b64_tr_b16 v[84:85], v6 offset:3072
    ds_read_b64_tr_b16 v[86:87], v6 offset:3840
    ds_read_b64_tr_b16 v[88:89], v6 offset:3136
    ds_read_b64_tr_b16 v[90:91], v6 offset:3904
    v_mfma_f32_32x32x16_bf16 v[16:31], v[116:119], v[112:115], v[16:31]
    ds_read_b64_tr_b16 v[92:93], v6 offset:3200
    ds_read_b64_tr_b16 v[94:95], v6 offset:3968
    v_mfma_f32_32x32x16_bf16 v[32:47], v[120:123], v[112:115], v[32:47]
    v_mfma_f32_32x32x16_bf16 v[48:63], v[124:127], v[112:115], v[48:63]
    s_waitcnt lgkmcnt(0)
    v_mfma_f32_32x32x16_bf16 v[16:31], v[68:71], v[64:67], v[16:31]
    s_barrier
    ds_read_b128 v[96:99], v4 offset:16384
    ds_read_b64_tr_b16 v[100:101], v6 offset:6144
    ds_read_b64_tr_b16 v[102:103], v6 offset:6912
    ds_read_b64_tr_b16 v[104:105], v6 offset:6208
    v_mfma_f32_32x32x16_bf16 v[32:47], v[72:75], v[64:67], v[32:47]
    ds_read_b64_tr_b16 v[106:107], v6 offset:6976
    ds_read_b64_tr_b16 v[108:109], v6 offset:6272
    ds_read_b64_tr_b16 v[110:111], v6 offset:7040
    ds_read_b128 v[112:115], v5 offset:16384
    v_mfma_f32_32x32x16_bf16 v[48:63], v[76:79], v[64:67], v[48:63]
    ds_read_b64_tr_b16 v[116:117], v6 offset:9216
    ds_read_b64_tr_b16 v[118:119], v6 offset:9984
    ds_read_b64_tr_b16 v[120:121], v6 offset:9280
    ds_read_b64_tr_b16 v[122:123], v6 offset:10048
    v_mfma_f32_32x32x16_bf16 v[16:31], v[84:87], v[80:83], v[16:31]
    ds_read_b64_tr_b16 v[124:125], v6 offset:9344
    ds_read_b64_tr_b16 v[126:127], v6 offset:10112
    v_mfma_f32_32x32x16_bf16 v[32:47], v[88:91], v[80:83], v[32:47]
    v_mfma_f32_32x32x16_bf16 v[48:63], v[92:95], v[80:83], v[48:63]
    s_waitcnt lgkmcnt(0)
    v_mfma_f32_32x32x16_bf16 v[16:31], v[100:103], v[96:99], v[16:31]
    s_barrier
    ds_read_b128 v[64:67], v2 offset:32768
    ds_read_b64_tr_b16 v[68:69], v6 offset:12288
    ds_read_b64_tr_b16 v[70:71], v6 offset:13056
    ds_read_b64_tr_b16 v[72:73], v6 offset:12352
    v_mfma_f32_32x32x16_bf16 v[32:47], v[104:107], v[96:99], v[32:47]
    ds_read_b64_tr_b16 v[74:75], v6 offset:13120
    ds_read_b64_tr_b16 v[76:77], v6 offset:12416
    ds_read_b64_tr_b16 v[78:79], v6 offset:13184
    ds_read_b128 v[80:83], v3 offset:32768
    v_mfma_f32_32x32x16_bf16 v[48:63], v[108:111], v[96:99], v[48:63]
    ds_read_b64_tr_b16 v[84:85], v6 offset:15360
    ds_read_b64_tr_b16 v[86:87], v6 offset:16128
    ds_read_b64_tr_b16 v[88:89], v6 offset:15424
    ds_read_b64_tr_b16 v[90:91], v6 offset:16192
    v_mfma_f32_32x32x16_bf16 v[16:31], v[116:119], v[112:115], v[16:31]
    ds_read_b64_tr_b16 v[92:93], v6 offset:15488
    ds_read_b64_tr_b16 v[94:95], v6 offset:16256
    v_mfma_f32_32x32x16_bf16 v[32:47], v[120:123], v[112:115], v[32:47]
    v_mfma_f32_32x32x16_bf16 v[48:63], v[124:127], v[112:115], v[48:63]
    s_waitcnt lgkmcnt(0)
    v_mfma_f32_32x32x16_bf16 v[16:31], v[68:71], v[64:67], v[16:31]
    s_barrier
    ds_read_b128 v[96:99], v4 offset:32768
    ds_read_b64_tr_b16 v[100:101], v6 offset:18432
    ds_read_b64_tr_b16 v[102:103], v6 offset:19200
    ds_read_b64_tr_b16 v[104:105], v6 offset:18496
    v_mfma_f32_32x32x16_bf16 v[32:47], v[72:75], v[64:67], v[32:47]
    ds_read_b64_tr_b16 v[106:107], v6 offset:19264
    ds_read_b64_tr_b16 v[108:109], v6 offset:18560
    ds_read_b64_tr_b16 v[110:111], v6 offset:19328
    ds_read_b128 v[112:115], v5 offset:32768
    v_mfma_f32_32x32x16_bf16 v[48:63], v[76:79], v[64:67], v[48:63]
    ds_read_b64_tr_b16 v[116:117], v6 offset:21504
    ds_read_b64_tr_b16 v[118:119], v6 offset:22272
    ds_read_b64_tr_b16 v[120:121], v6 offset:21568
    ds_read_b64_tr_b16 v[122:123], v6 offset:22336
    v_mfma_f32_32x32x16_bf16 v[16:31], v[84:87], v[80:83], v[16:31]
    ds_read_b64_tr_b16 v[124:125], v6 offset:21632
    ds_read_b64_tr_b16 v[126:127], v6 offset:22400
    v_mfma_f32_32x32x16_bf16 v[32:47], v[88:91], v[80:83], v[32:47]
    v_mfma_f32_32x32x16_bf16 v[48:63], v[92:95], v[80:83], v[48:63]
    s_waitcnt lgkmcnt(0)
    v_mfma_f32_32x32x16_bf16 v[16:31], v[100:103], v[96:99], v[16:31]
    s_barrier
    ds_read_b128 v[64:67], v2 offset:0
    ds_read_b64_tr_b16 v[68:69], v6 offset:0
    ds_read_b64_tr_b16 v[70:71], v6 offset:768
    ds_read_b64_tr_b16 v[72:73], v6 offset:64
    v_mfma_f32_32x32x16_bf16 v[32:47], v[104:107], v[96:99], v[32:47]
    ds_read_b64_tr_b16 v[74:75], v6 offset:832
    ds_read_b64_tr_b16 v[76:77], v6 offset:128
    ds_read_b64_tr_b16 v[78:79], v6 offset:896
    ds_read_b128 v[80:83], v3 offset:0
    v_mfma_f32_32x32x16_bf16 v[48:63], v[108:111], v[96:99], v[48:63]
    ds_read_b64_tr_b16 v[84:85], v6 offset:3072
    ds_read_b64_tr_b16 v[86:87], v6 offset:3840
    ds_read_b64_tr_b16 v[88:89], v6 offset:3136
    ds_read_b64_tr_b16 v[90:91], v6 offset:3904
    v_mfma_f32_32x32x16_bf16 v[16:31], v[116:119], v[112:115], v[16:31]
    ds_read_b64_tr_b16 v[92:93], v6 offset:3200
    ds_read_b64_tr_b16 v[94:95], v6 offset:3968
    v_mfma_f32_32x32x16_bf16 v[32:47], v[120:123], v[112:115], v[32:47]
    v_mfma_f32_32x32x16_bf16 v[48:63], v[124:127], v[112:115], v[48:63]
    s_waitcnt lgkmcnt(0)
    v_mfma_f32_32x32x16_bf16 v[16:31], v[68:71], v[64:67], v[16:31]
    s_barrier
    ds_read_b128 v[96:99], v4 offset:0
    ds_read_b64_tr_b16 v[100:101], v6 offset:6144
    ds_read_b64_tr_b16 v[102:103], v6 offset:6912
    ds_read_b64_tr_b16 v[104:105], v6 offset:6208
    v_mfma_f32_32x32x16_bf16 v[32:47], v[72:75], v[64:67], v[32:47]
    ds_read_b64_tr_b16 v[106:107], v6 offset:6976
    ds_read_b64_tr_b16 v[108:109], v6 offset:6272
    ds_read_b64_tr_b16 v[110:111], v6 offset:7040
    ds_read_b128 v[112:115], v5 offset:0
    v_mfma_f32_32x32x16_bf16 v[48:63], v[76:79], v[64:67], v[48:63]
    ds_read_b64_tr_b16 v[116:117], v6 offset:9216
    ds_read_b64_tr_b16 v[118:119], v6 offset:9984
    ds_read_b64_tr_b16 v[120:121], v6 offset:9280
    ds_read_b64_tr_b16 v[122:123], v6 offset:10048
    v_mfma_f32_32x32x16_bf16 v[16:31], v[84:87], v[80:83], v[16:31]
    ds_read_b64_tr_b16 v[124:125], v6 offset:9344
    ds_read_b64_tr_b16 v[126:127], v6 offset:10112
    v_mfma_f32_32x32x16_bf16 v[32:47], v[88:91], v[80:83], v[32:47]
    v_mfma_f32_32x32x16_bf16 v[48:63], v[92:95], v[80:83], v[48:63]
    s_waitcnt lgkmcnt(0)
    v_mfma_f32_32x32x16_bf16 v[16:31], v[100:103], v[96:99], v[16:31]
    s_barrier
    ds_read_b128 v[64:67], v2 offset:16384
    ds_read_b64_tr_b16 v[68:69], v6 offset:12288
    ds_read_b64_tr_b16 v[70:71], v6 offset:13056
    ds_read_b64_tr_b16 v[72:73], v6 offset:12352
    v_mfma_f32_32x32x16_bf16 v[32:47], v[104:107], v[96:99], v[32:47]
    ds_read_b64_tr_b16 v[74:75], v6 offset:13120
    ds_read_b64_tr_b16 v[76:77], v6 offset:12416
    ds_read_b64_tr_b16 v[78:79], v6 offset:13184
    ds_read_b128 v[80:83], v3 offset:16384
    v_mfma_f32_32x32x16_bf16 v[48:63], v[108:111], v[96:99], v[48:63]
    ds_read_b64_tr_b16 v[84:85], v6 offset:15360
    ds_read_b64_tr_b16 v[86:87], v6 offset:16128
    ds_read_b64_tr_b16 v[88:89], v6 offset:15424
    ds_read_b64_tr_b16 v[90:91], v6 offset:16192
    v_mfma_f32_32x32x16_bf16 v[16:31], v[116:119], v[112:115], v[16:31]
    ds_read_b64_tr_b16 v[92:93], v6 offset:15488
    ds_read_b64_tr_b16 v[94:95], v6 offset:16256
    v_mfma_f32_32x32x16_bf16 v[32:47], v[120:123], v[112:115], v[32:47]
    v_mfma_f32_32x32x16_bf16 v[48:63], v[124:127], v[112:115], v[48:63]
    s_waitcnt lgkmcnt(0)
    v_mfma_f32_32x32x16_bf16 v[16:31], v[68:71], v[64:67], v[16:31]
    s_barrier
    ds_read_b128 v[96:99], v4 offset:16384
    ds_read_b64_tr_b16 v[100:101], v6 offset:18432
    ds_read_b64_tr_b16 v[102:103], v6 offset:19200
    ds_read_b64_tr_b16 v[104:105], v6 offset:18496
    v_mfma_f32_32x32x16_bf16 v[32:47], v[72:75], v[64:67], v[32:47]
    ds_read_b64_tr_b16 v[106:107], v6 offset:19264
    ds_read_b64_tr_b16 v[108:109], v6 offset:18560
    ds_read_b64_tr_b16 v[110:111], v6 offset:19328
    ds_read_b128 v[112:115], v5 offset:16384
    v_mfma_f32_32x32x16_bf16 v[48:63], v[76:79], v[64:67], v[48:63]
    ds_read_b64_tr_b16 v[116:117], v6 offset:21504
    ds_read_b64_tr_b16 v[118:119], v6 offset:22272
    ds_read_b64_tr_b16 v[120:121], v6 offset:21568
    ds_read_b64_tr_b16 v[122:123], v6 offset:22336
    v_mfma_f32_32x32x16_bf16 v[16:31], v[84:87], v[80:83], v[16:31]
    ds_read_b64_tr_b16 v[124:125], v6 offset:21632
    ds_read_b64_tr_b16 v[126:127], v6 offset:22400
    v_mfma_f32_32x32x16_bf16 v[32:47], v[88:91], v[80:83], v[32:47]
    v_mfma_f32_32x32x16_bf16 v[48:63], v[92:95], v[80:83], v[48:63]
    s_waitcnt lgkmcnt(0)
    v_mfma_f32_32x32x16_bf16 v[16:31], v[100:103], v[96:99], v[16:31]
    s_barrier
    ds_read_b128 v[64:67], v2 offset:32768
    ds_read_b64_tr_b16 v[68:69], v6 offset:0
    ds_read_b64_tr_b16 v[70:71], v6 offset:768
    ds_read_b64_tr_b16 v[72:73], v6 offset:64
    v_mfma_f32_32x32x16_bf16 v[32:47], v[104:107], v[96:99], v[32:47]
    ds_read_b64_tr_b16 v[74:75], v6 offset:832
    ds_read_b64_tr_b16 v[76:77], v6 offset:128
    ds_read_b64_tr_b16 v[78:79], v6 offset:896
    ds_read_b128 v[80:83], v3 offset:32768
    v_mfma_f32_32x32x16_bf16 v[48:63], v[108:111], v[96:99], v[48:63]
    ds_read_b64_tr_b16 v[84:85], v6 offset:3072
    ds_read_b64_tr_b16 v[86:87], v6 offset:3840
    ds_read_b64_tr_b16 v[88:89], v6 offset:3136
    ds_read_b64_tr_b16 v[90:91], v6 offset:3904
    v_mfma_f32_32x32x16_bf16 v[16:31], v[116:119], v[112:115], v[16:31]
    ds_read_b64_tr_b16 v[92:93], v6 offset:3200
    ds_read_b64_tr_b16 v[94:95], v6 offset:3968
    v_mfma_f32_32x32x16_bf16 v[32:47], v[120:123], v[112:115], v[32:47]
    v_mfma_f32_32x32x16_bf16 v[48:63], v[124:127], v[112:115], v[48:63]
    s_waitcnt lgkmcnt(0)
    v_mfma_f32_32x32x16_bf16 v[16:31], v[68:71], v[64:67], v[16:31]
    s_barrier
    ds_read_b128 v[96:99], v4 offset:32768
    ds_read_b64_tr_b16 v[100:101], v6 offset:6144
    ds_read_b64_tr_b16 v[102:103], v6 offset:6912
    ds_read_b64_tr_b16 v[104:105], v6 offset:6208
    v_mfma_f32_32x32x16_bf16 v[32:47], v[72:75], v[64:67], v[32:47]
    ds_read_b64_tr_b16 v[106:107], v6 offset:6976
    ds_read_b64_tr_b16 v[108:109], v6 offset:6272
    ds_read_b64_tr_b16 v[110:111], v6 offset:7040
    ds_read_b128 v[112:115], v5 offset:32768
    v_mfma_f32_32x32x16_bf16 v[48:63], v[76:79], v[64:67], v[48:63]
    ds_read_b64_tr_b16 v[116:117], v6 offset:9216
    ds_read_b64_tr_b16 v[118:119], v6 offset:9984
    ds_read_b64_tr_b16 v[120:121], v6 offset:9280
    ds_read_b64_tr_b16 v[122:123], v6 offset:10048
    v_mfma_f32_32x32x16_bf16 v[16:31], v[84:87], v[80:83], v[16:31]
    ds_read_b64_tr_b16 v[124:125], v6 offset:9344
    ds_read_b64_tr_b16 v[126:127], v6 offset:10112
    v_mfma_f32_32x32x16_bf16 v[32:47], v[88:91], v[80:83], v[32:47]
    v_mfma_f32_32x32x16_bf16 v[48:63], v[92:95], v[80:83], v[48:63]
    s_waitcnt lgkmcnt(0)
    v_mfma_f32_32x32x16_bf16 v[16:31], v[100:103], v[96:99], v[16:31]
    s_barrier
    ds_read_b128 v[64:67], v2 offset:0
    ds_read_b64_tr_b16 v[68:69], v6 offset:12288
    ds_read_b64_tr_b16 v[70:71], v6 offset:13056
    ds_read_b64_tr_b16 v[72:73], v6 offset:12352
    v_mfma_f32_32x32x16_bf16 v[32:47], v[104:107], v[96:99], v[32:47]
    ds_read_b64_tr_b16 v[74:75], v6 offset:13120
    ds_read_b64_tr_b16 v[76:77], v6 offset:12416
    ds_read_b64_tr_b16 v[78:79], v6 offset:13184
    ds_read_b128 v[80:83], v3 offset:0
    v_mfma_f32_32x32x16_bf16 v[48:63], v[108:111], v[96:99], v[48:63]
    ds_read_b64_tr_b16 v[84:85], v6 offset:15360
    ds_read_b64_tr_b16 v[86:87], v6 offset:16128
    ds_read_b64_tr_b16 v[88:89], v6 offset:15424
    ds_read_b64_tr_b16 v[90:91], v6 offset:16192
    v_mfma_f32_32x32x16_bf16 v[16:31], v[116:119], v[112:115], v[16:31]
    ds_read_b64_tr_b16 v[92:93], v6 offset:15488
    ds_read_b64_tr_b16 v[94:95], v6 offset:16256
    v_mfma_f32_32x32x16_bf16 v[32:47], v[120:123], v[112:115], v[32:47]
    v_mfma_f32_32x32x16_bf16 v[48:63], v[124:127], v[112:115], v[48:63]
    s_waitcnt lgkmcnt(0)
    v_mfma_f32_32x32x16_bf16 v[16:31], v[68:71], v[64:67], v[16:31]
    s_barrier
    ds_read_b128 v[96:99], v4 offset:0
    ds_read_b64_tr_b16 v[100:101], v6 offset:18432
    ds_read_b64_tr_b16 v[102:103], v6 offset:19200
    ds_read_b64_tr_b16 v[104:105], v6 offset:18496
    v_mfma_f32_32x32x16_bf16 v[32:47], v[72:75], v[64:67], v[32:47]
    ds_read_b64_tr_b16 v[106:107], v6 offset:19264
    ds_read_b64_tr_b16 v[108:109], v6 offset:18560
    ds_read_b64_tr_b16 v[110:111], v6 offset:19328
    ds_read_b128 v[112:115], v5 offset:0
    v_mfma_f32_32x32x16_bf16 v[48:63], v[76:79], v[64:67], v[48:63]
    ds_read_b64_tr_b16 v[116:117], v6 offset:21504
    ds_read_b64_tr_b16 v[118:119], v6 offset:22272
    ds_read_b64_tr_b16 v[120:121], v6 offset:21568
    ds_read_b64_tr_b16 v[122:123], v6 offset:22336
    v_mfma_f32_32x32x16_bf16 v[16:31], v[84:87], v[80:83], v[16:31]
    ds_read_b64_tr_b16 v[124:125], v6 offset:21632
    ds_read_b64_tr_b16 v[126:127], v6 offset:22400
    v_mfma_f32_32x32x16_bf16 v[32:47], v[88:91], v[80:83], v[32:47]
    v_mfma_f32_32x32x16_bf16 v[48:63], v[92:95], v[80:83], v[48:63]
    s_waitcnt lgkmcnt(0)
    v_mfma_f32_32x32x16_bf16 v[16:31], v[100:103], v[96:99], v[16:31]
    v_mfma_f32_32x32x16_bf16 v[32:47], v[104:107], v[96:99], v[32:47]
    v_mfma_f32_32x32x16_bf16 v[48:63], v[108:111], v[96:99], v[48:63]
    v_mfma_f32_32x32x16_bf16 v[16:31], v[116:119], v[112:115], v[16:31]
    v_mfma_f32_32x32x16_bf16 v[32:47], v[120:123], v[112:115], v[32:47]
    v_mfma_f32_32x32x16_bf16 v[48:63], v[124:127], v[112:115], v[48:63]
    s_nop 15
    s_setprio 3
    s_mov_b32 s28, 0xbdd2d3e8
    s_mov_b32 s29, 0xbdd2d3e8
    s_mov_b32 s30, 1.0
    s_mov_b32 s31, 1.0
    v_mov_b32 v118, 0xc0135761
    v_mov_b32 v119, 0xc0135761
    s_lshl_b32 s26, s13, 7
    s_lshl_b32 s27, s12, 5
    s_add_u32 s26, s26, s27
    v_and_b32 v12, 15, v0
    v_add_u32 v12, s26, v12
    s_movk_i32 s27, 3072
    v_mul_lo_u32 v12, v12, s27
    s_mul_i32 s26, s14, 192
    s_add_u32 s26, s26, 0xd00000
    v_bfe_u32 v13, v0, 4, 1
    v_lshlrev_b32 v13, 5, v13
    v_lshl_add_u32 v13, v15, 4, v13
    v_add3_u32 v12, v12, v13, s26
    v_add_u32 v13, 49152, v12
    v_pk_mul_f32 v[120:121], v[16:17], v[16:17]
    v_pk_mul_f32 v[122:123], v[18:19], v[18:19]
    v_pk_fma_f32 v[120:121], v[120:121], s[28:29], v[118:119]
    v_pk_fma_f32 v[122:123], v[122:123], s[28:29], v[118:119]
    v_pk_mul_f32 v[120:121], v[120:121], v[16:17]
    v_pk_mul_f32 v[122:123], v[122:123], v[18:19]
    v_exp_f32 v120, v120
    v_exp_f32 v121, v121
    v_exp_f32 v122, v122
    v_exp_f32 v123, v123
    s_nop 0
    v_pk_add_f32 v[120:121], v[120:121], s[30:31]
    v_pk_add_f32 v[122:123], v[122:123], s[30:31]
    v_rcp_f32 v120, v120
    v_rcp_f32 v121, v121
    v_rcp_f32 v122, v122
    v_rcp_f32 v123, v123
    s_nop 0
    v_pk_mul_f32 v[16:17], v[16:17], v[120:121]
    v_pk_mul_f32 v[18:19], v[18:19], v[122:123]
    v_pk_mul_f32 v[120:121], v[20:21], v[20:21]
    v_pk_mul_f32 v[122:123], v[22:23], v[22:23]
    v_pk_fma_f32 v[120:121], v[120:121], s[28:29], v[118:119]
    v_pk_fma_f32 v[122:123], v[122:123], s[28:29], v[118:119]
    v_pk_mul_f32 v[120:121], v[120:121], v[20:21]
    v_pk_mul_f32 v[122:123], v[122:123], v[22:23]
    v_exp_f32 v120, v120
    v_exp_f32 v121, v121
    v_exp_f32 v122, v122
    v_exp_f32 v123, v123
    s_nop 0
    v_pk_add_f32 v[120:121], v[120:121], s[30:31]
    v_pk_add_f32 v[122:123], v[122:123], s[30:31]
    v_rcp_f32 v120, v120
    v_rcp_f32 v121, v121
    v_rcp_f32 v122, v122
    v_rcp_f32 v123, v123
    s_nop 0
    v_pk_mul_f32 v[20:21], v[20:21], v[120:121]
    v_pk_mul_f32 v[22:23], v[22:23], v[122:123]
    v_pk_mul_f32 v[120:121], v[24:25], v[24:25]
    v_pk_mul_f32 v[122:123], v[26:27], v[26:27]
    v_pk_fma_f32 v[120:121], v[120:121], s[28:29], v[118:119]
    v_pk_fma_f32 v[122:123], v[122:123], s[28:29], v[118:119]
    v_pk_mul_f32 v[120:121], v[120:121], v[24:25]
    v_pk_mul_f32 v[122:123], v[122:123], v[26:27]
    v_exp_f32 v120, v120
    v_exp_f32 v121, v121
    v_exp_f32 v122, v122
    v_exp_f32 v123, v123
    s_nop 0
    v_pk_add_f32 v[120:121], v[120:121], s[30:31]
    v_pk_add_f32 v[122:123], v[122:123], s[30:31]
    v_rcp_f32 v120, v120
    v_rcp_f32 v121, v121
    v_rcp_f32 v122, v122
    v_rcp_f32 v123, v123
    s_nop 0
    v_pk_mul_f32 v[24:25], v[24:25], v[120:121]
    v_pk_mul_f32 v[26:27], v[26:27], v[122:123]
    v_pk_mul_f32 v[120:121], v[28:29], v[28:29]
    v_pk_mul_f32 v[122:123], v[30:31], v[30:31]
    v_pk_fma_f32 v[120:121], v[120:121], s[28:29], v[118:119]
    v_pk_fma_f32 v[122:123], v[122:123], s[28:29], v[118:119]
    v_pk_mul_f32 v[120:121], v[120:121], v[28:29]
    v_pk_mul_f32 v[122:123], v[122:123], v[30:31]
    v_exp_f32 v120, v120
    v_exp_f32 v121, v121
    v_exp_f32 v122, v122
    v_exp_f32 v123, v123
    s_nop 0
    v_pk_add_f32 v[120:121], v[120:121], s[30:31]
    v_pk_add_f32 v[122:123], v[122:123], s[30:31]
    v_rcp_f32 v120, v120
    v_rcp_f32 v121, v121
    v_rcp_f32 v122, v122
    v_rcp_f32 v123, v123
    s_nop 0
    v_pk_mul_f32 v[28:29], v[28:29], v[120:121]
    v_pk_mul_f32 v[30:31], v[30:31], v[122:123]
    v_cvt_pk_bf16_f32 v64, v16, v17
    v_cvt_pk_bf16_f32 v65, v18, v19
    v_cvt_pk_bf16_f32 v66, v20, v21
    v_cvt_pk_bf16_f32 v67, v22, v23
    v_cvt_pk_bf16_f32 v68, v24, v25
    v_cvt_pk_bf16_f32 v69, v26, v27
    v_cvt_pk_bf16_f32 v70, v28, v29
    v_cvt_pk_bf16_f32 v71, v30, v31
    s_nop 1
    v_permlane16_swap_b32 v64, v68
    v_permlane16_swap_b32 v65, v69
    v_permlane16_swap_b32 v66, v70
    v_permlane16_swap_b32 v67, v71
    global_store_dwordx4 v12, v[64:67], s[10:11] offset:0 sc1
    global_store_dwordx4 v13, v[68:71], s[10:11] offset:0 sc1
    v_pk_mul_f32 v[120:121], v[32:33], v[32:33]
    v_pk_mul_f32 v[122:123], v[34:35], v[34:35]
    v_pk_fma_f32 v[120:121], v[120:121], s[28:29], v[118:119]
    v_pk_fma_f32 v[122:123], v[122:123], s[28:29], v[118:119]
    v_pk_mul_f32 v[120:121], v[120:121], v[32:33]
    v_pk_mul_f32 v[122:123], v[122:123], v[34:35]
    v_exp_f32 v120, v120
    v_exp_f32 v121, v121
    v_exp_f32 v122, v122
    v_exp_f32 v123, v123
    s_nop 0
    v_pk_add_f32 v[120:121], v[120:121], s[30:31]
    v_pk_add_f32 v[122:123], v[122:123], s[30:31]
    v_rcp_f32 v120, v120
    v_rcp_f32 v121, v121
    v_rcp_f32 v122, v122
    v_rcp_f32 v123, v123
    s_nop 0
    v_pk_mul_f32 v[32:33], v[32:33], v[120:121]
    v_pk_mul_f32 v[34:35], v[34:35], v[122:123]
    v_pk_mul_f32 v[120:121], v[36:37], v[36:37]
    v_pk_mul_f32 v[122:123], v[38:39], v[38:39]
    v_pk_fma_f32 v[120:121], v[120:121], s[28:29], v[118:119]
    v_pk_fma_f32 v[122:123], v[122:123], s[28:29], v[118:119]
    v_pk_mul_f32 v[120:121], v[120:121], v[36:37]
    v_pk_mul_f32 v[122:123], v[122:123], v[38:39]
    v_exp_f32 v120, v120
    v_exp_f32 v121, v121
    v_exp_f32 v122, v122
    v_exp_f32 v123, v123
    s_nop 0
    v_pk_add_f32 v[120:121], v[120:121], s[30:31]
    v_pk_add_f32 v[122:123], v[122:123], s[30:31]
    v_rcp_f32 v120, v120
    v_rcp_f32 v121, v121
    v_rcp_f32 v122, v122
    v_rcp_f32 v123, v123
    s_nop 0
    v_pk_mul_f32 v[36:37], v[36:37], v[120:121]
    v_pk_mul_f32 v[38:39], v[38:39], v[122:123]
    v_pk_mul_f32 v[120:121], v[40:41], v[40:41]
    v_pk_mul_f32 v[122:123], v[42:43], v[42:43]
    v_pk_fma_f32 v[120:121], v[120:121], s[28:29], v[118:119]
    v_pk_fma_f32 v[122:123], v[122:123], s[28:29], v[118:119]
    v_pk_mul_f32 v[120:121], v[120:121], v[40:41]
    v_pk_mul_f32 v[122:123], v[122:123], v[42:43]
    v_exp_f32 v120, v120
    v_exp_f32 v121, v121
    v_exp_f32 v122, v122
    v_exp_f32 v123, v123
    s_nop 0
    v_pk_add_f32 v[120:121], v[120:121], s[30:31]
    v_pk_add_f32 v[122:123], v[122:123], s[30:31]
    v_rcp_f32 v120, v120
    v_rcp_f32 v121, v121
    v_rcp_f32 v122, v122
    v_rcp_f32 v123, v123
    s_nop 0
    v_pk_mul_f32 v[40:41], v[40:41], v[120:121]
    v_pk_mul_f32 v[42:43], v[42:43], v[122:123]
    v_pk_mul_f32 v[120:121], v[44:45], v[44:45]
    v_pk_mul_f32 v[122:123], v[46:47], v[46:47]
    v_pk_fma_f32 v[120:121], v[120:121], s[28:29], v[118:119]
    v_pk_fma_f32 v[122:123], v[122:123], s[28:29], v[118:119]
    v_pk_mul_f32 v[120:121], v[120:121], v[44:45]
    v_pk_mul_f32 v[122:123], v[122:123], v[46:47]
    v_exp_f32 v120, v120
    v_exp_f32 v121, v121
    v_exp_f32 v122, v122
    v_exp_f32 v123, v123
    s_nop 0
    v_pk_add_f32 v[120:121], v[120:121], s[30:31]
    v_pk_add_f32 v[122:123], v[122:123], s[30:31]
    v_rcp_f32 v120, v120
    v_rcp_f32 v121, v121
    v_rcp_f32 v122, v122
    v_rcp_f32 v123, v123
    s_nop 0
    v_pk_mul_f32 v[44:45], v[44:45], v[120:121]
    v_pk_mul_f32 v[46:47], v[46:47], v[122:123]
    v_cvt_pk_bf16_f32 v72, v32, v33
    v_cvt_pk_bf16_f32 v73, v34, v35
    v_cvt_pk_bf16_f32 v74, v36, v37
    v_cvt_pk_bf16_f32 v75, v38, v39
    v_cvt_pk_bf16_f32 v76, v40, v41
    v_cvt_pk_bf16_f32 v77, v42, v43
    v_cvt_pk_bf16_f32 v78, v44, v45
    v_cvt_pk_bf16_f32 v79, v46, v47
    s_nop 1
    v_permlane16_swap_b32 v72, v76
    v_permlane16_swap_b32 v73, v77
    v_permlane16_swap_b32 v74, v78
    v_permlane16_swap_b32 v75, v79
    global_store_dwordx4 v12, v[72:75], s[10:11] offset:64 sc1
    global_store_dwordx4 v13, v[76:79], s[10:11] offset:64 sc1
    v_pk_mul_f32 v[120:121], v[48:49], v[48:49]
    v_pk_mul_f32 v[122:123], v[50:51], v[50:51]
    v_pk_fma_f32 v[120:121], v[120:121], s[28:29], v[118:119]
    v_pk_fma_f32 v[122:123], v[122:123], s[28:29], v[118:119]
    v_pk_mul_f32 v[120:121], v[120:121], v[48:49]
    v_pk_mul_f32 v[122:123], v[122:123], v[50:51]
    v_exp_f32 v120, v120
    v_exp_f32 v121, v121
    v_exp_f32 v122, v122
    v_exp_f32 v123, v123
    s_nop 0
    v_pk_add_f32 v[120:121], v[120:121], s[30:31]
    v_pk_add_f32 v[122:123], v[122:123], s[30:31]
    v_rcp_f32 v120, v120
    v_rcp_f32 v121, v121
    v_rcp_f32 v122, v122
    v_rcp_f32 v123, v123
    s_nop 0
    v_pk_mul_f32 v[48:49], v[48:49], v[120:121]
    v_pk_mul_f32 v[50:51], v[50:51], v[122:123]
    v_pk_mul_f32 v[120:121], v[52:53], v[52:53]
    v_pk_mul_f32 v[122:123], v[54:55], v[54:55]
    v_pk_fma_f32 v[120:121], v[120:121], s[28:29], v[118:119]
    v_pk_fma_f32 v[122:123], v[122:123], s[28:29], v[118:119]
    v_pk_mul_f32 v[120:121], v[120:121], v[52:53]
    v_pk_mul_f32 v[122:123], v[122:123], v[54:55]
    v_exp_f32 v120, v120
    v_exp_f32 v121, v121
    v_exp_f32 v122, v122
    v_exp_f32 v123, v123
    s_nop 0
    v_pk_add_f32 v[120:121], v[120:121], s[30:31]
    v_pk_add_f32 v[122:123], v[122:123], s[30:31]
    v_rcp_f32 v120, v120
    v_rcp_f32 v121, v121
    v_rcp_f32 v122, v122
    v_rcp_f32 v123, v123
    s_nop 0
    v_pk_mul_f32 v[52:53], v[52:53], v[120:121]
    v_pk_mul_f32 v[54:55], v[54:55], v[122:123]
    v_pk_mul_f32 v[120:121], v[56:57], v[56:57]
    v_pk_mul_f32 v[122:123], v[58:59], v[58:59]
    v_pk_fma_f32 v[120:121], v[120:121], s[28:29], v[118:119]
    v_pk_fma_f32 v[122:123], v[122:123], s[28:29], v[118:119]
    v_pk_mul_f32 v[120:121], v[120:121], v[56:57]
    v_pk_mul_f32 v[122:123], v[122:123], v[58:59]
    v_exp_f32 v120, v120
    v_exp_f32 v121, v121
    v_exp_f32 v122, v122
    v_exp_f32 v123, v123
    s_nop 0
    v_pk_add_f32 v[120:121], v[120:121], s[30:31]
    v_pk_add_f32 v[122:123], v[122:123], s[30:31]
    v_rcp_f32 v120, v120
    v_rcp_f32 v121, v121
    v_rcp_f32 v122, v122
    v_rcp_f32 v123, v123
    s_nop 0
    v_pk_mul_f32 v[56:57], v[56:57], v[120:121]
    v_pk_mul_f32 v[58:59], v[58:59], v[122:123]
    v_pk_mul_f32 v[120:121], v[60:61], v[60:61]
    v_pk_mul_f32 v[122:123], v[62:63], v[62:63]
    v_pk_fma_f32 v[120:121], v[120:121], s[28:29], v[118:119]
    v_pk_fma_f32 v[122:123], v[122:123], s[28:29], v[118:119]
    v_pk_mul_f32 v[120:121], v[120:121], v[60:61]
    v_pk_mul_f32 v[122:123], v[122:123], v[62:63]
    v_exp_f32 v120, v120
    v_exp_f32 v121, v121
    v_exp_f32 v122, v122
    v_exp_f32 v123, v123
    s_nop 0
    v_pk_add_f32 v[120:121], v[120:121], s[30:31]
    v_pk_add_f32 v[122:123], v[122:123], s[30:31]
    v_rcp_f32 v120, v120
    v_rcp_f32 v121, v121
    v_rcp_f32 v122, v122
    v_rcp_f32 v123, v123
    s_nop 0
    v_pk_mul_f32 v[60:61], v[60:61], v[120:121]
    v_pk_mul_f32 v[62:63], v[62:63], v[122:123]
    v_cvt_pk_bf16_f32 v80, v48, v49
    v_cvt_pk_bf16_f32 v81, v50, v51
    v_cvt_pk_bf16_f32 v82, v52, v53
    v_cvt_pk_bf16_f32 v83, v54, v55
    v_cvt_pk_bf16_f32 v84, v56, v57
    v_cvt_pk_bf16_f32 v85, v58, v59
    v_cvt_pk_bf16_f32 v86, v60, v61
    v_cvt_pk_bf16_f32 v87, v62, v63
    s_nop 1
    v_permlane16_swap_b32 v80, v84
    v_permlane16_swap_b32 v81, v85
    v_permlane16_swap_b32 v82, v86
    v_permlane16_swap_b32 v83, v87
    global_store_dwordx4 v12, v[80:83], s[10:11] offset:128 sc1
    global_store_dwordx4 v13, v[84:87], s[10:11] offset:128 sc1
    s_branch pk_m1_mlp1_done
pk_m1_loader:
    s_sub_u32 s12, s12, 4
    s_add_u32 s16, s10, 0x900000
    s_addc_u32 s17, s11, 0
    s_mov_b32 s18, 2621440
    s_mov_b32 s19, 0x20000
    s_mov_b32 s20, s4
    s_mov_b32 s21, s5
    s_mov_b32 s22, 1966080
    s_mov_b32 s23, 0x20000
    v_lshrrev_b32 v14, 3, v0
    v_mul_u32_u24 v14, 1280, v14
    v_lshrrev_b32 v15, 4, v0
    v_and_b32 v21, 7, v0
    v_add_u32 v22, 0, v15
    v_and_b32 v22, 7, v22
    v_xor_b32 v22, v21, v22
    v_lshl_add_u32 v2, v22, 4, v14
    v_add_u32 v22, 4, v15
    v_and_b32 v22, 7, v22
    v_xor_b32 v22, v21, v22
    v_lshl_add_u32 v3, v22, 4, v14
    v_add_u32 v3, 9216, v3
    v_add_u32 v22, 8, v15
    v_and_b32 v22, 7, v22
    v_xor_b32 v22, v21, v22
    v_lshl_add_u32 v4, v22, 4, v14
    v_add_u32 v4, 18432, v4
    v_add_u32 v22, 12, v15
    v_and_b32 v22, 7, v22
    v_xor_b32 v22, v21, v22
    v_lshl_add_u32 v5, v22, 4, v14
    v_add_u32 v5, 27648, v5
    s_mov_b32 s27, 43691
    s_add_u32 s28, s12, 0
    s_lshl_b32 s28, s28, 6
    v_add_u32 v21, s28, v0
    v_mul_lo_u32 v22, v21, s27
    v_lshrrev_b32 v22, 19, v22
    v_mul_u32_u24 v23, 12, v22
    v_sub_u32 v21, v21, v23
    v_mul_u32_u24 v22, 3072, v22
    v_lshl_add_u32 v6, v21, 4, v22
    s_add_u32 s28, s12, 4
    s_lshl_b32 s28, s28, 6
    v_add_u32 v21, s28, v0
    v_mul_lo_u32 v22, v21, s27
    v_lshrrev_b32 v22, 19, v22
    v_mul_u32_u24 v23, 12, v22
    v_sub_u32 v21, v21, v23
    v_mul_u32_u24 v22, 3072, v22
    v_lshl_add_u32 v7, v21, 4, v22
    s_lshl_b32 s30, s13, 7
    s_lshl_b32 s26, s12, 5
    s_add_u32 s30, s30, s26
    s_mul_i32 s30, s30, 1280
    s_mul_i32 s31, s14, 192
    s_lshl_b32 s32, s12, 12
    s_lshl_b32 s33, s12, 10
    s_lshr_b32 s34, s96, 3
    s_and_b32 s35, s34, 3
    s_lshr_b32 s34, s34, 2
    s_mul_i32 s35, s35, 3
    s_add_u32 s34, s34, s35
    s_cmp_ge_u32 s34, 10
    s_cselect_b32 s35, 10, 0
    s_sub_u32 s34, s34, s35
    s_lshl_b32 s35, s34, 7
    s_add_u32 s36, s30, 1280
    s_add_u32 s30, s30, s35
    s_mul_i32 s35, s34, 196608
    s_add_u32 s37, s31, 1966080
    s_add_u32 s31, s31, s35
    s_setprio 0
    s_cmp_lt_u32 s12, 2
    s_cbranch_scc0 pk_m1_loaderB
    s_add_u32 m0, s32, 0
    s_nop 0
    buffer_load_dwordx4 v2, s[16:19], s30 offen offset:0 sc1 lds
    buffer_load_dwordx4 v3, s[16:19], s30 offen offset:1024 sc1 lds
    buffer_load_dwordx4 v4, s[16:19], s30 offen offset:2048 sc1 lds
    buffer_load_dwordx4 v5, s[16:19], s30 offen offset:3072 sc1 lds
    s_add_u32 s30, s30, 128
    s_cmp_ge_u32 s30, s36
    s_cselect_b32 s35, 1280, 0
    s_sub_u32 s30, s30, s35
    s_add_u32 m0, s33, 49152
    s_nop 0
    buffer_load_dwordx4 v6, s[20:23], s31 offen lds
    s_add_u32 m0, s33, 53248
    s_nop 0
    buffer_load_dwordx4 v7, s[20:23], s31 offen lds
    s_add_u32 s31, s31, 98304
    s_cmp_ge_u32 s31, s37
    s_cselect_b32 s35, 1966080, 0
    s_sub_u32 s31, s31, s35
    s_add_u32 m0, s33, 55296
    s_nop 0
    buffer_load_dwordx4 v6, s[20:23], s31 offen lds
    s_add_u32 m0, s33, 59392
    s_nop 0
    buffer_load_dwordx4 v7, s[20:23], s31 offen lds
    s_add_u32 s31, s31, 98304
    s_cmp_ge_u32 s31, s37
    s_cselect_b32 s35, 1966080, 0
    s_sub_u32 s31, s31, s35
    s_barrier
    s_cmp_lg_u32 s97, 4
    s_cbranch_scc1 qsig_35
    s_cmp_ge_u32 s14, 15
    s_cbranch_scc1 qsig2_36
    v_mov_b32 v20, v2
    v_mov_b32 v21, v3
    s_lshl_b32 s56, s14, 7
    s_lshl_b32 s57, s13, 2
    s_add_u32 s56, s56, s57
    s_add_u32 s56, s56, 0x1f00800
    v_mov_b32 v2, s56
    v_mov_b32 v3, s100
    s_mov_b64 exec, 1
    global_store_dword v2, v3, s[10:11] sc1
    s_mov_b64 exec, -1
    v_mov_b32 v2, v20
    v_mov_b32 v3, v21
qsig2_36:
    s_lshl_b32 s56, s96, 7
    s_add_u32 s56, s56, 0x1f08000
    v_mov_b32 v22, s56
    v_mov_b32 v23, s100
    s_mov_b64 exec, 1
    global_store_dword v22, v23, s[10:11]
    s_mov_b64 exec, -1
qsig_35:
    s_waitcnt vmcnt(2)
    s_barrier
    s_add_u32 m0, s32, 16384
    s_nop 0
    buffer_load_dwordx4 v2, s[16:19], s30 offen offset:0 sc1 lds
    buffer_load_dwordx4 v3, s[16:19], s30 offen offset:1024 sc1 lds
    buffer_load_dwordx4 v4, s[16:19], s30 offen offset:2048 sc1 lds
    buffer_load_dwordx4 v5, s[16:19], s30 offen offset:3072 sc1 lds
    s_add_u32 s30, s30, 128
    s_cmp_ge_u32 s30, s36
    s_cselect_b32 s35, 1280, 0
    s_sub_u32 s30, s30, s35
    s_add_u32 m0, s33, 61440
    s_nop 0
    buffer_load_dwordx4 v6, s[20:23], s31 offen lds
    s_add_u32 m0, s33, 65536
    s_nop 0
    buffer_load_dwordx4 v7, s[20:23], s31 offen lds
    s_add_u32 s31, s31, 98304
    s_cmp_ge_u32 s31, s37
    s_cselect_b32 s35, 1966080, 0
    s_sub_u32 s31, s31, s35
    s_add_u32 m0, s33, 67584
    s_nop 0
    buffer_load_dwordx4 v6, s[20:23], s31 offen lds
    s_add_u32 m0, s33, 71680
    s_nop 0
    buffer_load_dwordx4 v7, s[20:23], s31 offen lds
    s_add_u32 s31, s31, 98304
    s_cmp_ge_u32 s31, s37
    s_cselect_b32 s35, 1966080, 0
    s_sub_u32 s31, s31, s35
    s_add_u32 m0, s32, 32768
    s_nop 0
    buffer_load_dwordx4 v2, s[16:19], s30 offen offset:0 sc1 lds
    buffer_load_dwordx4 v3, s[16:19], s30 offen offset:1024 sc1 lds
    buffer_load_dwordx4 v4, s[16:19], s30 offen offset:2048 sc1 lds
    buffer_load_dwordx4 v5, s[16:19], s30 offen offset:3072 sc1 lds
    s_add_u32 s30, s30, 128
    s_cmp_ge_u32 s30, s36
    s_cselect_b32 s35, 1280, 0
    s_sub_u32 s30, s30, s35
    s_waitcnt vmcnt(12)
    s_barrier
    s_add_u32 m0, s33, 49152
    s_nop 0
    buffer_load_dwordx4 v6, s[20:23], s31 offen lds
    s_add_u32 m0, s33, 53248
    s_nop 0
    buffer_load_dwordx4 v7, s[20:23], s31 offen lds
    s_add_u32 s31, s31, 98304
    s_cmp_ge_u32 s31, s37
    s_cselect_b32 s35, 1966080, 0
    s_sub_u32 s31, s31, s35
    s_waitcnt vmcnt(8)
    s_barrier
    s_add_u32 m0, s33, 55296
    s_nop 0
    buffer_load_dwordx4 v6, s[20:23], s31 offen lds
    s_add_u32 m0, s33, 59392
    s_nop 0
    buffer_load_dwordx4 v7, s[20:23], s31 offen lds
    s_add_u32 s31, s31, 98304
    s_cmp_ge_u32 s31, s37
    s_cselect_b32 s35, 1966080, 0
    s_sub_u32 s31, s31, s35
    s_add_u32 m0, s32, 0
    s_nop 0
    buffer_load_dwordx4 v2, s[16:19], s30 offen offset:0 sc1 lds
    buffer_load_dwordx4 v3, s[16:19], s30 offen offset:1024 sc1 lds
    buffer_load_dwordx4 v4, s[16:19], s30 offen offset:2048 sc1 lds
    buffer_load_dwordx4 v5, s[16:19], s30 offen offset:3072 sc1 lds
    s_add_u32 s30, s30, 128
    s_cmp_ge_u32 s30, s36
    s_cselect_b32 s35, 1280, 0
    s_sub_u32 s30, s30, s35
    s_waitcnt vmcnt(12)
    s_barrier
    s_add_u32 m0, s33, 61440
    s_nop 0
    buffer_load_dwordx4 v6, s[20:23], s31 offen lds
    s_add_u32 m0, s33, 65536
    s_nop 0
    buffer_load_dwordx4 v7, s[20:23], s31 offen lds
    s_add_u32 s31, s31, 98304
    s_cmp_ge_u32 s31, s37
    s_cselect_b32 s35, 1966080, 0
    s_sub_u32 s31, s31, s35
    s_waitcnt vmcnt(8)
    s_barrier
    s_add_u32 m0, s33, 67584
    s_nop 0
    buffer_load_dwordx4 v6, s[20:23], s31 offen lds
    s_add_u32 m0, s33, 71680
    s_nop 0
    buffer_load_dwordx4 v7, s[20:23], s31 offen lds
    s_add_u32 s31, s31, 98304
    s_cmp_ge_u32 s31, s37
    s_cselect_b32 s35, 1966080, 0
    s_sub_u32 s31, s31, s35
    s_add_u32 m0, s32, 16384
    s_nop 0
    buffer_load_dwordx4 v2, s[16:19], s30 offen offset:0 sc1 lds
    buffer_load_dwordx4 v3, s[16:19], s30 offen offset:1024 sc1 lds
    buffer_load_dwordx4 v4, s[16:19], s30 offen offset:2048 sc1 lds
    buffer_load_dwordx4 v5, s[16:19], s30 offen offset:3072 sc1 lds
    s_add_u32 s30, s30, 128
    s_cmp_ge_u32 s30, s36
    s_cselect_b32 s35, 1280, 0
    s_sub_u32 s30, s30, s35
    s_waitcnt vmcnt(12)
    s_barrier
    s_add_u32 m0, s33, 49152
    s_nop 0
    buffer_load_dwordx4 v6, s[20:23], s31 offen lds
    s_add_u32 m0, s33, 53248
    s_nop 0
    buffer_load_dwordx4 v7, s[20:23], s31 offen lds
    s_add_u32 s31, s31, 98304
    s_cmp_ge_u32 s31, s37
    s_cselect_b32 s35, 1966080, 0
    s_sub_u32 s31, s31, s35
    s_waitcnt vmcnt(8)
    s_barrier
    s_add_u32 m0, s33, 55296
    s_nop 0
    buffer_load_dwordx4 v6, s[20:23], s31 offen lds
    s_add_u32 m0, s33, 59392
    s_nop 0
    buffer_load_dwordx4 v7, s[20:23], s31 offen lds
    s_add_u32 s31, s31, 98304
    s_cmp_ge_u32 s31, s37
    s_cselect_b32 s35, 1966080, 0
    s_sub_u32 s31, s31, s35
    s_add_u32 m0, s32, 32768
    s_nop 0
    buffer_load_dwordx4 v2, s[16:19], s30 offen offset:0 sc1 lds
    buffer_load_dwordx4 v3, s[16:19], s30 offen offset:1024 sc1 lds
    buffer_load_dwordx4 v4, s[16:19], s30 offen offset:2048 sc1 lds
    buffer_load_dwordx4 v5, s[16:19], s30 offen offset:3072 sc1 lds
    s_add_u32 s30, s30, 128
    s_cmp_ge_u32 s30, s36
    s_cselect_b32 s35, 1280, 0
    s_sub_u32 s30, s30, s35
    s_waitcnt vmcnt(12)
    s_barrier
    s_add_u32 m0, s33, 61440
    s_nop 0
    buffer_load_dwordx4 v6, s[20:23], s31 offen lds
    s_add_u32 m0, s33, 65536
    s_nop 0
    buffer_load_dwordx4 v7, s[20:23], s31 offen lds
    s_add_u32 s31, s31, 98304
    s_cmp_ge_u32 s31, s37
    s_cselect_b32 s35, 1966080, 0
    s_sub_u32 s31, s31, s35
    s_waitcnt vmcnt(8)
    s_barrier
    s_add_u32 m0, s33, 67584
    s_nop 0
    buffer_load_dwordx4 v6, s[20:23], s31 offen lds
    s_add_u32 m0, s33, 71680
    s_nop 0
    buffer_load_dwordx4 v7, s[20:23], s31 offen lds
    s_add_u32 s31, s31, 98304
    s_cmp_ge_u32 s31, s37
    s_cselect_b32 s35, 1966080, 0
    s_sub_u32 s31, s31, s35
    s_add_u32 m0, s32, 0
    s_nop 0
    buffer_load_dwordx4 v2, s[16:19], s30 offen offset:0 sc1 lds
    buffer_load_dwordx4 v3, s[16:19], s30 offen offset:1024 sc1 lds
    buffer_load_dwordx4 v4, s[16:19], s30 offen offset:2048 sc1 lds
    buffer_load_dwordx4 v5, s[16:19], s30 offen offset:3072 sc1 lds
    s_add_u32 s30, s30, 128
    s_cmp_ge_u32 s30, s36
    s_cselect_b32 s35, 1280, 0
    s_sub_u32 s30, s30, s35
    s_waitcnt vmcnt(12)
    s_barrier
    s_add_u32 m0, s33, 49152
    s_nop 0
    buffer_load_dwordx4 v6, s[20:23], s31 offen lds
    s_add_u32 m0, s33, 53248
    s_nop 0
    buffer_load_dwordx4 v7, s[20:23], s31 offen lds
    s_add_u32 s31, s31, 98304
    s_cmp_ge_u32 s31, s37
    s_cselect_b32 s35, 1966080, 0
    s_sub_u32 s31, s31, s35
    s_waitcnt vmcnt(8)
    s_barrier
    s_add_u32 m0, s33, 55296
    s_nop 0
    buffer_load_dwordx4 v6, s[20:23], s31 offen lds
    s_add_u32 m0, s33, 59392
    s_nop 0
    buffer_load_dwordx4 v7, s[20:23], s31 offen lds
    s_add_u32 s31, s31, 98304
    s_cmp_ge_u32 s31, s37
    s_cselect_b32 s35, 1966080, 0
    s_sub_u32 s31, s31, s35
    s_add_u32 m0, s32, 16384
    s_nop 0
    buffer_load_dwordx4 v2, s[16:19], s30 offen offset:0 sc1 lds
    buffer_load_dwordx4 v3, s[16:19], s30 offen offset:1024 sc1 lds
    buffer_load_dwordx4 v4, s[16:19], s30 offen offset:2048 sc1 lds
    buffer_load_dwordx4 v5, s[16:19], s30 offen offset:3072 sc1 lds
    s_add_u32 s30, s30, 128
    s_cmp_ge_u32 s30, s36
    s_cselect_b32 s35, 1280, 0
    s_sub_u32 s30, s30, s35
    s_waitcnt vmcnt(12)
    s_barrier
    s_add_u32 m0, s33, 61440
    s_nop 0
    buffer_load_dwordx4 v6, s[20:23], s31 offen lds
    s_add_u32 m0, s33, 65536
    s_nop 0
    buffer_load_dwordx4 v7, s[20:23], s31 offen lds
    s_add_u32 s31, s31, 98304
    s_cmp_ge_u32 s31, s37
    s_cselect_b32 s35, 1966080, 0
    s_sub_u32 s31, s31, s35
    s_waitcnt vmcnt(8)
    s_barrier
    s_add_u32 m0, s33, 67584
    s_nop 0
    buffer_load_dwordx4 v6, s[20:23], s31 offen lds
    s_add_u32 m0, s33, 71680
    s_nop 0
    buffer_load_dwordx4 v7, s[20:23], s31 offen lds
    s_add_u32 s31, s31, 98304
    s_cmp_ge_u32 s31, s37
    s_cselect_b32 s35, 1966080, 0
    s_sub_u32 s31, s31, s35
    s_add_u32 m0, s32, 32768
    s_nop 0
    buffer_load_dwordx4 v2, s[16:19], s30 offen offset:0 sc1 lds
    buffer_load_dwordx4 v3, s[16:19], s30 offen offset:1024 sc1 lds
    buffer_load_dwordx4 v4, s[16:19], s30 offen offset:2048 sc1 lds
    buffer_load_dwordx4 v5, s[16:19], s30 offen offset:3072 sc1 lds
    s_add_u32 s30, s30, 128
    s_cmp_ge_u32 s30, s36
    s_cselect_b32 s35, 1280, 0
    s_sub_u32 s30, s30, s35
    s_waitcnt vmcnt(12)
    s_barrier
    s_add_u32 m0, s33, 49152
    s_nop 0
    buffer_load_dwordx4 v6, s[20:23], s31 offen lds
    s_add_u32 m0, s33, 53248
    s_nop 0
    buffer_load_dwordx4 v7, s[20:23], s31 offen lds
    s_add_u32 s31, s31, 98304
    s_cmp_ge_u32 s31, s37
    s_cselect_b32 s35, 1966080, 0
    s_sub_u32 s31, s31, s35
    s_waitcnt vmcnt(8)
    s_barrier
    s_add_u32 m0, s33, 55296
    s_nop 0
    buffer_load_dwordx4 v6, s[20:23], s31 offen lds
    s_add_u32 m0, s33, 59392
    s_nop 0
    buffer_load_dwordx4 v7, s[20:23], s31 offen lds
    s_add_u32 s31, s31, 98304
    s_cmp_ge_u32 s31, s37
    s_cselect_b32 s35, 1966080, 0
    s_sub_u32 s31, s31, s35
    s_add_u32 m0, s32, 0
    s_nop 0
    buffer_load_dwordx4 v2, s[16:19], s30 offen offset:0 sc1 lds
    buffer_load_dwordx4 v3, s[16:19], s30 offen offset:1024 sc1 lds
    buffer_load_dwordx4 v4, s[16:19], s30 offen offset:2048 sc1 lds
    buffer_load_dwordx4 v5, s[16:19], s30 offen offset:3072 sc1 lds
    s_add_u32 s30, s30, 128
    s_cmp_ge_u32 s30, s36
    s_cselect_b32 s35, 1280, 0
    s_sub_u32 s30, s30, s35
    s_waitcnt vmcnt(12)
    s_barrier
    s_add_u32 m0, s33, 61440
    s_nop 0
    buffer_load_dwordx4 v6, s[20:23], s31 offen lds
    s_add_u32 m0, s33, 65536
    s_nop 0
    buffer_load_dwordx4 v7, s[20:23], s31 offen lds
    s_add_u32 s31, s31, 98304
    s_cmp_ge_u32 s31, s37
    s_cselect_b32 s35, 1966080, 0
    s_sub_u32 s31, s31, s35
    s_waitcnt vmcnt(8)
    s_barrier
    s_add_u32 m0, s33, 67584
    s_nop 0
    buffer_load_dwordx4 v6, s[20:23], s31 offen lds
    s_add_u32 m0, s33, 71680
    s_nop 0
    buffer_load_dwordx4 v7, s[20:23], s31 offen lds
    s_add_u32 s31, s31, 98304
    s_cmp_ge_u32 s31, s37
    s_cselect_b32 s35, 1966080, 0
    s_sub_u32 s31, s31, s35
    s_waitcnt vmcnt(8)
    s_barrier
    s_waitcnt vmcnt(2)
    s_barrier
    s_waitcnt vmcnt(0)
    s_barrier
    s_branch pk_m1_loader_end
pk_m1_loaderB:
    s_add_u32 m0, s32, 0
    s_nop 0
    buffer_load_dwordx4 v2, s[16:19], s30 offen offset:0 sc1 lds
    buffer_load_dwordx4 v3, s[16:19], s30 offen offset:1024 sc1 lds
    buffer_load_dwordx4 v4, s[16:19], s30 offen offset:2048 sc1 lds
    buffer_load_dwordx4 v5, s[16:19], s30 offen offset:3072 sc1 lds
    s_add_u32 s30, s30, 128
    s_cmp_ge_u32 s30, s36
    s_cselect_b32 s35, 1280, 0
    s_sub_u32 s30, s30, s35
    s_add_u32 m0, s33, 49152
    s_nop 0
    buffer_load_dwordx4 v6, s[20:23], s31 offen lds
    s_add_u32 s31, s31, 98304
    s_cmp_ge_u32 s31, s37
    s_cselect_b32 s35, 1966080, 0
    s_sub_u32 s31, s31, s35
    s_add_u32 m0, s33, 55296
    s_nop 0
    buffer_load_dwordx4 v6, s[20:23], s31 offen lds
    s_add_u32 s31, s31, 98304
    s_cmp_ge_u32 s31, s37
    s_cselect_b32 s35, 1966080, 0
    s_sub_u32 s31, s31, s35
    s_barrier
    s_cmp_lg_u32 s97, 4
    s_cbranch_scc1 qsig_37
    s_cmp_ge_u32 s14, 15
    s_cbranch_scc1 qsig2_38
    v_mov_b32 v20, v2
    v_mov_b32 v21, v3
    s_lshl_b32 s56, s14, 7
    s_lshl_b32 s57, s13, 2
    s_add_u32 s56, s56, s57
    s_add_u32 s56, s56, 0x1f00800
    v_mov_b32 v2, s56
    v_mov_b32 v3, s100
    s_mov_b64 exec, 1
    global_store_dword v2, v3, s[10:11] sc1
    s_mov_b64 exec, -1
    v_mov_b32 v2, v20
    v_mov_b32 v3, v21
qsig2_38:
    s_lshl_b32 s56, s96, 7
    s_add_u32 s56, s56, 0x1f08000
    v_mov_b32 v22, s56
    v_mov_b32 v23, s100
    s_mov_b64 exec, 1
    global_store_dword v22, v23, s[10:11]
    s_mov_b64 exec, -1
qsig_37:
    s_waitcnt vmcnt(1)
    s_barrier
    s_add_u32 m0, s32, 16384
    s_nop 0
    buffer_load_dwordx4 v2, s[16:19], s30 offen offset:0 sc1 lds
    buffer_load_dwordx4 v3, s[16:19], s30 offen offset:1024 sc1 lds
    buffer_load_dwordx4 v4, s[16:19], s30 offen offset:2048 sc1 lds
    buffer_load_dwordx4 v5, s[16:19], s30 offen offset:3072 sc1 lds
    s_add_u32 s30, s30, 128
    s_cmp_ge_u32 s30, s36
    s_cselect_b32 s35, 1280, 0
    s_sub_u32 s30, s30, s35
    s_add_u32 m0, s33, 61440
    s_nop 0
    buffer_load_dwordx4 v6, s[20:23], s31 offen lds
    s_add_u32 s31, s31, 98304
    s_cmp_ge_u32 s31, s37
    s_cselect_b32 s35, 1966080, 0
    s_sub_u32 s31, s31, s35
    s_add_u32 m0, s33, 67584
    s_nop 0
    buffer_load_dwordx4 v6, s[20:23], s31 offen lds
    s_add_u32 s31, s31, 98304
    s_cmp_ge_u32 s31, s37
    s_cselect_b32 s35, 1966080, 0
    s_sub_u32 s31, s31, s35
    s_add_u32 m0, s32, 32768
    s_nop 0
    buffer_load_dwordx4 v2, s[16:19], s30 offen offset:0 sc1 lds
    buffer_load_dwordx4 v3, s[16:19], s30 offen offset:1024 sc1 lds
    buffer_load_dwordx4 v4, s[16:19], s30 offen offset:2048 sc1 lds
    buffer_load_dwordx4 v5, s[16:19], s30 offen offset:3072 sc1 lds
    s_add_u32 s30, s30, 128
    s_cmp_ge_u32 s30, s36
    s_cselect_b32 s35, 1280, 0
    s_sub_u32 s30, s30, s35
    s_waitcnt vmcnt(10)
    s_barrier
    s_add_u32 m0, s33, 49152
    s_nop 0
    buffer_load_dwordx4 v6, s[20:23], s31 offen lds
    s_add_u32 s31, s31, 98304
    s_cmp_ge_u32 s31, s37
    s_cselect_b32 s35, 1966080, 0
    s_sub_u32 s31, s31, s35
    s_waitcnt vmcnt(6)
    s_barrier
    s_add_u32 m0, s33, 55296
    s_nop 0
    buffer_load_dwordx4 v6, s[20:23], s31 offen lds
    s_add_u32 s31, s31, 98304
    s_cmp_ge_u32 s31, s37
    s_cselect_b32 s35, 1966080, 0
    s_sub_u32 s31, s31, s35
    s_add_u32 m0, s32, 0
    s_nop 0
    buffer_load_dwordx4 v2, s[16:19], s30 offen offset:0 sc1 lds
    buffer_load_dwordx4 v3, s[16:19], s30 offen offset:1024 sc1 lds
    buffer_load_dwordx4 v4, s[16:19], s30 offen offset:2048 sc1 lds
    buffer_load_dwordx4 v5, s[16:19], s30 offen offset:3072 sc1 lds
    s_add_u32 s30, s30, 128
    s_cmp_ge_u32 s30, s36
    s_cselect_b32 s35, 1280, 0
    s_sub_u32 s30, s30, s35
    s_waitcnt vmcnt(10)
    s_barrier
    s_add_u32 m0, s33, 61440
    s_nop 0
    buffer_load_dwordx4 v6, s[20:23], s31 offen lds
    s_add_u32 s31, s31, 98304
    s_cmp_ge_u32 s31, s37
    s_cselect_b32 s35, 1966080, 0
    s_sub_u32 s31, s31, s35
    s_waitcnt vmcnt(6)
    s_barrier
    s_add_u32 m0, s33, 67584
    s_nop 0
    buffer_load_dwordx4 v6, s[20:23], s31 offen lds
    s_add_u32 s31, s31, 98304
    s_cmp_ge_u32 s31, s37
    s_cselect_b32 s35, 1966080, 0
    s_sub_u32 s31, s31, s35
    s_add_u32 m0, s32, 16384
    s_nop 0
    buffer_load_dwordx4 v2, s[16:19], s30 offen offset:0 sc1 lds
    buffer_load_dwordx4 v3, s[16:19], s30 offen offset:1024 sc1 lds
    buffer_load_dwordx4 v4, s[16:19], s30 offen offset:2048 sc1 lds
    buffer_load_dwordx4 v5, s[16:19], s30 offen offset:3072 sc1 lds
    s_add_u32 s30, s30, 128
    s_cmp_ge_u32 s30, s36
    s_cselect_b32 s35, 1280, 0
    s_sub_u32 s30, s30, s35
    s_waitcnt vmcnt(10)
    s_barrier
    s_add_u32 m0, s33, 49152
    s_nop 0
    buffer_load_dwordx4 v6, s[20:23], s31 offen lds
    s_add_u32 s31, s31, 98304
    s_cmp_ge_u32 s31, s37
    s_cselect_b32 s35, 1966080, 0
    s_sub_u32 s31, s31, s35
    s_waitcnt vmcnt(6)
    s_barrier
    s_add_u32 m0, s33, 55296
    s_nop 0
    buffer_load_dwordx4 v6, s[20:23], s31 offen lds
    s_add_u32 s31, s31, 98304
    s_cmp_ge_u32 s31, s37
    s_cselect_b32 s35, 1966080, 0
    s_sub_u32 s31, s31, s35
    s_add_u32 m0, s32, 32768
    s_nop 0
    buffer_load_dwordx4 v2, s[16:19], s30 offen offset:0 sc1 lds
    buffer_load_dwordx4 v3, s[16:19], s30 offen offset:1024 sc1 lds
    buffer_load_dwordx4 v4, s[16:19], s30 offen offset:2048 sc1 lds
    buffer_load_dwordx4 v5, s[16:19], s30 offen offset:3072 sc1 lds
    s_add_u32 s30, s30, 128
    s_cmp_ge_u32 s30, s36
    s_cselect_b32 s35, 1280, 0
    s_sub_u32 s30, s30, s35
    s_waitcnt vmcnt(10)
    s_barrier
    s_add_u32 m0, s33, 61440
    s_nop 0
    buffer_load_dwordx4 v6, s[20:23], s31 offen lds
    s_add_u32 s31, s31, 98304
    s_cmp_ge_u32 s31, s37
    s_cselect_b32 s35, 1966080, 0
    s_sub_u32 s31, s31, s35
    s_waitcnt vmcnt(6)
    s_barrier
    s_add_u32 m0, s33, 67584
    s_nop 0
    buffer_load_dwordx4 v6, s[20:23], s31 offen lds
    s_add_u32 s31, s31, 98304
    s_cmp_ge_u32 s31, s37
    s_cselect_b32 s35, 1966080, 0
    s_sub_u32 s31, s31, s35
    s_add_u32 m0, s32, 0
    s_nop 0
    buffer_load_dwordx4 v2, s[16:19], s30 offen offset:0 sc1 lds
    buffer_load_dwordx4 v3, s[16:19], s30 offen offset:1024 sc1 lds
    buffer_load_dwordx4 v4, s[16:19], s30 offen offset:2048 sc1 lds
    buffer_load_dwordx4 v5, s[16:19], s30 offen offset:3072 sc1 lds
    s_add_u32 s30, s30, 128
    s_cmp_ge_u32 s30, s36
    s_cselect_b32 s35, 1280, 0
    s_sub_u32 s30, s30, s35
    s_waitcnt vmcnt(10)
    s_barrier
    s_add_u32 m0, s33, 49152
    s_nop 0
    buffer_load_dwordx4 v6, s[20:23], s31 offen lds
    s_add_u32 s31, s31, 98304
    s_cmp_ge_u32 s31, s37
    s_cselect_b32 s35, 1966080, 0
    s_sub_u32 s31, s31, s35
    s_waitcnt vmcnt(6)
    s_barrier
    s_add_u32 m0, s33, 55296
    s_nop 0
    buffer_load_dwordx4 v6, s[20:23], s31 offen lds
    s_add_u32 s31, s31, 98304
    s_cmp_ge_u32 s31, s37
    s_cselect_b32 s35, 1966080, 0
    s_sub_u32 s31, s31, s35
    s_add_u32 m0, s32, 16384
    s_nop 0
    buffer_load_dwordx4 v2, s[16:19], s30 offen offset:0 sc1 lds
    buffer_load_dwordx4 v3, s[16:19], s30 offen offset:1024 sc1 lds
    buffer_load_dwordx4 v4, s[16:19], s30 offen offset:2048 sc1 lds
    buffer_load_dwordx4 v5, s[16:19], s30 offen offset:3072 sc1 lds
    s_add_u32 s30, s30, 128
    s_cmp_ge_u32 s30, s36
    s_cselect_b32 s35, 1280, 0
    s_sub_u32 s30, s30, s35
    s_waitcnt vmcnt(10)
    s_barrier
    s_add_u32 m0, s33, 61440
    s_nop 0
    buffer_load_dwordx4 v6, s[20:23], s31 offen lds
    s_add_u32 s31, s31, 98304
    s_cmp_ge_u32 s31, s37
    s_cselect_b32 s35, 1966080, 0
    s_sub_u32 s31, s31, s35
    s_waitcnt vmcnt(6)
    s_barrier
    s_add_u32 m0, s33, 67584
    s_nop 0
    buffer_load_dwordx4 v6, s[20:23], s31 offen lds
    s_add_u32 s31, s31, 98304
    s_cmp_ge_u32 s31, s37
    s_cselect_b32 s35, 1966080, 0
    s_sub_u32 s31, s31, s35
    s_add_u32 m0, s32, 32768
    s_nop 0
    buffer_load_dwordx4 v2, s[16:19], s30 offen offset:0 sc1 lds
    buffer_load_dwordx4 v3, s[16:19], s30 offen offset:1024 sc1 lds
    buffer_load_dwordx4 v4, s[16:19], s30 offen offset:2048 sc1 lds
    buffer_load_dwordx4 v5, s[16:19], s30 offen offset:3072 sc1 lds
    s_add_u32 s30, s30, 128
    s_cmp_ge_u32 s30, s36
    s_cselect_b32 s35, 1280, 0
    s_sub_u32 s30, s30, s35
    s_waitcnt vmcnt(10)
    s_barrier
    s_add_u32 m0, s33, 49152
    s_nop 0
    buffer_load_dwordx4 v6, s[20:23], s31 offen lds
    s_add_u32 s31, s31, 98304
    s_cmp_ge_u32 s31, s37
    s_cselect_b32 s35, 1966080, 0
    s_sub_u32 s31, s31, s35
    s_waitcnt vmcnt(6)
    s_barrier
    s_add_u32 m0, s33, 55296
    s_nop 0
    buffer_load_dwordx4 v6, s[20:23], s31 offen lds
    s_add_u32 s31, s31, 98304
    s_cmp_ge_u32 s31, s37
    s_cselect_b32 s35, 1966080, 0
    s_sub_u32 s31, s31, s35
    s_add_u32 m0, s32, 0
    s_nop 0
    buffer_load_dwordx4 v2, s[16:19], s30 offen offset:0 sc1 lds
    buffer_load_dwordx4 v3, s[16:19], s30 offen offset:1024 sc1 lds
    buffer_load_dwordx4 v4, s[16:19], s30 offen offset:2048 sc1 lds
    buffer_load_dwordx4 v5, s[16:19], s30 offen offset:3072 sc1 lds
    s_add_u32 s30, s30, 128
    s_cmp_ge_u32 s30, s36
    s_cselect_b32 s35, 1280, 0
    s_sub_u32 s30, s30, s35
    s_waitcnt vmcnt(10)
    s_barrier
    s_add_u32 m0, s33, 61440
    s_nop 0
    buffer_load_dwordx4 v6, s[20:23], s31 offen lds
    s_add_u32 s31, s31, 98304
    s_cmp_ge_u32 s31, s37
    s_cselect_b32 s35, 1966080, 0
    s_sub_u32 s31, s31, s35
    s_waitcnt vmcnt(6)
    s_barrier
    s_add_u32 m0, s33, 67584
    s_nop 0
    buffer_load_dwordx4 v6, s[20:23], s31 offen lds
    s_add_u32 s31, s31, 98304
    s_cmp_ge_u32 s31, s37
    s_cselect_b32 s35, 1966080, 0
    s_sub_u32 s31, s31, s35
    s_waitcnt vmcnt(6)
    s_barrier
    s_waitcnt vmcnt(1)
    s_barrier
    s_waitcnt vmcnt(0)
    s_barrier
pk_m1_loader_end:
    s_cmp_lg_u32 s97, 5
    s_cbranch_scc1 pw2g_39
    s_load_dwordx2 s[40:41], s[0:1], 48
    s_mul_i32 s58, s96, 7680
    v_min_u32 v16, 59, v0
    v_lshl_add_u32 v16, v16, 7, s58
    s_waitcnt lgkmcnt(0)
    global_load_dword v17, v16, s[40:41]
pw2g_39:
    s_setprio 3
pk_m1_mlp1_done:
    s_waitcnt vmcnt(0)
    s_barrier
    s_cmp_lg_u32 s97, 4
    s_cbranch_scc1 hsig_40
    s_lshl_b32 s56, s13, 7
    s_lshl_b32 s57, s14, 2
    s_add_u32 s56, s56, s57
    s_add_u32 s56, s56, 0x1f01000
    v_mov_b32 v2, s56
    v_mov_b32 v3, s100
    s_mov_b64 exec, 1
    global_store_dword v2, v3, s[10:11] sc1
    s_mov_b64 exec, -1
    s_and_b32 s3, s96, 7
    s_lshr_b32 s15, s96, 3
    s_lshl_b32 s13, s3, 2
    s_and_b32 s24, s15, 3
    s_add_u32 s13, s13, s24
    s_lshr_b32 s14, s15, 2
    s_lshr_b32 s27, s13, 1
    s_lshl_b32 s56, s27, 7
    s_add_u32 s56, s56, 0x1f01000
    v_mbcnt_lo_u32_b32 v2, -1, 0
    v_mbcnt_hi_u32_b32 v2, -1, v2
    v_min_u32 v2, 15, v2
    v_lshl_add_u32 v2, v2, 2, s56
    s_mov_b32 s57, 0
fw_41:
    global_load_dword v3, v2, s[10:11] sc1
    s_add_u32 s57, s57, 1
    s_waitcnt vmcnt(0)
    v_cmp_ne_u32 vcc, s100, v3
    s_cbranch_vccz fwok_42
    s_sleep 2
    s_cmp_lt_u32 s57, 0x8000
    s_cbranch_scc1 fw_41
fwok_42:
hsig_40:
    s_barrier
    s_load_dwordx4 s[4:7], s[0:1], 48
    s_load_dwordx2 s[8:9], s[0:1], 16
    s_load_dwordx2 s[38:39], s[0:1], 72
    s_mov_b32 s12, s97
    s_and_b32 s3, s96, 7
    s_lshr_b32 s15, s96, 3
    s_lshl_b32 s13, s3, 2
    s_and_b32 s24, s15, 3
    s_add_u32 s13, s13, s24
    s_lshr_b32 s14, s15, 2
    s_setprio 3
    s_cmp_ge_u32 s12, 4
    s_cbranch_scc1 pk_g2_g_loader
    v_and_b32 v14, 15, v0
    v_lshrrev_b32 v15, 4, v0
    v_lshrrev_b32 v16, 1, v14
    v_xor_b32 v16, v15, v16
    s_lshl_b32 s26, s12, 11
    v_lshlrev_b32 v17, 7, v14
    v_add_u32 v17, s26, v17
    v_xor_b32 v18, 0, v16
    v_lshl_add_u32 v2, v18, 4, v17
    v_add_u32 v4, 55296, v2
    v_xor_b32 v18, 4, v16
    v_lshl_add_u32 v3, v18, 4, v17
    v_add_u32 v5, 55296, v3
    v_lshrrev_b32 v18, 1, v15
    v_lshlrev_b32 v18, 4, v18
    v_and_b32 v19, 1, v15
    v_lshl_add_u32 v18, v19, 2, v18
    v_lshrrev_b32 v19, 2, v14
    v_add_u32 v18, v18, v19
    v_mul_u32_u24 v18, 160, v18
    v_and_b32 v19, 3, v14
    v_lshl_add_u32 v18, v19, 3, v18
    v_add_u32 v6, 8192, v18
    v_add_u32 v7, 55296, v6
    s_lshl_b32 s26, s13, 6
    s_lshl_b32 s27, s12, 4
    s_add_u32 s26, s26, s27
    v_add_u32 v20, s26, v14
    s_mul_i32 s27, s14, 80
    v_lshl_add_u32 v21, v15, 2, s27
    v_lshlrev_b32 v22, 2, v20
    v_add_u32 v22, 0xc00000, v22
    v_lshlrev_b32 v24, 1, v21
    s_waitcnt lgkmcnt(0)
    global_load_dword v23, v22, s[10:11] sc1
    global_load_dwordx2 v[72:73], v24, s[6:7] offset:0
    global_load_dwordx2 v[74:75], v24, s[6:7] offset:32
    global_load_dwordx2 v[76:77], v24, s[6:7] offset:64
    global_load_dwordx2 v[78:79], v24, s[6:7] offset:96
    global_load_dwordx2 v[80:81], v24, s[6:7] offset:128
    s_waitcnt vmcnt(0)
    v_lshlrev_b32 v32, 16, v72
    v_and_b32 v33, 0xffff0000, v72
    v_lshlrev_b32 v34, 16, v73
    v_and_b32 v35, 0xffff0000, v73
    v_lshlrev_b32 v36, 16, v74
    v_and_b32 v37, 0xffff0000, v74
    v_lshlrev_b32 v38, 16, v75
    v_and_b32 v39, 0xffff0000, v75
    v_lshlrev_b32 v40, 16, v76
    v_and_b32 v41, 0xffff0000, v76
    v_lshlrev_b32 v42, 16, v77
    v_and_b32 v43, 0xffff0000, v77
    v_lshlrev_b32 v44, 16, v78
    v_and_b32 v45, 0xffff0000, v78
    v_lshlrev_b32 v46, 16, v79
    v_and_b32 v47, 0xffff0000, v79
    v_lshlrev_b32 v48, 16, v80
    v_and_b32 v49, 0xffff0000, v80
    v_lshlrev_b32 v50, 16, v81
    v_and_b32 v51, 0xffff0000, v81
    v_lshrrev_b32 v18, 2, v14
    v_lshl_add_u32 v18, v15, 3, v18
    v_and_b32 v19, 2, v18
    v_lshrrev_b32 v25, 1, v18
    v_and_b32 v25, 4, v25
    v_or_b32 v19, v19, v25
    v_bfe_u32 v25, v14, 1, 1
    s_lshl_b32 s26, s12, 1
    v_add_u32 v25, s26, v25
    v_xor_b32 v19, v19, v25
    v_lshlrev_b32 v18, 7, v18
    v_lshl_add_u32 v18, v19, 4, v18
    v_and_b32 v19, 1, v14
    v_lshl_add_u32 v8, v19, 3, v18
    v_add_u32 v9, 55296, v8
    s_setprio 0
    s_barrier
    ds_read_b128 v[72:75], v2 offset:0
    ds_read_b64_tr_b16 v[76:77], v6 offset:0
    ds_read_b64_tr_b16 v[78:79], v6 offset:1280
    ds_read_b64_tr_b16 v[80:81], v6 offset:32
    ds_read_b64_tr_b16 v[82:83], v6 offset:1312
    ds_read_b64_tr_b16 v[84:85], v6 offset:64
    ds_read_b64_tr_b16 v[86:87], v6 offset:1344
    ds_read_b64_tr_b16 v[88:89], v6 offset:96
    ds_read_b64_tr_b16 v[90:91], v6 offset:1376
    ds_read_b64_tr_b16 v[92:93], v6 offset:128
    ds_read_b64_tr_b16 v[94:95], v6 offset:1408
    s_waitcnt lgkmcnt(0)
    v_mfma_f32_16x16x32_bf16 v[32:35], v[76:79], v[72:75], v[32:35]
    ds_read_b128 v[96:99], v3 offset:0
    ds_read_b64_tr_b16 v[100:101], v6 offset:5120
    ds_read_b64_tr_b16 v[102:103], v6 offset:6400
    v_mfma_f32_16x16x32_bf16 v[36:39], v[80:83], v[72:75], v[36:39]
    ds_read_b64_tr_b16 v[104:105], v6 offset:5152
    ds_read_b64_tr_b16 v[106:107], v6 offset:6432
    ds_read_b64_tr_b16 v[108:109], v6 offset:5184
    v_mfma_f32_16x16x32_bf16 v[40:43], v[84:87], v[72:75], v[40:43]
    ds_read_b64_tr_b16 v[110:111], v6 offset:6464
    ds_read_b64_tr_b16 v[112:113], v6 offset:5216
    ds_read_b64_tr_b16 v[114:115], v6 offset:6496
    v_mfma_f32_16x16x32_bf16 v[44:47], v[88:91], v[72:75], v[44:47]
    ds_read_b64_tr_b16 v[116:117], v6 offset:5248
    ds_read_b64_tr_b16 v[118:119], v6 offset:6528
    v_mfma_f32_16x16x32_bf16 v[48:51], v[92:95], v[72:75], v[48:51]
    s_waitcnt lgkmcnt(0)
    s_barrier
    v_mfma_f32_16x16x32_bf16 v[32:35], v[100:103], v[96:99], v[32:35]
    ds_read_b128 v[72:75], v2 offset:18432
    ds_read_b64_tr_b16 v[76:77], v6 offset:18432
    ds_read_b64_tr_b16 v[78:79], v6 offset:19712
    v_mfma_f32_16x16x32_bf16 v[36:39], v[104:107], v[96:99], v[36:39]
    ds_read_b64_tr_b16 v[80:81], v6 offset:18464
    ds_read_b64_tr_b16 v[82:83], v6 offset:19744
    ds_read_b64_tr_b16 v[84:85], v6 offset:18496
    v_mfma_f32_16x16x32_bf16 v[40:43], v[108:111], v[96:99], v[40:43]
    ds_read_b64_tr_b16 v[86:87], v6 offset:19776
    ds_read_b64_tr_b16 v[88:89], v6 offset:18528
    ds_read_b64_tr_b16 v[90:91], v6 offset:19808
    v_mfma_f32_16x16x32_bf16 v[44:47], v[112:115], v[96:99], v[44:47]
    ds_read_b64_tr_b16 v[92:93], v6 offset:18560
    ds_read_b64_tr_b16 v[94:95], v6 offset:19840
    v_mfma_f32_16x16x32_bf16 v[48:51], v[116:119], v[96:99], v[48:51]
    s_waitcnt lgkmcnt(0)
    v_mfma_f32_16x16x32_bf16 v[32:35], v[76:79], v[72:75], v[32:35]
    ds_read_b128 v[96:99], v3 offset:18432
    ds_read_b64_tr_b16 v[100:101], v6 offset:23552
    ds_read_b64_tr_b16 v[102:103], v6 offset:24832
    v_mfma_f32_16x16x32_bf16 v[36:39], v[80:83], v[72:75], v[36:39]
    ds_read_b64_tr_b16 v[104:105], v6 offset:23584
    ds_read_b64_tr_b16 v[106:107], v6 offset:24864
    ds_read_b64_tr_b16 v[108:109], v6 offset:23616
    v_mfma_f32_16x16x32_bf16 v[40:43], v[84:87], v[72:75], v[40:43]
    ds_read_b64_tr_b16 v[110:111], v6 offset:24896
    ds_read_b64_tr_b16 v[112:113], v6 offset:23648
    ds_read_b64_tr_b16 v[114:115], v6 offset:24928
    v_mfma_f32_16x16x32_bf16 v[44:47], v[88:91], v[72:75], v[44:47]
    ds_read_b64_tr_b16 v[116:117], v6 offset:23680
    ds_read_b64_tr_b16 v[118:119], v6 offset:24960
    v_mfma_f32_16x16x32_bf16 v[48:51], v[92:95], v[72:75], v[48:51]
    s_waitcnt lgkmcnt(0)
    s_barrier
    v_mfma_f32_16x16x32_bf16 v[32:35], v[100:103], v[96:99], v[32:35]
    ds_read_b128 v[72:75], v2 offset:36864
    ds_read_b64_tr_b16 v[76:77], v6 offset:36864
    ds_read_b64_tr_b16 v[78:79], v6 offset:38144
    v_mfma_f32_16x16x32_bf16 v[36:39], v[104:107], v[96:99], v[36:39]
    ds_read_b64_tr_b16 v[80:81], v6 offset:36896
    ds_read_b64_tr_b16 v[82:83], v6 offset:38176
    ds_read_b64_tr_b16 v[84:85], v6 offset:36928
    v_mfma_f32_16x16x32_bf16 v[40:43], v[108:111], v[96:99], v[40:43]
    ds_read_b64_tr_b16 v[86:87], v6 offset:38208
    ds_read_b64_tr_b16 v[88:89], v6 offset:36960
    ds_read_b64_tr_b16 v[90:91], v6 offset:38240
    v_mfma_f32_16x16x32_bf16 v[44:47], v[112:115], v[96:99], v[44:47]
    ds_read_b64_tr_b16 v[92:93], v6 offset:36992
    ds_read_b64_tr_b16 v[94:95], v6 offset:38272
    v_mfma_f32_16x16x32_bf16 v[48:51], v[116:119], v[96:99], v[48:51]
    s_waitcnt lgkmcnt(0)
    v_mfma_f32_16x16x32_bf16 v[32:35], v[76:79], v[72:75], v[32:35]
    ds_read_b128 v[96:99], v3 offset:36864
    ds_read_b64_tr_b16 v[100:101], v6 offset:41984
    ds_read_b64_tr_b16 v[102:103], v6 offset:43264
    v_mfma_f32_16x16x32_bf16 v[36:39], v[80:83], v[72:75], v[36:39]
    ds_read_b64_tr_b16 v[104:105], v6 offset:42016
    ds_read_b64_tr_b16 v[106:107], v6 offset:43296
    ds_read_b64_tr_b16 v[108:109], v6 offset:42048
    v_mfma_f32_16x16x32_bf16 v[40:43], v[84:87], v[72:75], v[40:43]
    ds_read_b64_tr_b16 v[110:111], v6 offset:43328
    ds_read_b64_tr_b16 v[112:113], v6 offset:42080
    ds_read_b64_tr_b16 v[114:115], v6 offset:43360
    v_mfma_f32_16x16x32_bf16 v[44:47], v[88:91], v[72:75], v[44:47]
    ds_read_b64_tr_b16 v[116:117], v6 offset:42112
    ds_read_b64_tr_b16 v[118:119], v6 offset:43392
    v_mfma_f32_16x16x32_bf16 v[48:51], v[92:95], v[72:75], v[48:51]
    s_waitcnt lgkmcnt(0)
    s_barrier
    v_mfma_f32_16x16x32_bf16 v[32:35], v[100:103], v[96:99], v[32:35]
    ds_read_b128 v[72:75], v4 offset:0
    ds_read_b64_tr_b16 v[76:77], v7 offset:0
    ds_read_b64_tr_b16 v[78:79], v7 offset:1280
    v_mfma_f32_16x16x32_bf16 v[36:39], v[104:107], v[96:99], v[36:39]
    ds_read_b64_tr_b16 v[80:81], v7 offset:32
    ds_read_b64_tr_b16 v[82:83], v7 offset:1312
    ds_read_b64_tr_b16 v[84:85], v7 offset:64
    v_mfma_f32_16x16x32_bf16 v[40:43], v[108:111], v[96:99], v[40:43]
    ds_read_b64_tr_b16 v[86:87], v7 offset:1344
    ds_read_b64_tr_b16 v[88:89], v7 offset:96
    ds_read_b64_tr_b16 v[90:91], v7 offset:1376
    v_mfma_f32_16x16x32_bf16 v[44:47], v[112:115], v[96:99], v[44:47]
    ds_read_b64_tr_b16 v[92:93], v7 offset:128
    ds_read_b64_tr_b16 v[94:95], v7 offset:1408
    v_mfma_f32_16x16x32_bf16 v[48:51], v[116:119], v[96:99], v[48:51]
    s_waitcnt lgkmcnt(0)
    v_mfma_f32_16x16x32_bf16 v[32:35], v[76:79], v[72:75], v[32:35]
    ds_read_b128 v[96:99], v5 offset:0
    ds_read_b64_tr_b16 v[100:101], v7 offset:5120
    ds_read_b64_tr_b16 v[102:103], v7 offset:6400
    v_mfma_f32_16x16x32_bf16 v[36:39], v[80:83], v[72:75], v[36:39]
    ds_read_b64_tr_b16 v[104:105], v7 offset:5152
    ds_read_b64_tr_b16 v[106:107], v7 offset:6432
    ds_read_b64_tr_b16 v[108:109], v7 offset:5184
    v_mfma_f32_16x16x32_bf16 v[40:43], v[84:87], v[72:75], v[40:43]
    ds_read_b64_tr_b16 v[110:111], v7 offset:6464
    ds_read_b64_tr_b16 v[112:113], v7 offset:5216
    ds_read_b64_tr_b16 v[114:115], v7 offset:6496
    v_mfma_f32_16x16x32_bf16 v[44:47], v[88:91], v[72:75], v[44:47]
    ds_read_b64_tr_b16 v[116:117], v7 offset:5248
    ds_read_b64_tr_b16 v[118:119], v7 offset:6528
    v_mfma_f32_16x16x32_bf16 v[48:51], v[92:95], v[72:75], v[48:51]
    s_waitcnt lgkmcnt(0)
    s_barrier
    v_mfma_f32_16x16x32_bf16 v[32:35], v[100:103], v[96:99], v[32:35]
    ds_read_b128 v[72:75], v2 offset:0
    ds_read_b64_tr_b16 v[76:77], v6 offset:0
    ds_read_b64_tr_b16 v[78:79], v6 offset:1280
    v_mfma_f32_16x16x32_bf16 v[36:39], v[104:107], v[96:99], v[36:39]
    ds_read_b64_tr_b16 v[80:81], v6 offset:32
    ds_read_b64_tr_b16 v[82:83], v6 offset:1312
    ds_read_b64_tr_b16 v[84:85], v6 offset:64
    v_mfma_f32_16x16x32_bf16 v[40:43], v[108:111], v[96:99], v[40:43]
    ds_read_b64_tr_b16 v[86:87], v6 offset:1344
    ds_read_b64_tr_b16 v[88:89], v6 offset:96
    ds_read_b64_tr_b16 v[90:91], v6 offset:1376
    v_mfma_f32_16x16x32_bf16 v[44:47], v[112:115], v[96:99], v[44:47]
    ds_read_b64_tr_b16 v[92:93], v6 offset:128
    ds_read_b64_tr_b16 v[94:95], v6 offset:1408
    v_mfma_f32_16x16x32_bf16 v[48:51], v[116:119], v[96:99], v[48:51]
    s_waitcnt lgkmcnt(0)
    v_mfma_f32_16x16x32_bf16 v[32:35], v[76:79], v[72:75], v[32:35]
    ds_read_b128 v[96:99], v3 offset:0
    ds_read_b64_tr_b16 v[100:101], v6 offset:5120
    ds_read_b64_tr_b16 v[102:103], v6 offset:6400
    v_mfma_f32_16x16x32_bf16 v[36:39], v[80:83], v[72:75], v[36:39]
    ds_read_b64_tr_b16 v[104:105], v6 offset:5152
    ds_read_b64_tr_b16 v[106:107], v6 offset:6432
    ds_read_b64_tr_b16 v[108:109], v6 offset:5184
    v_mfma_f32_16x16x32_bf16 v[40:43], v[84:87], v[72:75], v[40:43]
    ds_read_b64_tr_b16 v[110:111], v6 offset:6464
    ds_read_b64_tr_b16 v[112:113], v6 offset:5216
    ds_read_b64_tr_b16 v[114:115], v6 offset:6496
    v_mfma_f32_16x16x32_bf16 v[44:47], v[88:91], v[72:75], v[44:47]
    ds_read_b64_tr_b16 v[116:117], v6 offset:5248
    ds_read_b64_tr_b16 v[118:119], v6 offset:6528
    v_mfma_f32_16x16x32_bf16 v[48:51], v[92:95], v[72:75], v[48:51]
    s_waitcnt lgkmcnt(0)
    s_barrier
    v_mfma_f32_16x16x32_bf16 v[32:35], v[100:103], v[96:99], v[32:35]
    ds_read_b128 v[72:75], v2 offset:18432
    ds_read_b64_tr_b16 v[76:77], v6 offset:18432
    ds_read_b64_tr_b16 v[78:79], v6 offset:19712
    v_mfma_f32_16x16x32_bf16 v[36:39], v[104:107], v[96:99], v[36:39]
    ds_read_b64_tr_b16 v[80:81], v6 offset:18464
    ds_read_b64_tr_b16 v[82:83], v6 offset:19744
    ds_read_b64_tr_b16 v[84:85], v6 offset:18496
    v_mfma_f32_16x16x32_bf16 v[40:43], v[108:111], v[96:99], v[40:43]
    ds_read_b64_tr_b16 v[86:87], v6 offset:19776
    ds_read_b64_tr_b16 v[88:89], v6 offset:18528
    ds_read_b64_tr_b16 v[90:91], v6 offset:19808
    v_mfma_f32_16x16x32_bf16 v[44:47], v[112:115], v[96:99], v[44:47]
    ds_read_b64_tr_b16 v[92:93], v6 offset:18560
    ds_read_b64_tr_b16 v[94:95], v6 offset:19840
    v_mfma_f32_16x16x32_bf16 v[48:51], v[116:119], v[96:99], v[48:51]
    s_waitcnt lgkmcnt(0)
    v_mfma_f32_16x16x32_bf16 v[32:35], v[76:79], v[72:75], v[32:35]
    ds_read_b128 v[96:99], v3 offset:18432
    ds_read_b64_tr_b16 v[100:101], v6 offset:23552
    ds_read_b64_tr_b16 v[102:103], v6 offset:24832
    v_mfma_f32_16x16x32_bf16 v[36:39], v[80:83], v[72:75], v[36:39]
    ds_read_b64_tr_b16 v[104:105], v6 offset:23584
    ds_read_b64_tr_b16 v[106:107], v6 offset:24864
    ds_read_b64_tr_b16 v[108:109], v6 offset:23616
    v_mfma_f32_16x16x32_bf16 v[40:43], v[84:87], v[72:75], v[40:43]
    ds_read_b64_tr_b16 v[110:111], v6 offset:24896
    ds_read_b64_tr_b16 v[112:113], v6 offset:23648
    ds_read_b64_tr_b16 v[114:115], v6 offset:24928
    v_mfma_f32_16x16x32_bf16 v[44:47], v[88:91], v[72:75], v[44:47]
    ds_read_b64_tr_b16 v[116:117], v6 offset:23680
    ds_read_b64_tr_b16 v[118:119], v6 offset:24960
    v_mfma_f32_16x16x32_bf16 v[48:51], v[92:95], v[72:75], v[48:51]
    s_waitcnt lgkmcnt(0)
    s_barrier
    v_mfma_f32_16x16x32_bf16 v[32:35], v[100:103], v[96:99], v[32:35]
    ds_read_b128 v[72:75], v2 offset:36864
    ds_read_b64_tr_b16 v[76:77], v6 offset:36864
    ds_read_b64_tr_b16 v[78:79], v6 offset:38144
    v_mfma_f32_16x16x32_bf16 v[36:39], v[104:107], v[96:99], v[36:39]
    ds_read_b64_tr_b16 v[80:81], v6 offset:36896
    ds_read_b64_tr_b16 v[82:83], v6 offset:38176
    ds_read_b64_tr_b16 v[84:85], v6 offset:36928
    v_mfma_f32_16x16x32_bf16 v[40:43], v[108:111], v[96:99], v[40:43]
    ds_read_b64_tr_b16 v[86:87], v6 offset:38208
    ds_read_b64_tr_b16 v[88:89], v6 offset:36960
    ds_read_b64_tr_b16 v[90:91], v6 offset:38240
    v_mfma_f32_16x16x32_bf16 v[44:47], v[112:115], v[96:99], v[44:47]
    ds_read_b64_tr_b16 v[92:93], v6 offset:36992
    ds_read_b64_tr_b16 v[94:95], v6 offset:38272
    v_mfma_f32_16x16x32_bf16 v[48:51], v[116:119], v[96:99], v[48:51]
    s_waitcnt lgkmcnt(0)
    v_mfma_f32_16x16x32_bf16 v[32:35], v[76:79], v[72:75], v[32:35]
    ds_read_b128 v[96:99], v3 offset:36864
    ds_read_b64_tr_b16 v[100:101], v6 offset:41984
    ds_read_b64_tr_b16 v[102:103], v6 offset:43264
    v_mfma_f32_16x16x32_bf16 v[36:39], v[80:83], v[72:75], v[36:39]
    ds_read_b64_tr_b16 v[104:105], v6 offset:42016
    ds_read_b64_tr_b16 v[106:107], v6 offset:43296
    ds_read_b64_tr_b16 v[108:109], v6 offset:42048
    v_mfma_f32_16x16x32_bf16 v[40:43], v[84:87], v[72:75], v[40:43]
    ds_read_b64_tr_b16 v[110:111], v6 offset:43328
    ds_read_b64_tr_b16 v[112:113], v6 offset:42080
    ds_read_b64_tr_b16 v[114:115], v6 offset:43360
    v_mfma_f32_16x16x32_bf16 v[44:47], v[88:91], v[72:75], v[44:47]
    ds_read_b64_tr_b16 v[116:117], v6 offset:42112
    ds_read_b64_tr_b16 v[118:119], v6 offset:43392
    v_mfma_f32_16x16x32_bf16 v[48:51], v[92:95], v[72:75], v[48:51]
    s_waitcnt lgkmcnt(0)
    s_barrier
    v_mfma_f32_16x16x32_bf16 v[32:35], v[100:103], v[96:99], v[32:35]
    ds_read_b128 v[72:75], v4 offset:0
    ds_read_b64_tr_b16 v[76:77], v7 offset:0
    ds_read_b64_tr_b16 v[78:79], v7 offset:1280
    v_mfma_f32_16x16x32_bf16 v[36:39], v[104:107], v[96:99], v[36:39]
    ds_read_b64_tr_b16 v[80:81], v7 offset:32
    ds_read_b64_tr_b16 v[82:83], v7 offset:1312
    ds_read_b64_tr_b16 v[84:85], v7 offset:64
    v_mfma_f32_16x16x32_bf16 v[40:43], v[108:111], v[96:99], v[40:43]
    ds_read_b64_tr_b16 v[86:87], v7 offset:1344
    ds_read_b64_tr_b16 v[88:89], v7 offset:96
    ds_read_b64_tr_b16 v[90:91], v7 offset:1376
    v_mfma_f32_16x16x32_bf16 v[44:47], v[112:115], v[96:99], v[44:47]
    ds_read_b64_tr_b16 v[92:93], v7 offset:128
    ds_read_b64_tr_b16 v[94:95], v7 offset:1408
    v_mfma_f32_16x16x32_bf16 v[48:51], v[116:119], v[96:99], v[48:51]
    s_waitcnt lgkmcnt(0)
    v_mfma_f32_16x16x32_bf16 v[32:35], v[76:79], v[72:75], v[32:35]
    ds_read_b128 v[96:99], v5 offset:0
    ds_read_b64_tr_b16 v[100:101], v7 offset:5120
    ds_read_b64_tr_b16 v[102:103], v7 offset:6400
    v_mfma_f32_16x16x32_bf16 v[36:39], v[80:83], v[72:75], v[36:39]
    ds_read_b64_tr_b16 v[104:105], v7 offset:5152
    ds_read_b64_tr_b16 v[106:107], v7 offset:6432
    ds_read_b64_tr_b16 v[108:109], v7 offset:5184
    v_mfma_f32_16x16x32_bf16 v[40:43], v[84:87], v[72:75], v[40:43]
    ds_read_b64_tr_b16 v[110:111], v7 offset:6464
    ds_read_b64_tr_b16 v[112:113], v7 offset:5216
    ds_read_b64_tr_b16 v[114:115], v7 offset:6496
    v_mfma_f32_16x16x32_bf16 v[44:47], v[88:91], v[72:75], v[44:47]
    ds_read_b64_tr_b16 v[116:117], v7 offset:5248
    ds_read_b64_tr_b16 v[118:119], v7 offset:6528
    v_mfma_f32_16x16x32_bf16 v[48:51], v[92:95], v[72:75], v[48:51]
    s_waitcnt lgkmcnt(0)
    s_barrier
    v_mfma_f32_16x16x32_bf16 v[32:35], v[100:103], v[96:99], v[32:35]
    ds_read_b128 v[72:75], v2 offset:0
    ds_read_b64_tr_b16 v[76:77], v6 offset:0
    ds_read_b64_tr_b16 v[78:79], v6 offset:1280
    v_mfma_f32_16x16x32_bf16 v[36:39], v[104:107], v[96:99], v[36:39]
    ds_read_b64_tr_b16 v[80:81], v6 offset:32
    ds_read_b64_tr_b16 v[82:83], v6 offset:1312
    ds_read_b64_tr_b16 v[84:85], v6 offset:64
    v_mfma_f32_16x16x32_bf16 v[40:43], v[108:111], v[96:99], v[40:43]
    ds_read_b64_tr_b16 v[86:87], v6 offset:1344
    ds_read_b64_tr_b16 v[88:89], v6 offset:96
    ds_read_b64_tr_b16 v[90:91], v6 offset:1376
    v_mfma_f32_16x16x32_bf16 v[44:47], v[112:115], v[96:99], v[44:47]
    ds_read_b64_tr_b16 v[92:93], v6 offset:128
    ds_read_b64_tr_b16 v[94:95], v6 offset:1408
    v_mfma_f32_16x16x32_bf16 v[48:51], v[116:119], v[96:99], v[48:51]
    s_waitcnt lgkmcnt(0)
    v_mfma_f32_16x16x32_bf16 v[32:35], v[76:79], v[72:75], v[32:35]
    ds_read_b128 v[96:99], v3 offset:0
    ds_read_b64_tr_b16 v[100:101], v6 offset:5120
    ds_read_b64_tr_b16 v[102:103], v6 offset:6400
    v_mfma_f32_16x16x32_bf16 v[36:39], v[80:83], v[72:75], v[36:39]
    ds_read_b64_tr_b16 v[104:105], v6 offset:5152
    ds_read_b64_tr_b16 v[106:107], v6 offset:6432
    ds_read_b64_tr_b16 v[108:109], v6 offset:5184
    v_mfma_f32_16x16x32_bf16 v[40:43], v[84:87], v[72:75], v[40:43]
    ds_read_b64_tr_b16 v[110:111], v6 offset:6464
    ds_read_b64_tr_b16 v[112:113], v6 offset:5216
    ds_read_b64_tr_b16 v[114:115], v6 offset:6496
    v_mfma_f32_16x16x32_bf16 v[44:47], v[88:91], v[72:75], v[44:47]
    ds_read_b64_tr_b16 v[116:117], v6 offset:5248
    ds_read_b64_tr_b16 v[118:119], v6 offset:6528
    v_mfma_f32_16x16x32_bf16 v[48:51], v[92:95], v[72:75], v[48:51]
    s_waitcnt lgkmcnt(0)
    s_barrier
    v_mfma_f32_16x16x32_bf16 v[32:35], v[100:103], v[96:99], v[32:35]
    ds_read_b128 v[72:75], v2 offset:18432
    ds_read_b64_tr_b16 v[76:77], v6 offset:18432
    ds_read_b64_tr_b16 v[78:79], v6 offset:19712
    v_mfma_f32_16x16x32_bf16 v[36:39], v[104:107], v[96:99], v[36:39]
    ds_read_b64_tr_b16 v[80:81], v6 offset:18464
    ds_read_b64_tr_b16 v[82:83], v6 offset:19744
    ds_read_b64_tr_b16 v[84:85], v6 offset:18496
    v_mfma_f32_16x16x32_bf16 v[40:43], v[108:111], v[96:99], v[40:43]
    ds_read_b64_tr_b16 v[86:87], v6 offset:19776
    ds_read_b64_tr_b16 v[88:89], v6 offset:18528
    ds_read_b64_tr_b16 v[90:91], v6 offset:19808
    v_mfma_f32_16x16x32_bf16 v[44:47], v[112:115], v[96:99], v[44:47]
    ds_read_b64_tr_b16 v[92:93], v6 offset:18560
    ds_read_b64_tr_b16 v[94:95], v6 offset:19840
    v_mfma_f32_16x16x32_bf16 v[48:51], v[116:119], v[96:99], v[48:51]
    s_waitcnt lgkmcnt(0)
    v_mfma_f32_16x16x32_bf16 v[32:35], v[76:79], v[72:75], v[32:35]
    ds_read_b128 v[96:99], v3 offset:18432
    ds_read_b64_tr_b16 v[100:101], v6 offset:23552
    ds_read_b64_tr_b16 v[102:103], v6 offset:24832
    v_mfma_f32_16x16x32_bf16 v[36:39], v[80:83], v[72:75], v[36:39]
    ds_read_b64_tr_b16 v[104:105], v6 offset:23584
    ds_read_b64_tr_b16 v[106:107], v6 offset:24864
    ds_read_b64_tr_b16 v[108:109], v6 offset:23616
    v_mfma_f32_16x16x32_bf16 v[40:43], v[84:87], v[72:75], v[40:43]
    ds_read_b64_tr_b16 v[110:111], v6 offset:24896
    ds_read_b64_tr_b16 v[112:113], v6 offset:23648
    ds_read_b64_tr_b16 v[114:115], v6 offset:24928
    v_mfma_f32_16x16x32_bf16 v[44:47], v[88:91], v[72:75], v[44:47]
    ds_read_b64_tr_b16 v[116:117], v6 offset:23680
    ds_read_b64_tr_b16 v[118:119], v6 offset:24960
    v_mfma_f32_16x16x32_bf16 v[48:51], v[92:95], v[72:75], v[48:51]
    s_waitcnt lgkmcnt(0)
    s_barrier
    v_mfma_f32_16x16x32_bf16 v[32:35], v[100:103], v[96:99], v[32:35]
    ds_read_b128 v[72:75], v2 offset:36864
    ds_read_b64_tr_b16 v[76:77], v6 offset:36864
    ds_read_b64_tr_b16 v[78:79], v6 offset:38144
    v_mfma_f32_16x16x32_bf16 v[36:39], v[104:107], v[96:99], v[36:39]
    ds_read_b64_tr_b16 v[80:81], v6 offset:36896
    ds_read_b64_tr_b16 v[82:83], v6 offset:38176
    ds_read_b64_tr_b16 v[84:85], v6 offset:36928
    v_mfma_f32_16x16x32_bf16 v[40:43], v[108:111], v[96:99], v[40:43]
    ds_read_b64_tr_b16 v[86:87], v6 offset:38208
    ds_read_b64_tr_b16 v[88:89], v6 offset:36960
    ds_read_b64_tr_b16 v[90:91], v6 offset:38240
    v_mfma_f32_16x16x32_bf16 v[44:47], v[112:115], v[96:99], v[44:47]
    ds_read_b64_tr_b16 v[92:93], v6 offset:36992
    ds_read_b64_tr_b16 v[94:95], v6 offset:38272
    v_mfma_f32_16x16x32_bf16 v[48:51], v[116:119], v[96:99], v[48:51]
    s_waitcnt lgkmcnt(0)
    v_mfma_f32_16x16x32_bf16 v[32:35], v[76:79], v[72:75], v[32:35]
    ds_read_b128 v[96:99], v3 offset:36864
    ds_read_b64_tr_b16 v[100:101], v6 offset:41984
    ds_read_b64_tr_b16 v[102:103], v6 offset:43264
    v_mfma_f32_16x16x32_bf16 v[36:39], v[80:83], v[72:75], v[36:39]
    ds_read_b64_tr_b16 v[104:105], v6 offset:42016
    ds_read_b64_tr_b16 v[106:107], v6 offset:43296
    ds_read_b64_tr_b16 v[108:109], v6 offset:42048
    v_mfma_f32_16x16x32_bf16 v[40:43], v[84:87], v[72:75], v[40:43]
    ds_read_b64_tr_b16 v[110:111], v6 offset:43328
    ds_read_b64_tr_b16 v[112:113], v6 offset:42080
    ds_read_b64_tr_b16 v[114:115], v6 offset:43360
    v_mfma_f32_16x16x32_bf16 v[44:47], v[88:91], v[72:75], v[44:47]
    ds_read_b64_tr_b16 v[116:117], v6 offset:42112
    ds_read_b64_tr_b16 v[118:119], v6 offset:43392
    v_mfma_f32_16x16x32_bf16 v[48:51], v[92:95], v[72:75], v[48:51]
    s_waitcnt lgkmcnt(0)
    s_barrier
    v_mfma_f32_16x16x32_bf16 v[32:35], v[100:103], v[96:99], v[32:35]
    ds_read_b128 v[72:75], v4 offset:0
    ds_read_b64_tr_b16 v[76:77], v7 offset:0
    ds_read_b64_tr_b16 v[78:79], v7 offset:1280
    v_mfma_f32_16x16x32_bf16 v[36:39], v[104:107], v[96:99], v[36:39]
    ds_read_b64_tr_b16 v[80:81], v7 offset:32
    ds_read_b64_tr_b16 v[82:83], v7 offset:1312
    ds_read_b64_tr_b16 v[84:85], v7 offset:64
    v_mfma_f32_16x16x32_bf16 v[40:43], v[108:111], v[96:99], v[40:43]
    ds_read_b64_tr_b16 v[86:87], v7 offset:1344
    ds_read_b64_tr_b16 v[88:89], v7 offset:96
    ds_read_b64_tr_b16 v[90:91], v7 offset:1376
    v_mfma_f32_16x16x32_bf16 v[44:47], v[112:115], v[96:99], v[44:47]
    ds_read_b64_tr_b16 v[92:93], v7 offset:128
    ds_read_b64_tr_b16 v[94:95], v7 offset:1408
    v_mfma_f32_16x16x32_bf16 v[48:51], v[116:119], v[96:99], v[48:51]
    s_waitcnt lgkmcnt(0)
    v_mfma_f32_16x16x32_bf16 v[32:35], v[76:79], v[72:75], v[32:35]
    ds_read_b128 v[96:99], v5 offset:0
    ds_read_b64_tr_b16 v[100:101], v7 offset:5120
    ds_read_b64_tr_b16 v[102:103], v7 offset:6400
    v_mfma_f32_16x16x32_bf16 v[36:39], v[80:83], v[72:75], v[36:39]
    ds_read_b64_tr_b16 v[104:105], v7 offset:5152
    ds_read_b64_tr_b16 v[106:107], v7 offset:6432
    ds_read_b64_tr_b16 v[108:109], v7 offset:5184
    v_mfma_f32_16x16x32_bf16 v[40:43], v[84:87], v[72:75], v[40:43]
    ds_read_b64_tr_b16 v[110:111], v7 offset:6464
    ds_read_b64_tr_b16 v[112:113], v7 offset:5216
    ds_read_b64_tr_b16 v[114:115], v7 offset:6496
    v_mfma_f32_16x16x32_bf16 v[44:47], v[88:91], v[72:75], v[44:47]
    ds_read_b64_tr_b16 v[116:117], v7 offset:5248
    ds_read_b64_tr_b16 v[118:119], v7 offset:6528
    v_mfma_f32_16x16x32_bf16 v[48:51], v[92:95], v[72:75], v[48:51]
    s_waitcnt lgkmcnt(0)
    s_barrier
    v_mfma_f32_16x16x32_bf16 v[32:35], v[100:103], v[96:99], v[32:35]
    ds_read_b128 v[72:75], v2 offset:0
    ds_read_b64_tr_b16 v[76:77], v6 offset:0
    ds_read_b64_tr_b16 v[78:79], v6 offset:1280
    v_mfma_f32_16x16x32_bf16 v[36:39], v[104:107], v[96:99], v[36:39]
    ds_read_b64_tr_b16 v[80:81], v6 offset:32
    ds_read_b64_tr_b16 v[82:83], v6 offset:1312
    ds_read_b64_tr_b16 v[84:85], v6 offset:64
    v_mfma_f32_16x16x32_bf16 v[40:43], v[108:111], v[96:99], v[40:43]
    ds_read_b64_tr_b16 v[86:87], v6 offset:1344
    ds_read_b64_tr_b16 v[88:89], v6 offset:96
    ds_read_b64_tr_b16 v[90:91], v6 offset:1376
    v_mfma_f32_16x16x32_bf16 v[44:47], v[112:115], v[96:99], v[44:47]
    ds_read_b64_tr_b16 v[92:93], v6 offset:128
    ds_read_b64_tr_b16 v[94:95], v6 offset:1408
    v_mfma_f32_16x16x32_bf16 v[48:51], v[116:119], v[96:99], v[48:51]
    s_waitcnt lgkmcnt(0)
    v_mfma_f32_16x16x32_bf16 v[32:35], v[76:79], v[72:75], v[32:35]
    ds_read_b128 v[96:99], v3 offset:0
    ds_read_b64_tr_b16 v[100:101], v6 offset:5120
    ds_read_b64_tr_b16 v[102:103], v6 offset:6400
    v_mfma_f32_16x16x32_bf16 v[36:39], v[80:83], v[72:75], v[36:39]
    ds_read_b64_tr_b16 v[104:105], v6 offset:5152
    ds_read_b64_tr_b16 v[106:107], v6 offset:6432
    ds_read_b64_tr_b16 v[108:109], v6 offset:5184
    v_mfma_f32_16x16x32_bf16 v[40:43], v[84:87], v[72:75], v[40:43]
    ds_read_b64_tr_b16 v[110:111], v6 offset:6464
    ds_read_b64_tr_b16 v[112:113], v6 offset:5216
    ds_read_b64_tr_b16 v[114:115], v6 offset:6496
    v_mfma_f32_16x16x32_bf16 v[44:47], v[88:91], v[72:75], v[44:47]
    ds_read_b64_tr_b16 v[116:117], v6 offset:5248
    ds_read_b64_tr_b16 v[118:119], v6 offset:6528
    v_mfma_f32_16x16x32_bf16 v[48:51], v[92:95], v[72:75], v[48:51]
    s_waitcnt lgkmcnt(0)
    s_barrier
    v_mfma_f32_16x16x32_bf16 v[32:35], v[100:103], v[96:99], v[32:35]
    ds_read_b128 v[72:75], v2 offset:18432
    ds_read_b64_tr_b16 v[76:77], v6 offset:18432
    ds_read_b64_tr_b16 v[78:79], v6 offset:19712
    v_mfma_f32_16x16x32_bf16 v[36:39], v[104:107], v[96:99], v[36:39]
    ds_read_b64_tr_b16 v[80:81], v6 offset:18464
    ds_read_b64_tr_b16 v[82:83], v6 offset:19744
    ds_read_b64_tr_b16 v[84:85], v6 offset:18496
    v_mfma_f32_16x16x32_bf16 v[40:43], v[108:111], v[96:99], v[40:43]
    ds_read_b64_tr_b16 v[86:87], v6 offset:19776
    ds_read_b64_tr_b16 v[88:89], v6 offset:18528
    ds_read_b64_tr_b16 v[90:91], v6 offset:19808
    v_mfma_f32_16x16x32_bf16 v[44:47], v[112:115], v[96:99], v[44:47]
    ds_read_b64_tr_b16 v[92:93], v6 offset:18560
    ds_read_b64_tr_b16 v[94:95], v6 offset:19840
    v_mfma_f32_16x16x32_bf16 v[48:51], v[116:119], v[96:99], v[48:51]
    s_waitcnt lgkmcnt(0)
    v_mfma_f32_16x16x32_bf16 v[32:35], v[76:79], v[72:75], v[32:35]
    ds_read_b128 v[96:99], v3 offset:18432
    ds_read_b64_tr_b16 v[100:101], v6 offset:23552
    ds_read_b64_tr_b16 v[102:103], v6 offset:24832
    v_mfma_f32_16x16x32_bf16 v[36:39], v[80:83], v[72:75], v[36:39]
    ds_read_b64_tr_b16 v[104:105], v6 offset:23584
    ds_read_b64_tr_b16 v[106:107], v6 offset:24864
    ds_read_b64_tr_b16 v[108:109], v6 offset:23616
    v_mfma_f32_16x16x32_bf16 v[40:43], v[84:87], v[72:75], v[40:43]
    ds_read_b64_tr_b16 v[110:111], v6 offset:24896
    ds_read_b64_tr_b16 v[112:113], v6 offset:23648
    ds_read_b64_tr_b16 v[114:115], v6 offset:24928
    v_mfma_f32_16x16x32_bf16 v[44:47], v[88:91], v[72:75], v[44:47]
    ds_read_b64_tr_b16 v[116:117], v6 offset:23680
    ds_read_b64_tr_b16 v[118:119], v6 offset:24960
    v_mfma_f32_16x16x32_bf16 v[48:51], v[92:95], v[72:75], v[48:51]
    s_waitcnt lgkmcnt(0)
    s_barrier
    v_mfma_f32_16x16x32_bf16 v[32:35], v[100:103], v[96:99], v[32:35]
    ds_read_b128 v[72:75], v2 offset:36864
    ds_read_b64_tr_b16 v[76:77], v6 offset:36864
    ds_read_b64_tr_b16 v[78:79], v6 offset:38144
    v_mfma_f32_16x16x32_bf16 v[36:39], v[104:107], v[96:99], v[36:39]
    ds_read_b64_tr_b16 v[80:81], v6 offset:36896
    ds_read_b64_tr_b16 v[82:83], v6 offset:38176
    ds_read_b64_tr_b16 v[84:85], v6 offset:36928
    v_mfma_f32_16x16x32_bf16 v[40:43], v[108:111], v[96:99], v[40:43]
    ds_read_b64_tr_b16 v[86:87], v6 offset:38208
    ds_read_b64_tr_b16 v[88:89], v6 offset:36960
    ds_read_b64_tr_b16 v[90:91], v6 offset:38240
    v_mfma_f32_16x16x32_bf16 v[44:47], v[112:115], v[96:99], v[44:47]
    ds_read_b64_tr_b16 v[92:93], v6 offset:36992
    ds_read_b64_tr_b16 v[94:95], v6 offset:38272
    v_mfma_f32_16x16x32_bf16 v[48:51], v[116:119], v[96:99], v[48:51]
    s_waitcnt lgkmcnt(0)
    v_mfma_f32_16x16x32_bf16 v[32:35], v[76:79], v[72:75], v[32:35]
    ds_read_b128 v[96:99], v3 offset:36864
    ds_read_b64_tr_b16 v[100:101], v6 offset:41984
    ds_read_b64_tr_b16 v[102:103], v6 offset:43264
    v_mfma_f32_16x16x32_bf16 v[36:39], v[80:83], v[72:75], v[36:39]
    ds_read_b64_tr_b16 v[104:105], v6 offset:42016
    ds_read_b64_tr_b16 v[106:107], v6 offset:43296
    ds_read_b64_tr_b16 v[108:109], v6 offset:42048
    v_mfma_f32_16x16x32_bf16 v[40:43], v[84:87], v[72:75], v[40:43]
    ds_read_b64_tr_b16 v[110:111], v6 offset:43328
    ds_read_b64_tr_b16 v[112:113], v6 offset:42080
    ds_read_b64_tr_b16 v[114:115], v6 offset:43360
    v_mfma_f32_16x16x32_bf16 v[44:47], v[88:91], v[72:75], v[44:47]
    ds_read_b64_tr_b16 v[116:117], v6 offset:42112
    ds_read_b64_tr_b16 v[118:119], v6 offset:43392
    v_mfma_f32_16x16x32_bf16 v[48:51], v[92:95], v[72:75], v[48:51]
    s_waitcnt lgkmcnt(0)
    s_barrier
    v_mfma_f32_16x16x32_bf16 v[32:35], v[100:103], v[96:99], v[32:35]
    ds_read_b128 v[72:75], v4 offset:0
    ds_read_b64_tr_b16 v[76:77], v7 offset:0
    ds_read_b64_tr_b16 v[78:79], v7 offset:1280
    v_mfma_f32_16x16x32_bf16 v[36:39], v[104:107], v[96:99], v[36:39]
    ds_read_b64_tr_b16 v[80:81], v7 offset:32
    ds_read_b64_tr_b16 v[82:83], v7 offset:1312
    ds_read_b64_tr_b16 v[84:85], v7 offset:64
    v_mfma_f32_16x16x32_bf16 v[40:43], v[108:111], v[96:99], v[40:43]
    ds_read_b64_tr_b16 v[86:87], v7 offset:1344
    ds_read_b64_tr_b16 v[88:89], v7 offset:96
    ds_read_b64_tr_b16 v[90:91], v7 offset:1376
    v_mfma_f32_16x16x32_bf16 v[44:47], v[112:115], v[96:99], v[44:47]
    ds_read_b64_tr_b16 v[92:93], v7 offset:128
    ds_read_b64_tr_b16 v[94:95], v7 offset:1408
    v_mfma_f32_16x16x32_bf16 v[48:51], v[116:119], v[96:99], v[48:51]
    s_waitcnt lgkmcnt(0)
    v_mfma_f32_16x16x32_bf16 v[32:35], v[76:79], v[72:75], v[32:35]
    ds_read_b128 v[96:99], v5 offset:0
    ds_read_b64_tr_b16 v[100:101], v7 offset:5120
    ds_read_b64_tr_b16 v[102:103], v7 offset:6400
    v_mfma_f32_16x16x32_bf16 v[36:39], v[80:83], v[72:75], v[36:39]
    ds_read_b64_tr_b16 v[104:105], v7 offset:5152
    ds_read_b64_tr_b16 v[106:107], v7 offset:6432
    ds_read_b64_tr_b16 v[108:109], v7 offset:5184
    v_mfma_f32_16x16x32_bf16 v[40:43], v[84:87], v[72:75], v[40:43]
    ds_read_b64_tr_b16 v[110:111], v7 offset:6464
    ds_read_b64_tr_b16 v[112:113], v7 offset:5216
    ds_read_b64_tr_b16 v[114:115], v7 offset:6496
    v_mfma_f32_16x16x32_bf16 v[44:47], v[88:91], v[72:75], v[44:47]
    ds_read_b64_tr_b16 v[116:117], v7 offset:5248
    ds_read_b64_tr_b16 v[118:119], v7 offset:6528
    v_mfma_f32_16x16x32_bf16 v[48:51], v[92:95], v[72:75], v[48:51]
    s_waitcnt lgkmcnt(0)
    s_barrier
    v_mfma_f32_16x16x32_bf16 v[32:35], v[100:103], v[96:99], v[32:35]
    ds_read_b128 v[72:75], v2 offset:0
    ds_read_b64_tr_b16 v[76:77], v6 offset:0
    ds_read_b64_tr_b16 v[78:79], v6 offset:1280
    v_mfma_f32_16x16x32_bf16 v[36:39], v[104:107], v[96:99], v[36:39]
    ds_read_b64_tr_b16 v[80:81], v6 offset:32
    ds_read_b64_tr_b16 v[82:83], v6 offset:1312
    ds_read_b64_tr_b16 v[84:85], v6 offset:64
    v_mfma_f32_16x16x32_bf16 v[40:43], v[108:111], v[96:99], v[40:43]
    ds_read_b64_tr_b16 v[86:87], v6 offset:1344
    ds_read_b64_tr_b16 v[88:89], v6 offset:96
    ds_read_b64_tr_b16 v[90:91], v6 offset:1376
    v_mfma_f32_16x16x32_bf16 v[44:47], v[112:115], v[96:99], v[44:47]
    ds_read_b64_tr_b16 v[92:93], v6 offset:128
    ds_read_b64_tr_b16 v[94:95], v6 offset:1408
    v_mfma_f32_16x16x32_bf16 v[48:51], v[116:119], v[96:99], v[48:51]
    s_waitcnt lgkmcnt(0)
    v_mfma_f32_16x16x32_bf16 v[32:35], v[76:79], v[72:75], v[32:35]
    ds_read_b128 v[96:99], v3 offset:0
    ds_read_b64_tr_b16 v[100:101], v6 offset:5120
    ds_read_b64_tr_b16 v[102:103], v6 offset:6400
    v_mfma_f32_16x16x32_bf16 v[36:39], v[80:83], v[72:75], v[36:39]
    ds_read_b64_tr_b16 v[104:105], v6 offset:5152
    ds_read_b64_tr_b16 v[106:107], v6 offset:6432
    ds_read_b64_tr_b16 v[108:109], v6 offset:5184
    v_mfma_f32_16x16x32_bf16 v[40:43], v[84:87], v[72:75], v[40:43]
    ds_read_b64_tr_b16 v[110:111], v6 offset:6464
    ds_read_b64_tr_b16 v[112:113], v6 offset:5216
    ds_read_b64_tr_b16 v[114:115], v6 offset:6496
    v_mfma_f32_16x16x32_bf16 v[44:47], v[88:91], v[72:75], v[44:47]
    ds_read_b64_tr_b16 v[116:117], v6 offset:5248
    ds_read_b64_tr_b16 v[118:119], v6 offset:6528
    v_mfma_f32_16x16x32_bf16 v[48:51], v[92:95], v[72:75], v[48:51]
    s_waitcnt lgkmcnt(0)
    s_barrier
    v_mfma_f32_16x16x32_bf16 v[32:35], v[100:103], v[96:99], v[32:35]
    ds_read_b128 v[72:75], v2 offset:18432
    ds_read_b64_tr_b16 v[76:77], v6 offset:18432
    ds_read_b64_tr_b16 v[78:79], v6 offset:19712
    v_mfma_f32_16x16x32_bf16 v[36:39], v[104:107], v[96:99], v[36:39]
    ds_read_b64_tr_b16 v[80:81], v6 offset:18464
    ds_read_b64_tr_b16 v[82:83], v6 offset:19744
    ds_read_b64_tr_b16 v[84:85], v6 offset:18496
    v_mfma_f32_16x16x32_bf16 v[40:43], v[108:111], v[96:99], v[40:43]
    ds_read_b64_tr_b16 v[86:87], v6 offset:19776
    ds_read_b64_tr_b16 v[88:89], v6 offset:18528
    ds_read_b64_tr_b16 v[90:91], v6 offset:19808
    v_mfma_f32_16x16x32_bf16 v[44:47], v[112:115], v[96:99], v[44:47]
    ds_read_b64_tr_b16 v[92:93], v6 offset:18560
    ds_read_b64_tr_b16 v[94:95], v6 offset:19840
    v_mfma_f32_16x16x32_bf16 v[48:51], v[116:119], v[96:99], v[48:51]
    s_waitcnt lgkmcnt(0)
    v_mfma_f32_16x16x32_bf16 v[32:35], v[76:79], v[72:75], v[32:35]
    ds_read_b128 v[96:99], v3 offset:18432
    ds_read_b64_tr_b16 v[100:101], v6 offset:23552
    ds_read_b64_tr_b16 v[102:103], v6 offset:24832
    v_mfma_f32_16x16x32_bf16 v[36:39], v[80:83], v[72:75], v[36:39]
    ds_read_b64_tr_b16 v[104:105], v6 offset:23584
    ds_read_b64_tr_b16 v[106:107], v6 offset:24864
    ds_read_b64_tr_b16 v[108:109], v6 offset:23616
    v_mfma_f32_16x16x32_bf16 v[40:43], v[84:87], v[72:75], v[40:43]
    ds_read_b64_tr_b16 v[110:111], v6 offset:24896
    ds_read_b64_tr_b16 v[112:113], v6 offset:23648
    ds_read_b64_tr_b16 v[114:115], v6 offset:24928
    v_mfma_f32_16x16x32_bf16 v[44:47], v[88:91], v[72:75], v[44:47]
    ds_read_b64_tr_b16 v[116:117], v6 offset:23680
    ds_read_b64_tr_b16 v[118:119], v6 offset:24960
    v_mfma_f32_16x16x32_bf16 v[48:51], v[92:95], v[72:75], v[48:51]
    s_waitcnt lgkmcnt(0)
    s_barrier
    v_mfma_f32_16x16x32_bf16 v[32:35], v[100:103], v[96:99], v[32:35]
    ds_read_b128 v[72:75], v2 offset:36864
    ds_read_b64_tr_b16 v[76:77], v6 offset:36864
    ds_read_b64_tr_b16 v[78:79], v6 offset:38144
    v_mfma_f32_16x16x32_bf16 v[36:39], v[104:107], v[96:99], v[36:39]
    ds_read_b64_tr_b16 v[80:81], v6 offset:36896
    ds_read_b64_tr_b16 v[82:83], v6 offset:38176
    ds_read_b64_tr_b16 v[84:85], v6 offset:36928
    v_mfma_f32_16x16x32_bf16 v[40:43], v[108:111], v[96:99], v[40:43]
    ds_read_b64_tr_b16 v[86:87], v6 offset:38208
    ds_read_b64_tr_b16 v[88:89], v6 offset:36960
    ds_read_b64_tr_b16 v[90:91], v6 offset:38240
    v_mfma_f32_16x16x32_bf16 v[44:47], v[112:115], v[96:99], v[44:47]
    ds_read_b64_tr_b16 v[92:93], v6 offset:36992
    ds_read_b64_tr_b16 v[94:95], v6 offset:38272
    v_mfma_f32_16x16x32_bf16 v[48:51], v[116:119], v[96:99], v[48:51]
    s_waitcnt lgkmcnt(0)
    v_mfma_f32_16x16x32_bf16 v[32:35], v[76:79], v[72:75], v[32:35]
    ds_read_b128 v[96:99], v3 offset:36864
    ds_read_b64_tr_b16 v[100:101], v6 offset:41984
    ds_read_b64_tr_b16 v[102:103], v6 offset:43264
    v_mfma_f32_16x16x32_bf16 v[36:39], v[80:83], v[72:75], v[36:39]
    ds_read_b64_tr_b16 v[104:105], v6 offset:42016
    ds_read_b64_tr_b16 v[106:107], v6 offset:43296
    ds_read_b64_tr_b16 v[108:109], v6 offset:42048
    v_mfma_f32_16x16x32_bf16 v[40:43], v[84:87], v[72:75], v[40:43]
    ds_read_b64_tr_b16 v[110:111], v6 offset:43328
    ds_read_b64_tr_b16 v[112:113], v6 offset:42080
    ds_read_b64_tr_b16 v[114:115], v6 offset:43360
    v_mfma_f32_16x16x32_bf16 v[44:47], v[88:91], v[72:75], v[44:47]
    ds_read_b64_tr_b16 v[116:117], v6 offset:42112
    ds_read_b64_tr_b16 v[118:119], v6 offset:43392
    v_mfma_f32_16x16x32_bf16 v[48:51], v[92:95], v[72:75], v[48:51]
    s_waitcnt lgkmcnt(0)
    s_barrier
    v_mfma_f32_16x16x32_bf16 v[32:35], v[100:103], v[96:99], v[32:35]
    ds_read_b128 v[72:75], v4 offset:0
    ds_read_b64_tr_b16 v[76:77], v7 offset:0
    ds_read_b64_tr_b16 v[78:79], v7 offset:1280
    v_mfma_f32_16x16x32_bf16 v[36:39], v[104:107], v[96:99], v[36:39]
    ds_read_b64_tr_b16 v[80:81], v7 offset:32
    ds_read_b64_tr_b16 v[82:83], v7 offset:1312
    ds_read_b64_tr_b16 v[84:85], v7 offset:64
    v_mfma_f32_16x16x32_bf16 v[40:43], v[108:111], v[96:99], v[40:43]
    ds_read_b64_tr_b16 v[86:87], v7 offset:1344
    ds_read_b64_tr_b16 v[88:89], v7 offset:96
    ds_read_b64_tr_b16 v[90:91], v7 offset:1376
    v_mfma_f32_16x16x32_bf16 v[44:47], v[112:115], v[96:99], v[44:47]
    ds_read_b64_tr_b16 v[92:93], v7 offset:128
    ds_read_b64_tr_b16 v[94:95], v7 offset:1408
    v_mfma_f32_16x16x32_bf16 v[48:51], v[116:119], v[96:99], v[48:51]
    s_waitcnt lgkmcnt(0)
    v_mfma_f32_16x16x32_bf16 v[32:35], v[76:79], v[72:75], v[32:35]
    ds_read_b128 v[96:99], v5 offset:0
    ds_read_b64_tr_b16 v[100:101], v7 offset:5120
    ds_read_b64_tr_b16 v[102:103], v7 offset:6400
    v_mfma_f32_16x16x32_bf16 v[36:39], v[80:83], v[72:75], v[36:39]
    ds_read_b64_tr_b16 v[104:105], v7 offset:5152
    ds_read_b64_tr_b16 v[106:107], v7 offset:6432
    ds_read_b64_tr_b16 v[108:109], v7 offset:5184
    v_mfma_f32_16x16x32_bf16 v[40:43], v[84:87], v[72:75], v[40:43]
    ds_read_b64_tr_b16 v[110:111], v7 offset:6464
    ds_read_b64_tr_b16 v[112:113], v7 offset:5216
    ds_read_b64_tr_b16 v[114:115], v7 offset:6496
    v_mfma_f32_16x16x32_bf16 v[44:47], v[88:91], v[72:75], v[44:47]
    ds_read_b64_tr_b16 v[116:117], v7 offset:5248
    ds_read_b64_tr_b16 v[118:119], v7 offset:6528
    v_mfma_f32_16x16x32_bf16 v[48:51], v[92:95], v[72:75], v[48:51]
    s_waitcnt lgkmcnt(0)
    s_barrier
    v_mfma_f32_16x16x32_bf16 v[32:35], v[100:103], v[96:99], v[32:35]
    ds_read_b128 v[72:75], v2 offset:0
    ds_read_b64_tr_b16 v[76:77], v6 offset:0
    ds_read_b64_tr_b16 v[78:79], v6 offset:1280
    v_mfma_f32_16x16x32_bf16 v[36:39], v[104:107], v[96:99], v[36:39]
    ds_read_b64_tr_b16 v[80:81], v6 offset:32
    ds_read_b64_tr_b16 v[82:83], v6 offset:1312
    ds_read_b64_tr_b16 v[84:85], v6 offset:64
    v_mfma_f32_16x16x32_bf16 v[40:43], v[108:111], v[96:99], v[40:43]
    ds_read_b64_tr_b16 v[86:87], v6 offset:1344
    ds_read_b64_tr_b16 v[88:89], v6 offset:96
    ds_read_b64_tr_b16 v[90:91], v6 offset:1376
    v_mfma_f32_16x16x32_bf16 v[44:47], v[112:115], v[96:99], v[44:47]
    ds_read_b64_tr_b16 v[92:93], v6 offset:128
    ds_read_b64_tr_b16 v[94:95], v6 offset:1408
    v_mfma_f32_16x16x32_bf16 v[48:51], v[116:119], v[96:99], v[48:51]
    s_waitcnt lgkmcnt(0)
    v_mfma_f32_16x16x32_bf16 v[32:35], v[76:79], v[72:75], v[32:35]
    ds_read_b128 v[96:99], v3 offset:0
    ds_read_b64_tr_b16 v[100:101], v6 offset:5120
    ds_read_b64_tr_b16 v[102:103], v6 offset:6400
    v_mfma_f32_16x16x32_bf16 v[36:39], v[80:83], v[72:75], v[36:39]
    ds_read_b64_tr_b16 v[104:105], v6 offset:5152
    ds_read_b64_tr_b16 v[106:107], v6 offset:6432
    ds_read_b64_tr_b16 v[108:109], v6 offset:5184
    v_mfma_f32_16x16x32_bf16 v[40:43], v[84:87], v[72:75], v[40:43]
    ds_read_b64_tr_b16 v[110:111], v6 offset:6464
    ds_read_b64_tr_b16 v[112:113], v6 offset:5216
    ds_read_b64_tr_b16 v[114:115], v6 offset:6496
    v_mfma_f32_16x16x32_bf16 v[44:47], v[88:91], v[72:75], v[44:47]
    ds_read_b64_tr_b16 v[116:117], v6 offset:5248
    ds_read_b64_tr_b16 v[118:119], v6 offset:6528
    v_mfma_f32_16x16x32_bf16 v[48:51], v[92:95], v[72:75], v[48:51]
    s_waitcnt lgkmcnt(0)
    s_barrier
    v_mfma_f32_16x16x32_bf16 v[32:35], v[100:103], v[96:99], v[32:35]
    ds_read_b128 v[72:75], v2 offset:18432
    ds_read_b64_tr_b16 v[76:77], v6 offset:18432
    ds_read_b64_tr_b16 v[78:79], v6 offset:19712
    v_mfma_f32_16x16x32_bf16 v[36:39], v[104:107], v[96:99], v[36:39]
    ds_read_b64_tr_b16 v[80:81], v6 offset:18464
    ds_read_b64_tr_b16 v[82:83], v6 offset:19744
    ds_read_b64_tr_b16 v[84:85], v6 offset:18496
    v_mfma_f32_16x16x32_bf16 v[40:43], v[108:111], v[96:99], v[40:43]
    ds_read_b64_tr_b16 v[86:87], v6 offset:19776
    ds_read_b64_tr_b16 v[88:89], v6 offset:18528
    ds_read_b64_tr_b16 v[90:91], v6 offset:19808
    v_mfma_f32_16x16x32_bf16 v[44:47], v[112:115], v[96:99], v[44:47]
    ds_read_b64_tr_b16 v[92:93], v6 offset:18560
    ds_read_b64_tr_b16 v[94:95], v6 offset:19840
    v_mfma_f32_16x16x32_bf16 v[48:51], v[116:119], v[96:99], v[48:51]
    s_waitcnt lgkmcnt(0)
    v_mfma_f32_16x16x32_bf16 v[32:35], v[76:79], v[72:75], v[32:35]
    ds_read_b128 v[96:99], v3 offset:18432
    ds_read_b64_tr_b16 v[100:101], v6 offset:23552
    ds_read_b64_tr_b16 v[102:103], v6 offset:24832
    v_mfma_f32_16x16x32_bf16 v[36:39], v[80:83], v[72:75], v[36:39]
    ds_read_b64_tr_b16 v[104:105], v6 offset:23584
    ds_read_b64_tr_b16 v[106:107], v6 offset:24864
    ds_read_b64_tr_b16 v[108:109], v6 offset:23616
    v_mfma_f32_16x16x32_bf16 v[40:43], v[84:87], v[72:75], v[40:43]
    ds_read_b64_tr_b16 v[110:111], v6 offset:24896
    ds_read_b64_tr_b16 v[112:113], v6 offset:23648
    ds_read_b64_tr_b16 v[114:115], v6 offset:24928
    v_mfma_f32_16x16x32_bf16 v[44:47], v[88:91], v[72:75], v[44:47]
    ds_read_b64_tr_b16 v[116:117], v6 offset:23680
    ds_read_b64_tr_b16 v[118:119], v6 offset:24960
    v_mfma_f32_16x16x32_bf16 v[48:51], v[92:95], v[72:75], v[48:51]
    s_waitcnt lgkmcnt(0)
    s_barrier
    v_mfma_f32_16x16x32_bf16 v[32:35], v[100:103], v[96:99], v[32:35]
    ds_read_b128 v[72:75], v2 offset:36864
    ds_read_b64_tr_b16 v[76:77], v6 offset:36864
    ds_read_b64_tr_b16 v[78:79], v6 offset:38144
    v_mfma_f32_16x16x32_bf16 v[36:39], v[104:107], v[96:99], v[36:39]
    ds_read_b64_tr_b16 v[80:81], v6 offset:36896
    ds_read_b64_tr_b16 v[82:83], v6 offset:38176
    ds_read_b64_tr_b16 v[84:85], v6 offset:36928
    v_mfma_f32_16x16x32_bf16 v[40:43], v[108:111], v[96:99], v[40:43]
    ds_read_b64_tr_b16 v[86:87], v6 offset:38208
    ds_read_b64_tr_b16 v[88:89], v6 offset:36960
    ds_read_b64_tr_b16 v[90:91], v6 offset:38240
    v_mfma_f32_16x16x32_bf16 v[44:47], v[112:115], v[96:99], v[44:47]
    ds_read_b64_tr_b16 v[92:93], v6 offset:36992
    ds_read_b64_tr_b16 v[94:95], v6 offset:38272
    v_mfma_f32_16x16x32_bf16 v[48:51], v[116:119], v[96:99], v[48:51]
    s_waitcnt lgkmcnt(0)
    v_mfma_f32_16x16x32_bf16 v[32:35], v[76:79], v[72:75], v[32:35]
    ds_read_b128 v[96:99], v3 offset:36864
    ds_read_b64_tr_b16 v[100:101], v6 offset:41984
    ds_read_b64_tr_b16 v[102:103], v6 offset:43264
    v_mfma_f32_16x16x32_bf16 v[36:39], v[80:83], v[72:75], v[36:39]
    ds_read_b64_tr_b16 v[104:105], v6 offset:42016
    ds_read_b64_tr_b16 v[106:107], v6 offset:43296
    ds_read_b64_tr_b16 v[108:109], v6 offset:42048
    v_mfma_f32_16x16x32_bf16 v[40:43], v[84:87], v[72:75], v[40:43]
    ds_read_b64_tr_b16 v[110:111], v6 offset:43328
    ds_read_b64_tr_b16 v[112:113], v6 offset:42080
    ds_read_b64_tr_b16 v[114:115], v6 offset:43360
    v_mfma_f32_16x16x32_bf16 v[44:47], v[88:91], v[72:75], v[44:47]
    ds_read_b64_tr_b16 v[116:117], v6 offset:42112
    ds_read_b64_tr_b16 v[118:119], v6 offset:43392
    v_mfma_f32_16x16x32_bf16 v[48:51], v[92:95], v[72:75], v[48:51]
    s_waitcnt lgkmcnt(0)
    s_barrier
    v_mfma_f32_16x16x32_bf16 v[32:35], v[100:103], v[96:99], v[32:35]
    ds_read_b128 v[72:75], v4 offset:0
    ds_read_b64_tr_b16 v[76:77], v7 offset:0
    ds_read_b64_tr_b16 v[78:79], v7 offset:1280
    v_mfma_f32_16x16x32_bf16 v[36:39], v[104:107], v[96:99], v[36:39]
    ds_read_b64_tr_b16 v[80:81], v7 offset:32
    ds_read_b64_tr_b16 v[82:83], v7 offset:1312
    ds_read_b64_tr_b16 v[84:85], v7 offset:64
    v_mfma_f32_16x16x32_bf16 v[40:43], v[108:111], v[96:99], v[40:43]
    ds_read_b64_tr_b16 v[86:87], v7 offset:1344
    ds_read_b64_tr_b16 v[88:89], v7 offset:96
    ds_read_b64_tr_b16 v[90:91], v7 offset:1376
    v_mfma_f32_16x16x32_bf16 v[44:47], v[112:115], v[96:99], v[44:47]
    ds_read_b64_tr_b16 v[92:93], v7 offset:128
    ds_read_b64_tr_b16 v[94:95], v7 offset:1408
    v_mfma_f32_16x16x32_bf16 v[48:51], v[116:119], v[96:99], v[48:51]
    s_waitcnt lgkmcnt(0)
    v_mfma_f32_16x16x32_bf16 v[32:35], v[76:79], v[72:75], v[32:35]
    ds_read_b128 v[96:99], v5 offset:0
    ds_read_b64_tr_b16 v[100:101], v7 offset:5120
    ds_read_b64_tr_b16 v[102:103], v7 offset:6400
    v_mfma_f32_16x16x32_bf16 v[36:39], v[80:83], v[72:75], v[36:39]
    ds_read_b64_tr_b16 v[104:105], v7 offset:5152
    ds_read_b64_tr_b16 v[106:107], v7 offset:6432
    ds_read_b64_tr_b16 v[108:109], v7 offset:5184
    v_mfma_f32_16x16x32_bf16 v[40:43], v[84:87], v[72:75], v[40:43]
    ds_read_b64_tr_b16 v[110:111], v7 offset:6464
    ds_read_b64_tr_b16 v[112:113], v7 offset:5216
    ds_read_b64_tr_b16 v[114:115], v7 offset:6496
    v_mfma_f32_16x16x32_bf16 v[44:47], v[88:91], v[72:75], v[44:47]
    ds_read_b64_tr_b16 v[116:117], v7 offset:5248
    ds_read_b64_tr_b16 v[118:119], v7 offset:6528
    v_mfma_f32_16x16x32_bf16 v[48:51], v[92:95], v[72:75], v[48:51]
    s_waitcnt lgkmcnt(0)
    v_mfma_f32_16x16x32_bf16 v[32:35], v[100:103], v[96:99], v[32:35]
    v_mfma_f32_16x16x32_bf16 v[36:39], v[104:107], v[96:99], v[36:39]
    v_mfma_f32_16x16x32_bf16 v[40:43], v[108:111], v[96:99], v[40:43]
    v_mfma_f32_16x16x32_bf16 v[44:47], v[112:115], v[96:99], v[44:47]
    v_mfma_f32_16x16x32_bf16 v[48:51], v[116:119], v[96:99], v[48:51]
    s_barrier
    s_setprio 0
    s_barrier
    ds_read_b64_tr_b16 v[72:73], v8 offset:0
    ds_read_b64_tr_b16 v[74:75], v8 offset:512
    ds_read_b64_tr_b16 v[76:77], v6 offset:0
    ds_read_b64_tr_b16 v[78:79], v6 offset:1280
    ds_read_b64_tr_b16 v[80:81], v6 offset:32
    ds_read_b64_tr_b16 v[82:83], v6 offset:1312
    ds_read_b64_tr_b16 v[84:85], v6 offset:64
    ds_read_b64_tr_b16 v[86:87], v6 offset:1344
    ds_read_b64_tr_b16 v[88:89], v6 offset:96
    ds_read_b64_tr_b16 v[90:91], v6 offset:1376
    ds_read_b64_tr_b16 v[92:93], v6 offset:128
    ds_read_b64_tr_b16 v[94:95], v6 offset:1408
    s_waitcnt lgkmcnt(0)
    v_mfma_f32_16x16x32_bf16 v[52:55], v[76:79], v[72:75], 0
    ds_read_b64_tr_b16 v[96:97], v8 offset:4096
    ds_read_b64_tr_b16 v[98:99], v8 offset:4608
    ds_read_b64_tr_b16 v[100:101], v6 offset:5120
    v_mfma_f32_16x16x32_bf16 v[56:59], v[80:83], v[72:75], 0
    ds_read_b64_tr_b16 v[102:103], v6 offset:6400
    ds_read_b64_tr_b16 v[104:105], v6 offset:5152
    ds_read_b64_tr_b16 v[106:107], v6 offset:6432
    v_mfma_f32_16x16x32_bf16 v[60:63], v[84:87], v[72:75], 0
    ds_read_b64_tr_b16 v[108:109], v6 offset:5184
    ds_read_b64_tr_b16 v[110:111], v6 offset:6464
    ds_read_b64_tr_b16 v[112:113], v6 offset:5216
    v_mfma_f32_16x16x32_bf16 v[64:67], v[88:91], v[72:75], 0
    ds_read_b64_tr_b16 v[114:115], v6 offset:6496
    ds_read_b64_tr_b16 v[116:117], v6 offset:5248
    ds_read_b64_tr_b16 v[118:119], v6 offset:6528
    v_mfma_f32_16x16x32_bf16 v[68:71], v[92:95], v[72:75], 0
    s_waitcnt lgkmcnt(0)
    s_barrier
    v_mfma_f32_16x16x32_bf16 v[52:55], v[100:103], v[96:99], v[52:55]
    ds_read_b64_tr_b16 v[72:73], v8 offset:18432
    ds_read_b64_tr_b16 v[74:75], v8 offset:18944
    ds_read_b64_tr_b16 v[76:77], v6 offset:18432
    v_mfma_f32_16x16x32_bf16 v[56:59], v[104:107], v[96:99], v[56:59]
    ds_read_b64_tr_b16 v[78:79], v6 offset:19712
    ds_read_b64_tr_b16 v[80:81], v6 offset:18464
    ds_read_b64_tr_b16 v[82:83], v6 offset:19744
    v_mfma_f32_16x16x32_bf16 v[60:63], v[108:111], v[96:99], v[60:63]
    ds_read_b64_tr_b16 v[84:85], v6 offset:18496
    ds_read_b64_tr_b16 v[86:87], v6 offset:19776
    ds_read_b64_tr_b16 v[88:89], v6 offset:18528
    v_mfma_f32_16x16x32_bf16 v[64:67], v[112:115], v[96:99], v[64:67]
    ds_read_b64_tr_b16 v[90:91], v6 offset:19808
    ds_read_b64_tr_b16 v[92:93], v6 offset:18560
    ds_read_b64_tr_b16 v[94:95], v6 offset:19840
    v_mfma_f32_16x16x32_bf16 v[68:71], v[116:119], v[96:99], v[68:71]
    s_waitcnt lgkmcnt(0)
    v_mfma_f32_16x16x32_bf16 v[52:55], v[76:79], v[72:75], v[52:55]
    ds_read_b64_tr_b16 v[96:97], v8 offset:22528
    ds_read_b64_tr_b16 v[98:99], v8 offset:23040
    ds_read_b64_tr_b16 v[100:101], v6 offset:23552
    v_mfma_f32_16x16x32_bf16 v[56:59], v[80:83], v[72:75], v[56:59]
    ds_read_b64_tr_b16 v[102:103], v6 offset:24832
    ds_read_b64_tr_b16 v[104:105], v6 offset:23584
    ds_read_b64_tr_b16 v[106:107], v6 offset:24864
    v_mfma_f32_16x16x32_bf16 v[60:63], v[84:87], v[72:75], v[60:63]
    ds_read_b64_tr_b16 v[108:109], v6 offset:23616
    ds_read_b64_tr_b16 v[110:111], v6 offset:24896
    ds_read_b64_tr_b16 v[112:113], v6 offset:23648
    v_mfma_f32_16x16x32_bf16 v[64:67], v[88:91], v[72:75], v[64:67]
    ds_read_b64_tr_b16 v[114:115], v6 offset:24928
    ds_read_b64_tr_b16 v[116:117], v6 offset:23680
    ds_read_b64_tr_b16 v[118:119], v6 offset:24960
    v_mfma_f32_16x16x32_bf16 v[68:71], v[92:95], v[72:75], v[68:71]
    s_waitcnt lgkmcnt(0)
    s_barrier
    v_mfma_f32_16x16x32_bf16 v[52:55], v[100:103], v[96:99], v[52:55]
    ds_read_b64_tr_b16 v[72:73], v8 offset:36864
    ds_read_b64_tr_b16 v[74:75], v8 offset:37376
    ds_read_b64_tr_b16 v[76:77], v6 offset:36864
    v_mfma_f32_16x16x32_bf16 v[56:59], v[104:107], v[96:99], v[56:59]
    ds_read_b64_tr_b16 v[78:79], v6 offset:38144
    ds_read_b64_tr_b16 v[80:81], v6 offset:36896
    ds_read_b64_tr_b16 v[82:83], v6 offset:38176
    v_mfma_f32_16x16x32_bf16 v[60:63], v[108:111], v[96:99], v[60:63]
    ds_read_b64_tr_b16 v[84:85], v6 offset:36928
    ds_read_b64_tr_b16 v[86:87], v6 offset:38208
    ds_read_b64_tr_b16 v[88:89], v6 offset:36960
    v_mfma_f32_16x16x32_bf16 v[64:67], v[112:115], v[96:99], v[64:67]
    ds_read_b64_tr_b16 v[90:91], v6 offset:38240
    ds_read_b64_tr_b16 v[92:93], v6 offset:36992
    ds_read_b64_tr_b16 v[94:95], v6 offset:38272
    v_mfma_f32_16x16x32_bf16 v[68:71], v[116:119], v[96:99], v[68:71]
    s_waitcnt lgkmcnt(0)
    v_mfma_f32_16x16x32_bf16 v[52:55], v[76:79], v[72:75], v[52:55]
    ds_read_b64_tr_b16 v[96:97], v8 offset:40960
    ds_read_b64_tr_b16 v[98:99], v8 offset:41472
    ds_read_b64_tr_b16 v[100:101], v6 offset:41984
    v_mfma_f32_16x16x32_bf16 v[56:59], v[80:83], v[72:75], v[56:59]
    ds_read_b64_tr_b16 v[102:103], v6 offset:43264
    ds_read_b64_tr_b16 v[104:105], v6 offset:42016
    ds_read_b64_tr_b16 v[106:107], v6 offset:43296
    v_mfma_f32_16x16x32_bf16 v[60:63], v[84:87], v[72:75], v[60:63]
    ds_read_b64_tr_b16 v[108:109], v6 offset:42048
    ds_read_b64_tr_b16 v[110:111], v6 offset:43328
    ds_read_b64_tr_b16 v[112:113], v6 offset:42080
    v_mfma_f32_16x16x32_bf16 v[64:67], v[88:91], v[72:75], v[64:67]
    ds_read_b64_tr_b16 v[114:115], v6 offset:43360
    ds_read_b64_tr_b16 v[116:117], v6 offset:42112
    ds_read_b64_tr_b16 v[118:119], v6 offset:43392
    v_mfma_f32_16x16x32_bf16 v[68:71], v[92:95], v[72:75], v[68:71]
    s_waitcnt lgkmcnt(0)
    s_barrier
    v_mfma_f32_16x16x32_bf16 v[52:55], v[100:103], v[96:99], v[52:55]
    ds_read_b64_tr_b16 v[72:73], v9 offset:0
    ds_read_b64_tr_b16 v[74:75], v9 offset:512
    ds_read_b64_tr_b16 v[76:77], v7 offset:0
    v_mfma_f32_16x16x32_bf16 v[56:59], v[104:107], v[96:99], v[56:59]
    ds_read_b64_tr_b16 v[78:79], v7 offset:1280
    ds_read_b64_tr_b16 v[80:81], v7 offset:32
    ds_read_b64_tr_b16 v[82:83], v7 offset:1312
    v_mfma_f32_16x16x32_bf16 v[60:63], v[108:111], v[96:99], v[60:63]
    ds_read_b64_tr_b16 v[84:85], v7 offset:64
    ds_read_b64_tr_b16 v[86:87], v7 offset:1344
    ds_read_b64_tr_b16 v[88:89], v7 offset:96
    v_mfma_f32_16x16x32_bf16 v[64:67], v[112:115], v[96:99], v[64:67]
    ds_read_b64_tr_b16 v[90:91], v7 offset:1376
    ds_read_b64_tr_b16 v[92:93], v7 offset:128
    ds_read_b64_tr_b16 v[94:95], v7 offset:1408
    v_mfma_f32_16x16x32_bf16 v[68:71], v[116:119], v[96:99], v[68:71]
    s_waitcnt lgkmcnt(0)
    v_mfma_f32_16x16x32_bf16 v[52:55], v[76:79], v[72:75], v[52:55]
    ds_read_b64_tr_b16 v[96:97], v9 offset:4096
    ds_read_b64_tr_b16 v[98:99], v9 offset:4608
    ds_read_b64_tr_b16 v[100:101], v7 offset:5120
    v_mfma_f32_16x16x32_bf16 v[56:59], v[80:83], v[72:75], v[56:59]
    ds_read_b64_tr_b16 v[102:103], v7 offset:6400
    ds_read_b64_tr_b16 v[104:105], v7 offset:5152
    ds_read_b64_tr_b16 v[106:107], v7 offset:6432
    v_mfma_f32_16x16x32_bf16 v[60:63], v[84:87], v[72:75], v[60:63]
    ds_read_b64_tr_b16 v[108:109], v7 offset:5184
    ds_read_b64_tr_b16 v[110:111], v7 offset:6464
    ds_read_b64_tr_b16 v[112:113], v7 offset:5216
    v_mfma_f32_16x16x32_bf16 v[64:67], v[88:91], v[72:75], v[64:67]
    ds_read_b64_tr_b16 v[114:115], v7 offset:6496
    ds_read_b64_tr_b16 v[116:117], v7 offset:5248
    ds_read_b64_tr_b16 v[118:119], v7 offset:6528
    v_mfma_f32_16x16x32_bf16 v[68:71], v[92:95], v[72:75], v[68:71]
    s_waitcnt lgkmcnt(0)
    s_barrier
    v_mfma_f32_16x16x32_bf16 v[52:55], v[100:103], v[96:99], v[52:55]
    ds_read_b64_tr_b16 v[72:73], v8 offset:0
    ds_read_b64_tr_b16 v[74:75], v8 offset:512
    ds_read_b64_tr_b16 v[76:77], v6 offset:0
    v_mfma_f32_16x16x32_bf16 v[56:59], v[104:107], v[96:99], v[56:59]
    ds_read_b64_tr_b16 v[78:79], v6 offset:1280
    ds_read_b64_tr_b16 v[80:81], v6 offset:32
    ds_read_b64_tr_b16 v[82:83], v6 offset:1312
    v_mfma_f32_16x16x32_bf16 v[60:63], v[108:111], v[96:99], v[60:63]
    ds_read_b64_tr_b16 v[84:85], v6 offset:64
    ds_read_b64_tr_b16 v[86:87], v6 offset:1344
    ds_read_b64_tr_b16 v[88:89], v6 offset:96
    v_mfma_f32_16x16x32_bf16 v[64:67], v[112:115], v[96:99], v[64:67]
    ds_read_b64_tr_b16 v[90:91], v6 offset:1376
    ds_read_b64_tr_b16 v[92:93], v6 offset:128
    ds_read_b64_tr_b16 v[94:95], v6 offset:1408
    v_mfma_f32_16x16x32_bf16 v[68:71], v[116:119], v[96:99], v[68:71]
    s_waitcnt lgkmcnt(0)
    v_mfma_f32_16x16x32_bf16 v[52:55], v[76:79], v[72:75], v[52:55]
    ds_read_b64_tr_b16 v[96:97], v8 offset:4096
    ds_read_b64_tr_b16 v[98:99], v8 offset:4608
    ds_read_b64_tr_b16 v[100:101], v6 offset:5120
    v_mfma_f32_16x16x32_bf16 v[56:59], v[80:83], v[72:75], v[56:59]
    ds_read_b64_tr_b16 v[102:103], v6 offset:6400
    ds_read_b64_tr_b16 v[104:105], v6 offset:5152
    ds_read_b64_tr_b16 v[106:107], v6 offset:6432
    v_mfma_f32_16x16x32_bf16 v[60:63], v[84:87], v[72:75], v[60:63]
    ds_read_b64_tr_b16 v[108:109], v6 offset:5184
    ds_read_b64_tr_b16 v[110:111], v6 offset:6464
    ds_read_b64_tr_b16 v[112:113], v6 offset:5216
    v_mfma_f32_16x16x32_bf16 v[64:67], v[88:91], v[72:75], v[64:67]
    ds_read_b64_tr_b16 v[114:115], v6 offset:6496
    ds_read_b64_tr_b16 v[116:117], v6 offset:5248
    ds_read_b64_tr_b16 v[118:119], v6 offset:6528
    v_mfma_f32_16x16x32_bf16 v[68:71], v[92:95], v[72:75], v[68:71]
    s_waitcnt lgkmcnt(0)
    s_barrier
    v_mfma_f32_16x16x32_bf16 v[52:55], v[100:103], v[96:99], v[52:55]
    ds_read_b64_tr_b16 v[72:73], v8 offset:18432
    ds_read_b64_tr_b16 v[74:75], v8 offset:18944
    ds_read_b64_tr_b16 v[76:77], v6 offset:18432
    v_mfma_f32_16x16x32_bf16 v[56:59], v[104:107], v[96:99], v[56:59]
    ds_read_b64_tr_b16 v[78:79], v6 offset:19712
    ds_read_b64_tr_b16 v[80:81], v6 offset:18464
    ds_read_b64_tr_b16 v[82:83], v6 offset:19744
    v_mfma_f32_16x16x32_bf16 v[60:63], v[108:111], v[96:99], v[60:63]
    ds_read_b64_tr_b16 v[84:85], v6 offset:18496
    ds_read_b64_tr_b16 v[86:87], v6 offset:19776
    ds_read_b64_tr_b16 v[88:89], v6 offset:18528
    v_mfma_f32_16x16x32_bf16 v[64:67], v[112:115], v[96:99], v[64:67]
    ds_read_b64_tr_b16 v[90:91], v6 offset:19808
    ds_read_b64_tr_b16 v[92:93], v6 offset:18560
    ds_read_b64_tr_b16 v[94:95], v6 offset:19840
    v_mfma_f32_16x16x32_bf16 v[68:71], v[116:119], v[96:99], v[68:71]
    s_waitcnt lgkmcnt(0)
    v_mfma_f32_16x16x32_bf16 v[52:55], v[76:79], v[72:75], v[52:55]
    ds_read_b64_tr_b16 v[96:97], v8 offset:22528
    ds_read_b64_tr_b16 v[98:99], v8 offset:23040
    ds_read_b64_tr_b16 v[100:101], v6 offset:23552
    v_mfma_f32_16x16x32_bf16 v[56:59], v[80:83], v[72:75], v[56:59]
    ds_read_b64_tr_b16 v[102:103], v6 offset:24832
    ds_read_b64_tr_b16 v[104:105], v6 offset:23584
    ds_read_b64_tr_b16 v[106:107], v6 offset:24864
    v_mfma_f32_16x16x32_bf16 v[60:63], v[84:87], v[72:75], v[60:63]
    ds_read_b64_tr_b16 v[108:109], v6 offset:23616
    ds_read_b64_tr_b16 v[110:111], v6 offset:24896
    ds_read_b64_tr_b16 v[112:113], v6 offset:23648
    v_mfma_f32_16x16x32_bf16 v[64:67], v[88:91], v[72:75], v[64:67]
    ds_read_b64_tr_b16 v[114:115], v6 offset:24928
    ds_read_b64_tr_b16 v[116:117], v6 offset:23680
    ds_read_b64_tr_b16 v[118:119], v6 offset:24960
    v_mfma_f32_16x16x32_bf16 v[68:71], v[92:95], v[72:75], v[68:71]
    s_waitcnt lgkmcnt(0)
    s_barrier
    v_mfma_f32_16x16x32_bf16 v[52:55], v[100:103], v[96:99], v[52:55]
    ds_read_b64_tr_b16 v[72:73], v8 offset:36864
    ds_read_b64_tr_b16 v[74:75], v8 offset:37376
    ds_read_b64_tr_b16 v[76:77], v6 offset:36864
    v_mfma_f32_16x16x32_bf16 v[56:59], v[104:107], v[96:99], v[56:59]
    ds_read_b64_tr_b16 v[78:79], v6 offset:38144
    ds_read_b64_tr_b16 v[80:81], v6 offset:36896
    ds_read_b64_tr_b16 v[82:83], v6 offset:38176
    v_mfma_f32_16x16x32_bf16 v[60:63], v[108:111], v[96:99], v[60:63]
    ds_read_b64_tr_b16 v[84:85], v6 offset:36928
    ds_read_b64_tr_b16 v[86:87], v6 offset:38208
    ds_read_b64_tr_b16 v[88:89], v6 offset:36960
    v_mfma_f32_16x16x32_bf16 v[64:67], v[112:115], v[96:99], v[64:67]
    ds_read_b64_tr_b16 v[90:91], v6 offset:38240
    ds_read_b64_tr_b16 v[92:93], v6 offset:36992
    ds_read_b64_tr_b16 v[94:95], v6 offset:38272
    v_mfma_f32_16x16x32_bf16 v[68:71], v[116:119], v[96:99], v[68:71]
    s_waitcnt lgkmcnt(0)
    v_mfma_f32_16x16x32_bf16 v[52:55], v[76:79], v[72:75], v[52:55]
    ds_read_b64_tr_b16 v[96:97], v8 offset:40960
    ds_read_b64_tr_b16 v[98:99], v8 offset:41472
    ds_read_b64_tr_b16 v[100:101], v6 offset:41984
    v_mfma_f32_16x16x32_bf16 v[56:59], v[80:83], v[72:75], v[56:59]
    ds_read_b64_tr_b16 v[102:103], v6 offset:43264
    ds_read_b64_tr_b16 v[104:105], v6 offset:42016
    ds_read_b64_tr_b16 v[106:107], v6 offset:43296
    v_mfma_f32_16x16x32_bf16 v[60:63], v[84:87], v[72:75], v[60:63]
    ds_read_b64_tr_b16 v[108:109], v6 offset:42048
    ds_read_b64_tr_b16 v[110:111], v6 offset:43328
    ds_read_b64_tr_b16 v[112:113], v6 offset:42080
    v_mfma_f32_16x16x32_bf16 v[64:67], v[88:91], v[72:75], v[64:67]
    ds_read_b64_tr_b16 v[114:115], v6 offset:43360
    ds_read_b64_tr_b16 v[116:117], v6 offset:42112
    ds_read_b64_tr_b16 v[118:119], v6 offset:43392
    v_mfma_f32_16x16x32_bf16 v[68:71], v[92:95], v[72:75], v[68:71]
    s_waitcnt lgkmcnt(0)
    s_barrier
    v_mfma_f32_16x16x32_bf16 v[52:55], v[100:103], v[96:99], v[52:55]
    ds_read_b64_tr_b16 v[72:73], v9 offset:0
    ds_read_b64_tr_b16 v[74:75], v9 offset:512
    ds_read_b64_tr_b16 v[76:77], v7 offset:0
    v_mfma_f32_16x16x32_bf16 v[56:59], v[104:107], v[96:99], v[56:59]
    ds_read_b64_tr_b16 v[78:79], v7 offset:1280
    ds_read_b64_tr_b16 v[80:81], v7 offset:32
    ds_read_b64_tr_b16 v[82:83], v7 offset:1312
    v_mfma_f32_16x16x32_bf16 v[60:63], v[108:111], v[96:99], v[60:63]
    ds_read_b64_tr_b16 v[84:85], v7 offset:64
    ds_read_b64_tr_b16 v[86:87], v7 offset:1344
    ds_read_b64_tr_b16 v[88:89], v7 offset:96
    v_mfma_f32_16x16x32_bf16 v[64:67], v[112:115], v[96:99], v[64:67]
    ds_read_b64_tr_b16 v[90:91], v7 offset:1376
    ds_read_b64_tr_b16 v[92:93], v7 offset:128
    ds_read_b64_tr_b16 v[94:95], v7 offset:1408
    v_mfma_f32_16x16x32_bf16 v[68:71], v[116:119], v[96:99], v[68:71]
    s_waitcnt lgkmcnt(0)
    v_mfma_f32_16x16x32_bf16 v[52:55], v[76:79], v[72:75], v[52:55]
    ds_read_b64_tr_b16 v[96:97], v9 offset:4096
    ds_read_b64_tr_b16 v[98:99], v9 offset:4608
    ds_read_b64_tr_b16 v[100:101], v7 offset:5120
    v_mfma_f32_16x16x32_bf16 v[56:59], v[80:83], v[72:75], v[56:59]
    ds_read_b64_tr_b16 v[102:103], v7 offset:6400
    ds_read_b64_tr_b16 v[104:105], v7 offset:5152
    ds_read_b64_tr_b16 v[106:107], v7 offset:6432
    v_mfma_f32_16x16x32_bf16 v[60:63], v[84:87], v[72:75], v[60:63]
    ds_read_b64_tr_b16 v[108:109], v7 offset:5184
    ds_read_b64_tr_b16 v[110:111], v7 offset:6464
    ds_read_b64_tr_b16 v[112:113], v7 offset:5216
    v_mfma_f32_16x16x32_bf16 v[64:67], v[88:91], v[72:75], v[64:67]
    ds_read_b64_tr_b16 v[114:115], v7 offset:6496
    ds_read_b64_tr_b16 v[116:117], v7 offset:5248
    ds_read_b64_tr_b16 v[118:119], v7 offset:6528
    v_mfma_f32_16x16x32_bf16 v[68:71], v[92:95], v[72:75], v[68:71]
    s_waitcnt lgkmcnt(0)
    s_barrier
    v_mfma_f32_16x16x32_bf16 v[52:55], v[100:103], v[96:99], v[52:55]
    ds_read_b64_tr_b16 v[72:73], v8 offset:0
    ds_read_b64_tr_b16 v[74:75], v8 offset:512
    ds_read_b64_tr_b16 v[76:77], v6 offset:0
    v_mfma_f32_16x16x32_bf16 v[56:59], v[104:107], v[96:99], v[56:59]
    ds_read_b64_tr_b16 v[78:79], v6 offset:1280
    ds_read_b64_tr_b16 v[80:81], v6 offset:32
    ds_read_b64_tr_b16 v[82:83], v6 offset:1312
    v_mfma_f32_16x16x32_bf16 v[60:63], v[108:111], v[96:99], v[60:63]
    ds_read_b64_tr_b16 v[84:85], v6 offset:64
    ds_read_b64_tr_b16 v[86:87], v6 offset:1344
    ds_read_b64_tr_b16 v[88:89], v6 offset:96
    v_mfma_f32_16x16x32_bf16 v[64:67], v[112:115], v[96:99], v[64:67]
    ds_read_b64_tr_b16 v[90:91], v6 offset:1376
    ds_read_b64_tr_b16 v[92:93], v6 offset:128
    ds_read_b64_tr_b16 v[94:95], v6 offset:1408
    v_mfma_f32_16x16x32_bf16 v[68:71], v[116:119], v[96:99], v[68:71]
    s_waitcnt lgkmcnt(0)
    v_mfma_f32_16x16x32_bf16 v[52:55], v[76:79], v[72:75], v[52:55]
    ds_read_b64_tr_b16 v[96:97], v8 offset:4096
    ds_read_b64_tr_b16 v[98:99], v8 offset:4608
    ds_read_b64_tr_b16 v[100:101], v6 offset:5120
    v_mfma_f32_16x16x32_bf16 v[56:59], v[80:83], v[72:75], v[56:59]
    ds_read_b64_tr_b16 v[102:103], v6 offset:6400
    ds_read_b64_tr_b16 v[104:105], v6 offset:5152
    ds_read_b64_tr_b16 v[106:107], v6 offset:6432
    v_mfma_f32_16x16x32_bf16 v[60:63], v[84:87], v[72:75], v[60:63]
    ds_read_b64_tr_b16 v[108:109], v6 offset:5184
    ds_read_b64_tr_b16 v[110:111], v6 offset:6464
    ds_read_b64_tr_b16 v[112:113], v6 offset:5216
    v_mfma_f32_16x16x32_bf16 v[64:67], v[88:91], v[72:75], v[64:67]
    ds_read_b64_tr_b16 v[114:115], v6 offset:6496
    ds_read_b64_tr_b16 v[116:117], v6 offset:5248
    ds_read_b64_tr_b16 v[118:119], v6 offset:6528
    v_mfma_f32_16x16x32_bf16 v[68:71], v[92:95], v[72:75], v[68:71]
    s_waitcnt lgkmcnt(0)
    s_barrier
    v_mfma_f32_16x16x32_bf16 v[52:55], v[100:103], v[96:99], v[52:55]
    ds_read_b64_tr_b16 v[72:73], v8 offset:18432
    ds_read_b64_tr_b16 v[74:75], v8 offset:18944
    ds_read_b64_tr_b16 v[76:77], v6 offset:18432
    v_mfma_f32_16x16x32_bf16 v[56:59], v[104:107], v[96:99], v[56:59]
    ds_read_b64_tr_b16 v[78:79], v6 offset:19712
    ds_read_b64_tr_b16 v[80:81], v6 offset:18464
    ds_read_b64_tr_b16 v[82:83], v6 offset:19744
    v_mfma_f32_16x16x32_bf16 v[60:63], v[108:111], v[96:99], v[60:63]
    ds_read_b64_tr_b16 v[84:85], v6 offset:18496
    ds_read_b64_tr_b16 v[86:87], v6 offset:19776
    ds_read_b64_tr_b16 v[88:89], v6 offset:18528
    v_mfma_f32_16x16x32_bf16 v[64:67], v[112:115], v[96:99], v[64:67]
    ds_read_b64_tr_b16 v[90:91], v6 offset:19808
    ds_read_b64_tr_b16 v[92:93], v6 offset:18560
    ds_read_b64_tr_b16 v[94:95], v6 offset:19840
    v_mfma_f32_16x16x32_bf16 v[68:71], v[116:119], v[96:99], v[68:71]
    s_waitcnt lgkmcnt(0)
    v_mfma_f32_16x16x32_bf16 v[52:55], v[76:79], v[72:75], v[52:55]
    ds_read_b64_tr_b16 v[96:97], v8 offset:22528
    ds_read_b64_tr_b16 v[98:99], v8 offset:23040
    ds_read_b64_tr_b16 v[100:101], v6 offset:23552
    v_mfma_f32_16x16x32_bf16 v[56:59], v[80:83], v[72:75], v[56:59]
    ds_read_b64_tr_b16 v[102:103], v6 offset:24832
    ds_read_b64_tr_b16 v[104:105], v6 offset:23584
    ds_read_b64_tr_b16 v[106:107], v6 offset:24864
    v_mfma_f32_16x16x32_bf16 v[60:63], v[84:87], v[72:75], v[60:63]
    ds_read_b64_tr_b16 v[108:109], v6 offset:23616
    ds_read_b64_tr_b16 v[110:111], v6 offset:24896
    ds_read_b64_tr_b16 v[112:113], v6 offset:23648
    v_mfma_f32_16x16x32_bf16 v[64:67], v[88:91], v[72:75], v[64:67]
    ds_read_b64_tr_b16 v[114:115], v6 offset:24928
    ds_read_b64_tr_b16 v[116:117], v6 offset:23680
    ds_read_b64_tr_b16 v[118:119], v6 offset:24960
    v_mfma_f32_16x16x32_bf16 v[68:71], v[92:95], v[72:75], v[68:71]
    s_waitcnt lgkmcnt(0)
    v_mfma_f32_16x16x32_bf16 v[52:55], v[100:103], v[96:99], v[52:55]
    v_mfma_f32_16x16x32_bf16 v[56:59], v[104:107], v[96:99], v[56:59]
    v_mfma_f32_16x16x32_bf16 v[60:63], v[108:111], v[96:99], v[60:63]
    v_mfma_f32_16x16x32_bf16 v[64:67], v[112:115], v[96:99], v[64:67]
    v_mfma_f32_16x16x32_bf16 v[68:71], v[116:119], v[96:99], v[68:71]
    s_nop 7
    s_setprio 3
    v_sub_f32 v22, 1.0, v23
    v_mul_u32_u24 v24, 1280, v20
    v_lshl_add_u32 v24, v21, 1, v24
    v_mul_f32 v32, v22, v32
    v_fmac_f32 v32, v23, v52
    v_mul_f32 v33, v22, v33
    v_fmac_f32 v33, v23, v53
    v_mul_f32 v34, v22, v34
    v_fmac_f32 v34, v23, v54
    v_mul_f32 v35, v22, v35
    v_fmac_f32 v35, v23, v55
    v_cvt_pk_bf16_f32 v72, v32, v33
    v_cvt_pk_bf16_f32 v73, v34, v35
    global_store_dwordx2 v24, v[72:73], s[38:39] offset:0
    v_mul_f32 v36, v22, v36
    v_fmac_f32 v36, v23, v56
    v_mul_f32 v37, v22, v37
    v_fmac_f32 v37, v23, v57
    v_mul_f32 v38, v22, v38
    v_fmac_f32 v38, v23, v58
    v_mul_f32 v39, v22, v39
    v_fmac_f32 v39, v23, v59
    v_cvt_pk_bf16_f32 v74, v36, v37
    v_cvt_pk_bf16_f32 v75, v38, v39
    global_store_dwordx2 v24, v[74:75], s[38:39] offset:32
    v_mul_f32 v40, v22, v40
    v_fmac_f32 v40, v23, v60
    v_mul_f32 v41, v22, v41
    v_fmac_f32 v41, v23, v61
    v_mul_f32 v42, v22, v42
    v_fmac_f32 v42, v23, v62
    v_mul_f32 v43, v22, v43
    v_fmac_f32 v43, v23, v63
    v_cvt_pk_bf16_f32 v76, v40, v41
    v_cvt_pk_bf16_f32 v77, v42, v43
    global_store_dwordx2 v24, v[76:77], s[38:39] offset:64
    v_mul_f32 v44, v22, v44
    v_fmac_f32 v44, v23, v64
    v_mul_f32 v45, v22, v45
    v_fmac_f32 v45, v23, v65
    v_mul_f32 v46, v22, v46
    v_fmac_f32 v46, v23, v66
    v_mul_f32 v47, v22, v47
    v_fmac_f32 v47, v23, v67
    v_cvt_pk_bf16_f32 v78, v44, v45
    v_cvt_pk_bf16_f32 v79, v46, v47
    global_store_dwordx2 v24, v[78:79], s[38:39] offset:96
    v_mul_f32 v48, v22, v48
    v_fmac_f32 v48, v23, v68
    v_mul_f32 v49, v22, v49
    v_fmac_f32 v49, v23, v69
    v_mul_f32 v50, v22, v50
    v_fmac_f32 v50, v23, v70
    v_mul_f32 v51, v22, v51
    v_fmac_f32 v51, v23, v71
    v_cvt_pk_bf16_f32 v80, v48, v49
    v_cvt_pk_bf16_f32 v81, v50, v51
    global_store_dwordx2 v24, v[80:81], s[38:39] offset:128
    s_branch pk_g2_g_done
pk_g2_g_loader:
    s_sub_u32 s12, s12, 4
    s_waitcnt lgkmcnt(0)
    v_lshrrev_b32 v15, 4, v0
    v_and_b32 v21, 7, v0
    v_lshrrev_b32 v14, 3, v0
    v_add_u32 v22, 0, v15
    v_and_b32 v22, 7, v22
    v_xor_b32 v22, v21, v22
    v_lshlrev_b32 v10, 4, v22
    v_add_u32 v22, 4, v15
    v_and_b32 v22, 7, v22
    v_xor_b32 v22, v21, v22
    v_lshlrev_b32 v11, 4, v22
    s_mov_b32 s27, 52429
    s_add_u32 s28, s12, 0
    s_lshl_b32 s28, s28, 6
    v_add_u32 v21, s28, v0
    v_mul_lo_u32 v22, v21, s27
    v_lshrrev_b32 v22, 19, v22
    v_mul_u32_u24 v23, 10, v22
    v_sub_u32 v21, v21, v23
    v_and_b32 v23, 0x33, v22
    v_and_b32 v24, 4, v22
    v_lshl_or_b32 v23, v24, 1, v23
    v_and_b32 v24, 8, v22
    v_lshrrev_b32 v24, 1, v24
    v_or_b32 v23, v23, v24
    v_mul_u32_u24 v23, 1280, v23
    v_lshl_add_u32 v6, v21, 4, v23
    s_add_u32 s28, s12, 4
    s_lshl_b32 s28, s28, 6
    v_add_u32 v21, s28, v0
    v_mul_lo_u32 v22, v21, s27
    v_lshrrev_b32 v22, 19, v22
    v_mul_u32_u24 v23, 10, v22
    v_sub_u32 v21, v21, v23
    v_and_b32 v23, 0x33, v22
    v_and_b32 v24, 4, v22
    v_lshl_or_b32 v23, v24, 1, v23
    v_and_b32 v24, 8, v22
    v_lshrrev_b32 v24, 1, v24
    v_or_b32 v23, v23, v24
    v_mul_u32_u24 v23, 1280, v23
    v_lshl_add_u32 v7, v21, 4, v23
    s_add_u32 s28, s12, 8
    s_lshl_b32 s28, s28, 6
    v_add_u32 v21, s28, v0
    v_mul_lo_u32 v22, v21, s27
    v_lshrrev_b32 v22, 19, v22
    v_mul_u32_u24 v23, 10, v22
    v_sub_u32 v21, v21, v23
    v_and_b32 v23, 0x33, v22
    v_and_b32 v24, 4, v22
    v_lshl_or_b32 v23, v24, 1, v23
    v_and_b32 v24, 8, v22
    v_lshrrev_b32 v24, 1, v24
    v_or_b32 v23, v23, v24
    v_mul_u32_u24 v23, 1280, v23
    v_lshl_add_u32 v8, v21, 4, v23
    s_lshl_b32 s32, s12, 11
    s_lshl_b32 s33, s12, 10
    s_cmp_lt_u32 s12, 2
    s_cbranch_scc0 pk_g2_g_loaderB
    s_add_u32 s16, s10, 0xd00000
    s_addc_u32 s17, s11, 0
    s_mov_b32 s18, 6291456
    s_mov_b32 s19, 0x20000
    s_mov_b32 s20, s4
    s_mov_b32 s21, s5
    s_mov_b32 s22, 1966080
    s_mov_b32 s23, 0x20000
    s_movk_i32 s26, 3072
    v_mul_lo_u32 v12, v14, s26
    v_add_u32 v2, v12, v10
    v_add_u32 v3, v12, v11
    v_add_u32 v3, 23552, v3
    s_lshl_b32 s30, s13, 6
    s_lshl_b32 s26, s12, 4
    s_add_u32 s30, s30, s26
    s_mul_i32 s30, s30, 3072
    s_mul_i32 s31, s14, 160
    s_setprio 0
    s_add_u32 m0, s32, 0
    s_nop 0
    buffer_load_dwordx4 v2, s[16:19], s30 offen offset:0 sc1 lds
    buffer_load_dwordx4 v3, s[16:19], s30 offen offset:1024 sc1 lds
    s_add_u32 s30, s30, 128
    s_add_u32 m0, s33, 8192
    s_nop 0
    buffer_load_dwordx4 v6, s[20:23], s31 offen lds
    s_add_u32 m0, s33, 12288
    s_nop 0
    buffer_load_dwordx4 v7, s[20:23], s31 offen lds
    s_add_u32 m0, s33, 16384
    s_nop 0
    buffer_load_dwordx4 v8, s[20:23], s31 offen lds
    s_add_u32 s31, s31, 81920
    s_add_u32 m0, s32, 18432
    s_nop 0
    buffer_load_dwordx4 v2, s[16:19], s30 offen offset:0 sc1 lds
    buffer_load_dwordx4 v3, s[16:19], s30 offen offset:1024 sc1 lds
    s_add_u32 s30, s30, 128
    s_add_u32 m0, s33, 26624
    s_nop 0
    buffer_load_dwordx4 v6, s[20:23], s31 offen lds
    s_add_u32 m0, s33, 30720
    s_nop 0
    buffer_load_dwordx4 v7, s[20:23], s31 offen lds
    s_add_u32 m0, s33, 34816
    s_nop 0
    buffer_load_dwordx4 v8, s[20:23], s31 offen lds
    s_add_u32 s31, s31, 81920
    s_waitcnt vmcnt(5)
    s_barrier
    s_add_u32 m0, s32, 36864
    s_nop 0
    buffer_load_dwordx4 v2, s[16:19], s30 offen offset:0 sc1 lds
    buffer_load_dwordx4 v3, s[16:19], s30 offen offset:1024 sc1 lds
    s_add_u32 s30, s30, 128
    s_add_u32 m0, s33, 45056
    s_nop 0
    buffer_load_dwordx4 v6, s[20:23], s31 offen lds
    s_add_u32 m0, s33, 49152
    s_nop 0
    buffer_load_dwordx4 v7, s[20:23], s31 offen lds
    s_add_u32 m0, s33, 53248
    s_nop 0
    buffer_load_dwordx4 v8, s[20:23], s31 offen lds
    s_add_u32 s31, s31, 81920
    s_add_u32 m0, s32, 55296
    s_nop 0
    buffer_load_dwordx4 v2, s[16:19], s30 offen offset:0 sc1 lds
    buffer_load_dwordx4 v3, s[16:19], s30 offen offset:1024 sc1 lds
    s_add_u32 s30, s30, 128
    s_add_u32 m0, s33, 63488
    s_nop 0
    buffer_load_dwordx4 v6, s[20:23], s31 offen lds
    s_add_u32 m0, s33, 67584
    s_nop 0
    buffer_load_dwordx4 v7, s[20:23], s31 offen lds
    s_add_u32 m0, s33, 71680
    s_nop 0
    buffer_load_dwordx4 v8, s[20:23], s31 offen lds
    s_add_u32 s31, s31, 81920
    s_waitcnt vmcnt(10)
    s_barrier
    s_add_u32 m0, s32, 0
    s_nop 0
    buffer_load_dwordx4 v2, s[16:19], s30 offen offset:0 sc1 lds
    buffer_load_dwordx4 v3, s[16:19], s30 offen offset:1024 sc1 lds
    s_add_u32 s30, s30, 128
    s_add_u32 m0, s33, 8192
    s_nop 0
    buffer_load_dwordx4 v6, s[20:23], s31 offen lds
    s_add_u32 m0, s33, 12288
    s_nop 0
    buffer_load_dwordx4 v7, s[20:23], s31 offen lds
    s_add_u32 m0, s33, 16384
    s_nop 0
    buffer_load_dwordx4 v8, s[20:23], s31 offen lds
    s_add_u32 s31, s31, 81920
    s_waitcnt vmcnt(10)
    s_barrier
    s_add_u32 m0, s32, 18432
    s_nop 0
    buffer_load_dwordx4 v2, s[16:19], s30 offen offset:0 sc1 lds
    buffer_load_dwordx4 v3, s[16:19], s30 offen offset:1024 sc1 lds
    s_add_u32 s30, s30, 128
    s_add_u32 m0, s33, 26624
    s_nop 0
    buffer_load_dwordx4 v6, s[20:23], s31 offen lds
    s_add_u32 m0, s33, 30720
    s_nop 0
    buffer_load_dwordx4 v7, s[20:23], s31 offen lds
    s_add_u32 m0, s33, 34816
    s_nop 0
    buffer_load_dwordx4 v8, s[20:23], s31 offen lds
    s_add_u32 s31, s31, 81920
    s_waitcnt vmcnt(10)
    s_barrier
    s_add_u32 m0, s32, 36864
    s_nop 0
    buffer_load_dwordx4 v2, s[16:19], s30 offen offset:0 sc1 lds
    buffer_load_dwordx4 v3, s[16:19], s30 offen offset:1024 sc1 lds
    s_add_u32 s30, s30, 128
    s_add_u32 m0, s33, 45056
    s_nop 0
    buffer_load_dwordx4 v6, s[20:23], s31 offen lds
    s_add_u32 m0, s33, 49152
    s_nop 0
    buffer_load_dwordx4 v7, s[20:23], s31 offen lds
    s_add_u32 m0, s33, 53248
    s_nop 0
    buffer_load_dwordx4 v8, s[20:23], s31 offen lds
    s_add_u32 s31, s31, 81920
    s_waitcnt vmcnt(10)
    s_barrier
    s_add_u32 m0, s32, 55296
    s_nop 0
    buffer_load_dwordx4 v2, s[16:19], s30 offen offset:0 sc1 lds
    buffer_load_dwordx4 v3, s[16:19], s30 offen offset:1024 sc1 lds
    s_add_u32 s30, s30, 128
    s_add_u32 m0, s33, 63488
    s_nop 0
    buffer_load_dwordx4 v6, s[20:23], s31 offen lds
    s_add_u32 m0, s33, 67584
    s_nop 0
    buffer_load_dwordx4 v7, s[20:23], s31 offen lds
    s_add_u32 m0, s33, 71680
    s_nop 0
    buffer_load_dwordx4 v8, s[20:23], s31 offen lds
    s_add_u32 s31, s31, 81920
    s_waitcnt vmcnt(10)
    s_barrier
    s_add_u32 m0, s32, 0
    s_nop 0
    buffer_load_dwordx4 v2, s[16:19], s30 offen offset:0 sc1 lds
    buffer_load_dwordx4 v3, s[16:19], s30 offen offset:1024 sc1 lds
    s_add_u32 s30, s30, 128
    s_add_u32 m0, s33, 8192
    s_nop 0
    buffer_load_dwordx4 v6, s[20:23], s31 offen lds
    s_add_u32 m0, s33, 12288
    s_nop 0
    buffer_load_dwordx4 v7, s[20:23], s31 offen lds
    s_add_u32 m0, s33, 16384
    s_nop 0
    buffer_load_dwordx4 v8, s[20:23], s31 offen lds
    s_add_u32 s31, s31, 81920
    s_waitcnt vmcnt(10)
    s_barrier
    s_add_u32 m0, s32, 18432
    s_nop 0
    buffer_load_dwordx4 v2, s[16:19], s30 offen offset:0 sc1 lds
    buffer_load_dwordx4 v3, s[16:19], s30 offen offset:1024 sc1 lds
    s_add_u32 s30, s30, 128
    s_add_u32 m0, s33, 26624
    s_nop 0
    buffer_load_dwordx4 v6, s[20:23], s31 offen lds
    s_add_u32 m0, s33, 30720
    s_nop 0
    buffer_load_dwordx4 v7, s[20:23], s31 offen lds
    s_add_u32 m0, s33, 34816
    s_nop 0
    buffer_load_dwordx4 v8, s[20:23], s31 offen lds
    s_add_u32 s31, s31, 81920
    s_waitcnt vmcnt(10)
    s_barrier
    s_add_u32 m0, s32, 36864
    s_nop 0
    buffer_load_dwordx4 v2, s[16:19], s30 offen offset:0 sc1 lds
    buffer_load_dwordx4 v3, s[16:19], s30 offen offset:1024 sc1 lds
    s_add_u32 s30, s30, 128
    s_add_u32 m0, s33, 45056
    s_nop 0
    buffer_load_dwordx4 v6, s[20:23], s31 offen lds
    s_add_u32 m0, s33, 49152
    s_nop 0
    buffer_load_dwordx4 v7, s[20:23], s31 offen lds
    s_add_u32 m0, s33, 53248
    s_nop 0
    buffer_load_dwordx4 v8, s[20:23], s31 offen lds
    s_add_u32 s31, s31, 81920
    s_waitcnt vmcnt(10)
    s_barrier
    s_add_u32 m0, s32, 55296
    s_nop 0
    buffer_load_dwordx4 v2, s[16:19], s30 offen offset:0 sc1 lds
    buffer_load_dwordx4 v3, s[16:19], s30 offen offset:1024 sc1 lds
    s_add_u32 s30, s30, 128
    s_add_u32 m0, s33, 63488
    s_nop 0
    buffer_load_dwordx4 v6, s[20:23], s31 offen lds
    s_add_u32 m0, s33, 67584
    s_nop 0
    buffer_load_dwordx4 v7, s[20:23], s31 offen lds
    s_add_u32 m0, s33, 71680
    s_nop 0
    buffer_load_dwordx4 v8, s[20:23], s31 offen lds
    s_add_u32 s31, s31, 81920
    s_waitcnt vmcnt(10)
    s_barrier
    s_add_u32 m0, s32, 0
    s_nop 0
    buffer_load_dwordx4 v2, s[16:19], s30 offen offset:0 sc1 lds
    buffer_load_dwordx4 v3, s[16:19], s30 offen offset:1024 sc1 lds
    s_add_u32 s30, s30, 128
    s_add_u32 m0, s33, 8192
    s_nop 0
    buffer_load_dwordx4 v6, s[20:23], s31 offen lds
    s_add_u32 m0, s33, 12288
    s_nop 0
    buffer_load_dwordx4 v7, s[20:23], s31 offen lds
    s_add_u32 m0, s33, 16384
    s_nop 0
    buffer_load_dwordx4 v8, s[20:23], s31 offen lds
    s_add_u32 s31, s31, 81920
    s_waitcnt vmcnt(10)
    s_barrier
    s_add_u32 m0, s32, 18432
    s_nop 0
    buffer_load_dwordx4 v2, s[16:19], s30 offen offset:0 sc1 lds
    buffer_load_dwordx4 v3, s[16:19], s30 offen offset:1024 sc1 lds
    s_add_u32 s30, s30, 128
    s_add_u32 m0, s33, 26624
    s_nop 0
    buffer_load_dwordx4 v6, s[20:23], s31 offen lds
    s_add_u32 m0, s33, 30720
    s_nop 0
    buffer_load_dwordx4 v7, s[20:23], s31 offen lds
    s_add_u32 m0, s33, 34816
    s_nop 0
    buffer_load_dwordx4 v8, s[20:23], s31 offen lds
    s_add_u32 s31, s31, 81920
    s_waitcnt vmcnt(10)
    s_barrier
    s_add_u32 m0, s32, 36864
    s_nop 0
    buffer_load_dwordx4 v2, s[16:19], s30 offen offset:0 sc1 lds
    buffer_load_dwordx4 v3, s[16:19], s30 offen offset:1024 sc1 lds
    s_add_u32 s30, s30, 128
    s_add_u32 m0, s33, 45056
    s_nop 0
    buffer_load_dwordx4 v6, s[20:23], s31 offen lds
    s_add_u32 m0, s33, 49152
    s_nop 0
    buffer_load_dwordx4 v7, s[20:23], s31 offen lds
    s_add_u32 m0, s33, 53248
    s_nop 0
    buffer_load_dwordx4 v8, s[20:23], s31 offen lds
    s_add_u32 s31, s31, 81920
    s_waitcnt vmcnt(10)
    s_barrier
    s_add_u32 m0, s32, 55296
    s_nop 0
    buffer_load_dwordx4 v2, s[16:19], s30 offen offset:0 sc1 lds
    buffer_load_dwordx4 v3, s[16:19], s30 offen offset:1024 sc1 lds
    s_add_u32 s30, s30, 128
    s_add_u32 m0, s33, 63488
    s_nop 0
    buffer_load_dwordx4 v6, s[20:23], s31 offen lds
    s_add_u32 m0, s33, 67584
    s_nop 0
    buffer_load_dwordx4 v7, s[20:23], s31 offen lds
    s_add_u32 m0, s33, 71680
    s_nop 0
    buffer_load_dwordx4 v8, s[20:23], s31 offen lds
    s_add_u32 s31, s31, 81920
    s_waitcnt vmcnt(10)
    s_barrier
    s_add_u32 m0, s32, 0
    s_nop 0
    buffer_load_dwordx4 v2, s[16:19], s30 offen offset:0 sc1 lds
    buffer_load_dwordx4 v3, s[16:19], s30 offen offset:1024 sc1 lds
    s_add_u32 s30, s30, 128
    s_add_u32 m0, s33, 8192
    s_nop 0
    buffer_load_dwordx4 v6, s[20:23], s31 offen lds
    s_add_u32 m0, s33, 12288
    s_nop 0
    buffer_load_dwordx4 v7, s[20:23], s31 offen lds
    s_add_u32 m0, s33, 16384
    s_nop 0
    buffer_load_dwordx4 v8, s[20:23], s31 offen lds
    s_add_u32 s31, s31, 81920
    s_waitcnt vmcnt(10)
    s_barrier
    s_add_u32 m0, s32, 18432
    s_nop 0
    buffer_load_dwordx4 v2, s[16:19], s30 offen offset:0 sc1 lds
    buffer_load_dwordx4 v3, s[16:19], s30 offen offset:1024 sc1 lds
    s_add_u32 s30, s30, 128
    s_add_u32 m0, s33, 26624
    s_nop 0
    buffer_load_dwordx4 v6, s[20:23], s31 offen lds
    s_add_u32 m0, s33, 30720
    s_nop 0
    buffer_load_dwordx4 v7, s[20:23], s31 offen lds
    s_add_u32 m0, s33, 34816
    s_nop 0
    buffer_load_dwordx4 v8, s[20:23], s31 offen lds
    s_add_u32 s31, s31, 81920
    s_waitcnt vmcnt(10)
    s_barrier
    s_add_u32 m0, s32, 36864
    s_nop 0
    buffer_load_dwordx4 v2, s[16:19], s30 offen offset:0 sc1 lds
    buffer_load_dwordx4 v3, s[16:19], s30 offen offset:1024 sc1 lds
    s_add_u32 s30, s30, 128
    s_add_u32 m0, s33, 45056
    s_nop 0
    buffer_load_dwordx4 v6, s[20:23], s31 offen lds
    s_add_u32 m0, s33, 49152
    s_nop 0
    buffer_load_dwordx4 v7, s[20:23], s31 offen lds
    s_add_u32 m0, s33, 53248
    s_nop 0
    buffer_load_dwordx4 v8, s[20:23], s31 offen lds
    s_add_u32 s31, s31, 81920
    s_waitcnt vmcnt(10)
    s_barrier
    s_add_u32 m0, s32, 55296
    s_nop 0
    buffer_load_dwordx4 v2, s[16:19], s30 offen offset:0 sc1 lds
    buffer_load_dwordx4 v3, s[16:19], s30 offen offset:1024 sc1 lds
    s_add_u32 s30, s30, 128
    s_add_u32 m0, s33, 63488
    s_nop 0
    buffer_load_dwordx4 v6, s[20:23], s31 offen lds
    s_add_u32 m0, s33, 67584
    s_nop 0
    buffer_load_dwordx4 v7, s[20:23], s31 offen lds
    s_add_u32 m0, s33, 71680
    s_nop 0
    buffer_load_dwordx4 v8, s[20:23], s31 offen lds
    s_add_u32 s31, s31, 81920
    s_waitcnt vmcnt(10)
    s_barrier
    s_add_u32 m0, s32, 0
    s_nop 0
    buffer_load_dwordx4 v2, s[16:19], s30 offen offset:0 sc1 lds
    buffer_load_dwordx4 v3, s[16:19], s30 offen offset:1024 sc1 lds
    s_add_u32 s30, s30, 128
    s_add_u32 m0, s33, 8192
    s_nop 0
    buffer_load_dwordx4 v6, s[20:23], s31 offen lds
    s_add_u32 m0, s33, 12288
    s_nop 0
    buffer_load_dwordx4 v7, s[20:23], s31 offen lds
    s_add_u32 m0, s33, 16384
    s_nop 0
    buffer_load_dwordx4 v8, s[20:23], s31 offen lds
    s_add_u32 s31, s31, 81920
    s_waitcnt vmcnt(10)
    s_barrier
    s_add_u32 m0, s32, 18432
    s_nop 0
    buffer_load_dwordx4 v2, s[16:19], s30 offen offset:0 sc1 lds
    buffer_load_dwordx4 v3, s[16:19], s30 offen offset:1024 sc1 lds
    s_add_u32 s30, s30, 128
    s_add_u32 m0, s33, 26624
    s_nop 0
    buffer_load_dwordx4 v6, s[20:23], s31 offen lds
    s_add_u32 m0, s33, 30720
    s_nop 0
    buffer_load_dwordx4 v7, s[20:23], s31 offen lds
    s_add_u32 m0, s33, 34816
    s_nop 0
    buffer_load_dwordx4 v8, s[20:23], s31 offen lds
    s_add_u32 s31, s31, 81920
    s_waitcnt vmcnt(10)
    s_barrier
    s_add_u32 m0, s32, 36864
    s_nop 0
    buffer_load_dwordx4 v2, s[16:19], s30 offen offset:0 sc1 lds
    buffer_load_dwordx4 v3, s[16:19], s30 offen offset:1024 sc1 lds
    s_add_u32 s30, s30, 128
    s_add_u32 m0, s33, 45056
    s_nop 0
    buffer_load_dwordx4 v6, s[20:23], s31 offen lds
    s_add_u32 m0, s33, 49152
    s_nop 0
    buffer_load_dwordx4 v7, s[20:23], s31 offen lds
    s_add_u32 m0, s33, 53248
    s_nop 0
    buffer_load_dwordx4 v8, s[20:23], s31 offen lds
    s_add_u32 s31, s31, 81920
    s_waitcnt vmcnt(10)
    s_barrier
    s_add_u32 m0, s32, 55296
    s_nop 0
    buffer_load_dwordx4 v2, s[16:19], s30 offen offset:0 sc1 lds
    buffer_load_dwordx4 v3, s[16:19], s30 offen offset:1024 sc1 lds
    s_add_u32 s30, s30, 128
    s_add_u32 m0, s33, 63488
    s_nop 0
    buffer_load_dwordx4 v6, s[20:23], s31 offen lds
    s_add_u32 m0, s33, 67584
    s_nop 0
    buffer_load_dwordx4 v7, s[20:23], s31 offen lds
    s_add_u32 m0, s33, 71680
    s_nop 0
    buffer_load_dwordx4 v8, s[20:23], s31 offen lds
    s_add_u32 s31, s31, 81920
    s_waitcnt vmcnt(10)
    s_barrier
    s_waitcnt vmcnt(5)
    s_barrier
    s_waitcnt vmcnt(0)
    s_barrier
    s_setprio 3
    s_lshr_b32 s40, s96, 3
    s_mul_i32 s40, s40, 25600
    s_lshl_b32 s41, s12, 6
    v_add_u32 v16, s41, v0
    v_min_u32 v16, 199, v16
    v_lshl_add_u32 v16, v16, 7, s40
    global_load_dword v17, v16, s[8:9]
    s_add_u32 s16, s10, 0x1400000
    s_addc_u32 s17, s11, 0
    s_mov_b32 s18, 2621440
    s_mov_b32 s19, 0x20000
    s_mov_b32 s20, s8
    s_mov_b32 s21, s9
    s_mov_b32 s22, 819200
    s_mov_b32 s23, 0x20000
    v_lshrrev_b32 v12, 3, v0
    v_and_b32 v13, 2, v12
    v_and_b32 v21, 7, v0
    v_xor_b32 v13, v13, v21
    v_lshlrev_b32 v12, 7, v12
    v_lshl_add_u32 v2, v13, 4, v12
    v_xor_b32 v13, 4, v13
    v_lshl_add_u32 v3, v13, 4, v12
    s_mul_i32 s30, s13, 81920
    s_lshl_b32 s26, s12, 11
    s_add_u32 s30, s30, s26
    s_mul_i32 s31, s14, 160
    s_add_u32 m0, s33, 8192
    s_nop 0
    buffer_load_dwordx4 v6, s[20:23], s31 offen lds
    s_add_u32 m0, s33, 12288
    s_nop 0
    buffer_load_dwordx4 v7, s[20:23], s31 offen lds
    s_add_u32 m0, s33, 16384
    s_nop 0
    buffer_load_dwordx4 v8, s[20:23], s31 offen lds
    s_add_u32 s31, s31, 81920
    s_add_u32 m0, s33, 26624
    s_nop 0
    buffer_load_dwordx4 v6, s[20:23], s31 offen lds
    s_add_u32 m0, s33, 30720
    s_nop 0
    buffer_load_dwordx4 v7, s[20:23], s31 offen lds
    s_add_u32 m0, s33, 34816
    s_nop 0
    buffer_load_dwordx4 v8, s[20:23], s31 offen lds
    s_add_u32 s31, s31, 81920
    s_add_u32 m0, s33, 45056
    s_nop 0
    buffer_load_dwordx4 v6, s[20:23], s31 offen lds
    s_add_u32 m0, s33, 49152
    s_nop 0
    buffer_load_dwordx4 v7, s[20:23], s31 offen lds
    s_add_u32 m0, s33, 53248
    s_nop 0
    buffer_load_dwordx4 v8, s[20:23], s31 offen lds
    s_add_u32 s31, s31, 81920
    s_cmp_lg_u32 s12, 0
    s_cbranch_scc1 nosync_43
    s_lshr_b32 s27, s13, 2
    s_lshl_b32 s56, s27, 7
    s_add_u32 s56, s56, 0x1f01800
    v_mbcnt_lo_u32_b32 v18, -1, 0
    v_mbcnt_hi_u32_b32 v18, -1, v18
    v_min_u32 v18, 31, v18
    v_lshl_add_u32 v18, v18, 2, s56
    s_mov_b32 s57, 0
fw_44:
    global_load_dword v19, v18, s[10:11] sc1
    s_add_u32 s57, s57, 1
    s_waitcnt vmcnt(0)
    v_cmp_ne_u32 vcc, s100, v19
    s_cbranch_vccz fwok_45
    s_sleep 2
    s_cmp_lt_u32 s57, 0x8000
    s_cbranch_scc1 fw_44
fwok_45:
nosync_43:
    s_barrier
    s_setprio 0
    s_add_u32 m0, s32, 0
    s_nop 0
    buffer_load_dwordx4 v2, s[16:19], s30 offen offset:0 sc1 lds
    buffer_load_dwordx4 v3, s[16:19], s30 offen offset:1024 sc1 lds
    s_add_u32 s30, s30, 8192
    s_add_u32 m0, s32, 18432
    s_nop 0
    buffer_load_dwordx4 v2, s[16:19], s30 offen offset:0 sc1 lds
    buffer_load_dwordx4 v3, s[16:19], s30 offen offset:1024 sc1 lds
    s_add_u32 s30, s30, 8192
    s_waitcnt vmcnt(2)
    s_barrier
    s_add_u32 m0, s32, 36864
    s_nop 0
    buffer_load_dwordx4 v2, s[16:19], s30 offen offset:0 sc1 lds
    buffer_load_dwordx4 v3, s[16:19], s30 offen offset:1024 sc1 lds
    s_add_u32 s30, s30, 8192
    s_add_u32 m0, s32, 55296
    s_nop 0
    buffer_load_dwordx4 v2, s[16:19], s30 offen offset:0 sc1 lds
    buffer_load_dwordx4 v3, s[16:19], s30 offen offset:1024 sc1 lds
    s_add_u32 s30, s30, 8192
    s_add_u32 m0, s33, 63488
    s_nop 0
    buffer_load_dwordx4 v6, s[20:23], s31 offen lds
    s_add_u32 m0, s33, 67584
    s_nop 0
    buffer_load_dwordx4 v7, s[20:23], s31 offen lds
    s_add_u32 m0, s33, 71680
    s_nop 0
    buffer_load_dwordx4 v8, s[20:23], s31 offen lds
    s_add_u32 s31, s31, 81920
    s_waitcnt vmcnt(7)
    s_barrier
    s_add_u32 m0, s32, 0
    s_nop 0
    buffer_load_dwordx4 v2, s[16:19], s30 offen offset:0 sc1 lds
    buffer_load_dwordx4 v3, s[16:19], s30 offen offset:1024 sc1 lds
    s_add_u32 s30, s30, 8192
    s_add_u32 m0, s33, 8192
    s_nop 0
    buffer_load_dwordx4 v6, s[20:23], s31 offen lds
    s_add_u32 m0, s33, 12288
    s_nop 0
    buffer_load_dwordx4 v7, s[20:23], s31 offen lds
    s_add_u32 m0, s33, 16384
    s_nop 0
    buffer_load_dwordx4 v8, s[20:23], s31 offen lds
    s_add_u32 s31, s31, 81920
    s_waitcnt vmcnt(10)
    s_barrier
    s_add_u32 m0, s32, 18432
    s_nop 0
    buffer_load_dwordx4 v2, s[16:19], s30 offen offset:0 sc1 lds
    buffer_load_dwordx4 v3, s[16:19], s30 offen offset:1024 sc1 lds
    s_add_u32 s30, s30, 8192
    s_add_u32 m0, s33, 26624
    s_nop 0
    buffer_load_dwordx4 v6, s[20:23], s31 offen lds
    s_add_u32 m0, s33, 30720
    s_nop 0
    buffer_load_dwordx4 v7, s[20:23], s31 offen lds
    s_add_u32 m0, s33, 34816
    s_nop 0
    buffer_load_dwordx4 v8, s[20:23], s31 offen lds
    s_add_u32 s31, s31, 81920
    s_waitcnt vmcnt(10)
    s_barrier
    s_add_u32 m0, s32, 36864
    s_nop 0
    buffer_load_dwordx4 v2, s[16:19], s30 offen offset:0 sc1 lds
    buffer_load_dwordx4 v3, s[16:19], s30 offen offset:1024 sc1 lds
    s_add_u32 s30, s30, 8192
    s_add_u32 m0, s33, 45056
    s_nop 0
    buffer_load_dwordx4 v6, s[20:23], s31 offen lds
    s_add_u32 m0, s33, 49152
    s_nop 0
    buffer_load_dwordx4 v7, s[20:23], s31 offen lds
    s_add_u32 m0, s33, 53248
    s_nop 0
    buffer_load_dwordx4 v8, s[20:23], s31 offen lds
    s_add_u32 s31, s31, 81920
    s_waitcnt vmcnt(10)
    s_barrier
    s_add_u32 m0, s32, 55296
    s_nop 0
    buffer_load_dwordx4 v2, s[16:19], s30 offen offset:0 sc1 lds
    buffer_load_dwordx4 v3, s[16:19], s30 offen offset:1024 sc1 lds
    s_add_u32 s30, s30, 8192
    s_add_u32 m0, s33, 63488
    s_nop 0
    buffer_load_dwordx4 v6, s[20:23], s31 offen lds
    s_add_u32 m0, s33, 67584
    s_nop 0
    buffer_load_dwordx4 v7, s[20:23], s31 offen lds
    s_add_u32 m0, s33, 71680
    s_nop 0
    buffer_load_dwordx4 v8, s[20:23], s31 offen lds
    s_add_u32 s31, s31, 81920
    s_waitcnt vmcnt(10)
    s_barrier
    s_add_u32 m0, s32, 0
    s_nop 0
    buffer_load_dwordx4 v2, s[16:19], s30 offen offset:0 sc1 lds
    buffer_load_dwordx4 v3, s[16:19], s30 offen offset:1024 sc1 lds
    s_add_u32 s30, s30, 8192
    s_add_u32 m0, s33, 8192
    s_nop 0
    buffer_load_dwordx4 v6, s[20:23], s31 offen lds
    s_add_u32 m0, s33, 12288
    s_nop 0
    buffer_load_dwordx4 v7, s[20:23], s31 offen lds
    s_add_u32 m0, s33, 16384
    s_nop 0
    buffer_load_dwordx4 v8, s[20:23], s31 offen lds
    s_add_u32 s31, s31, 81920
    s_waitcnt vmcnt(10)
    s_barrier
    s_add_u32 m0, s32, 18432
    s_nop 0
    buffer_load_dwordx4 v2, s[16:19], s30 offen offset:0 sc1 lds
    buffer_load_dwordx4 v3, s[16:19], s30 offen offset:1024 sc1 lds
    s_add_u32 s30, s30, 8192
    s_add_u32 m0, s33, 26624
    s_nop 0
    buffer_load_dwordx4 v6, s[20:23], s31 offen lds
    s_add_u32 m0, s33, 30720
    s_nop 0
    buffer_load_dwordx4 v7, s[20:23], s31 offen lds
    s_add_u32 m0, s33, 34816
    s_nop 0
    buffer_load_dwordx4 v8, s[20:23], s31 offen lds
    s_add_u32 s31, s31, 81920
    s_waitcnt vmcnt(10)
    s_barrier
    s_waitcnt vmcnt(5)
    s_barrier
    s_waitcnt vmcnt(0)
    s_barrier
    s_branch pk_g2_g_done
pk_g2_g_loaderB:
    s_add_u32 s16, s10, 0xd00000
    s_addc_u32 s17, s11, 0
    s_mov_b32 s18, 6291456
    s_mov_b32 s19, 0x20000
    s_mov_b32 s20, s4
    s_mov_b32 s21, s5
    s_mov_b32 s22, 1966080
    s_mov_b32 s23, 0x20000
    s_movk_i32 s26, 3072
    v_mul_lo_u32 v12, v14, s26
    v_add_u32 v2, v12, v10
    v_add_u32 v3, v12, v11
    v_add_u32 v3, 23552, v3
    s_lshl_b32 s30, s13, 6
    s_lshl_b32 s26, s12, 4
    s_add_u32 s30, s30, s26
    s_mul_i32 s30, s30, 3072
    s_mul_i32 s31, s14, 160
    s_setprio 0
    s_add_u32 m0, s32, 0
    s_nop 0
    buffer_load_dwordx4 v2, s[16:19], s30 offen offset:0 sc1 lds
    buffer_load_dwordx4 v3, s[16:19], s30 offen offset:1024 sc1 lds
    s_add_u32 s30, s30, 128
    s_add_u32 m0, s33, 8192
    s_nop 0
    buffer_load_dwordx4 v6, s[20:23], s31 offen lds
    s_add_u32 m0, s33, 12288
    s_nop 0
    buffer_load_dwordx4 v7, s[20:23], s31 offen lds
    s_add_u32 s31, s31, 81920
    s_add_u32 m0, s32, 18432
    s_nop 0
    buffer_load_dwordx4 v2, s[16:19], s30 offen offset:0 sc1 lds
    buffer_load_dwordx4 v3, s[16:19], s30 offen offset:1024 sc1 lds
    s_add_u32 s30, s30, 128
    s_add_u32 m0, s33, 26624
    s_nop 0
    buffer_load_dwordx4 v6, s[20:23], s31 offen lds
    s_add_u32 m0, s33, 30720
    s_nop 0
    buffer_load_dwordx4 v7, s[20:23], s31 offen lds
    s_add_u32 s31, s31, 81920
    s_waitcnt vmcnt(4)
    s_barrier
    s_add_u32 m0, s32, 36864
    s_nop 0
    buffer_load_dwordx4 v2, s[16:19], s30 offen offset:0 sc1 lds
    buffer_load_dwordx4 v3, s[16:19], s30 offen offset:1024 sc1 lds
    s_add_u32 s30, s30, 128
    s_add_u32 m0, s33, 45056
    s_nop 0
    buffer_load_dwordx4 v6, s[20:23], s31 offen lds
    s_add_u32 m0, s33, 49152
    s_nop 0
    buffer_load_dwordx4 v7, s[20:23], s31 offen lds
    s_add_u32 s31, s31, 81920
    s_add_u32 m0, s32, 55296
    s_nop 0
    buffer_load_dwordx4 v2, s[16:19], s30 offen offset:0 sc1 lds
    buffer_load_dwordx4 v3, s[16:19], s30 offen offset:1024 sc1 lds
    s_add_u32 s30, s30, 128
    s_add_u32 m0, s33, 63488
    s_nop 0
    buffer_load_dwordx4 v6, s[20:23], s31 offen lds
    s_add_u32 m0, s33, 67584
    s_nop 0
    buffer_load_dwordx4 v7, s[20:23], s31 offen lds
    s_add_u32 s31, s31, 81920
    s_waitcnt vmcnt(8)
    s_barrier
    s_add_u32 m0, s32, 0
    s_nop 0
    buffer_load_dwordx4 v2, s[16:19], s30 offen offset:0 sc1 lds
    buffer_load_dwordx4 v3, s[16:19], s30 offen offset:1024 sc1 lds
    s_add_u32 s30, s30, 128
    s_add_u32 m0, s33, 8192
    s_nop 0
    buffer_load_dwordx4 v6, s[20:23], s31 offen lds
    s_add_u32 m0, s33, 12288
    s_nop 0
    buffer_load_dwordx4 v7, s[20:23], s31 offen lds
    s_add_u32 s31, s31, 81920
    s_waitcnt vmcnt(8)
    s_barrier
    s_add_u32 m0, s32, 18432
    s_nop 0
    buffer_load_dwordx4 v2, s[16:19], s30 offen offset:0 sc1 lds
    buffer_load_dwordx4 v3, s[16:19], s30 offen offset:1024 sc1 lds
    s_add_u32 s30, s30, 128
    s_add_u32 m0, s33, 26624
    s_nop 0
    buffer_load_dwordx4 v6, s[20:23], s31 offen lds
    s_add_u32 m0, s33, 30720
    s_nop 0
    buffer_load_dwordx4 v7, s[20:23], s31 offen lds
    s_add_u32 s31, s31, 81920
    s_waitcnt vmcnt(8)
    s_barrier
    s_add_u32 m0, s32, 36864
    s_nop 0
    buffer_load_dwordx4 v2, s[16:19], s30 offen offset:0 sc1 lds
    buffer_load_dwordx4 v3, s[16:19], s30 offen offset:1024 sc1 lds
    s_add_u32 s30, s30, 128
    s_add_u32 m0, s33, 45056
    s_nop 0
    buffer_load_dwordx4 v6, s[20:23], s31 offen lds
    s_add_u32 m0, s33, 49152
    s_nop 0
    buffer_load_dwordx4 v7, s[20:23], s31 offen lds
    s_add_u32 s31, s31, 81920
    s_waitcnt vmcnt(8)
    s_barrier
    s_add_u32 m0, s32, 55296
    s_nop 0
    buffer_load_dwordx4 v2, s[16:19], s30 offen offset:0 sc1 lds
    buffer_load_dwordx4 v3, s[16:19], s30 offen offset:1024 sc1 lds
    s_add_u32 s30, s30, 128
    s_add_u32 m0, s33, 63488
    s_nop 0
    buffer_load_dwordx4 v6, s[20:23], s31 offen lds
    s_add_u32 m0, s33, 67584
    s_nop 0
    buffer_load_dwordx4 v7, s[20:23], s31 offen lds
    s_add_u32 s31, s31, 81920
    s_waitcnt vmcnt(8)
    s_barrier
    s_add_u32 m0, s32, 0
    s_nop 0
    buffer_load_dwordx4 v2, s[16:19], s30 offen offset:0 sc1 lds
    buffer_load_dwordx4 v3, s[16:19], s30 offen offset:1024 sc1 lds
    s_add_u32 s30, s30, 128
    s_add_u32 m0, s33, 8192
    s_nop 0
    buffer_load_dwordx4 v6, s[20:23], s31 offen lds
    s_add_u32 m0, s33, 12288
    s_nop 0
    buffer_load_dwordx4 v7, s[20:23], s31 offen lds
    s_add_u32 s31, s31, 81920
    s_waitcnt vmcnt(8)
    s_barrier
    s_add_u32 m0, s32, 18432
    s_nop 0
    buffer_load_dwordx4 v2, s[16:19], s30 offen offset:0 sc1 lds
    buffer_load_dwordx4 v3, s[16:19], s30 offen offset:1024 sc1 lds
    s_add_u32 s30, s30, 128
    s_add_u32 m0, s33, 26624
    s_nop 0
    buffer_load_dwordx4 v6, s[20:23], s31 offen lds
    s_add_u32 m0, s33, 30720
    s_nop 0
    buffer_load_dwordx4 v7, s[20:23], s31 offen lds
    s_add_u32 s31, s31, 81920
    s_waitcnt vmcnt(8)
    s_barrier
    s_add_u32 m0, s32, 36864
    s_nop 0
    buffer_load_dwordx4 v2, s[16:19], s30 offen offset:0 sc1 lds
    buffer_load_dwordx4 v3, s[16:19], s30 offen offset:1024 sc1 lds
    s_add_u32 s30, s30, 128
    s_add_u32 m0, s33, 45056
    s_nop 0
    buffer_load_dwordx4 v6, s[20:23], s31 offen lds
    s_add_u32 m0, s33, 49152
    s_nop 0
    buffer_load_dwordx4 v7, s[20:23], s31 offen lds
    s_add_u32 s31, s31, 81920
    s_waitcnt vmcnt(8)
    s_barrier
    s_add_u32 m0, s32, 55296
    s_nop 0
    buffer_load_dwordx4 v2, s[16:19], s30 offen offset:0 sc1 lds
    buffer_load_dwordx4 v3, s[16:19], s30 offen offset:1024 sc1 lds
    s_add_u32 s30, s30, 128
    s_add_u32 m0, s33, 63488
    s_nop 0
    buffer_load_dwordx4 v6, s[20:23], s31 offen lds
    s_add_u32 m0, s33, 67584
    s_nop 0
    buffer_load_dwordx4 v7, s[20:23], s31 offen lds
    s_add_u32 s31, s31, 81920
    s_waitcnt vmcnt(8)
    s_barrier
    s_add_u32 m0, s32, 0
    s_nop 0
    buffer_load_dwordx4 v2, s[16:19], s30 offen offset:0 sc1 lds
    buffer_load_dwordx4 v3, s[16:19], s30 offen offset:1024 sc1 lds
    s_add_u32 s30, s30, 128
    s_add_u32 m0, s33, 8192
    s_nop 0
    buffer_load_dwordx4 v6, s[20:23], s31 offen lds
    s_add_u32 m0, s33, 12288
    s_nop 0
    buffer_load_dwordx4 v7, s[20:23], s31 offen lds
    s_add_u32 s31, s31, 81920
    s_waitcnt vmcnt(8)
    s_barrier
    s_add_u32 m0, s32, 18432
    s_nop 0
    buffer_load_dwordx4 v2, s[16:19], s30 offen offset:0 sc1 lds
    buffer_load_dwordx4 v3, s[16:19], s30 offen offset:1024 sc1 lds
    s_add_u32 s30, s30, 128
    s_add_u32 m0, s33, 26624
    s_nop 0
    buffer_load_dwordx4 v6, s[20:23], s31 offen lds
    s_add_u32 m0, s33, 30720
    s_nop 0
    buffer_load_dwordx4 v7, s[20:23], s31 offen lds
    s_add_u32 s31, s31, 81920
    s_waitcnt vmcnt(8)
    s_barrier
    s_add_u32 m0, s32, 36864
    s_nop 0
    buffer_load_dwordx4 v2, s[16:19], s30 offen offset:0 sc1 lds
    buffer_load_dwordx4 v3, s[16:19], s30 offen offset:1024 sc1 lds
    s_add_u32 s30, s30, 128
    s_add_u32 m0, s33, 45056
    s_nop 0
    buffer_load_dwordx4 v6, s[20:23], s31 offen lds
    s_add_u32 m0, s33, 49152
    s_nop 0
    buffer_load_dwordx4 v7, s[20:23], s31 offen lds
    s_add_u32 s31, s31, 81920
    s_waitcnt vmcnt(8)
    s_barrier
    s_add_u32 m0, s32, 55296
    s_nop 0
    buffer_load_dwordx4 v2, s[16:19], s30 offen offset:0 sc1 lds
    buffer_load_dwordx4 v3, s[16:19], s30 offen offset:1024 sc1 lds
    s_add_u32 s30, s30, 128
    s_add_u32 m0, s33, 63488
    s_nop 0
    buffer_load_dwordx4 v6, s[20:23], s31 offen lds
    s_add_u32 m0, s33, 67584
    s_nop 0
    buffer_load_dwordx4 v7, s[20:23], s31 offen lds
    s_add_u32 s31, s31, 81920
    s_waitcnt vmcnt(8)
    s_barrier
    s_add_u32 m0, s32, 0
    s_nop 0
    buffer_load_dwordx4 v2, s[16:19], s30 offen offset:0 sc1 lds
    buffer_load_dwordx4 v3, s[16:19], s30 offen offset:1024 sc1 lds
    s_add_u32 s30, s30, 128
    s_add_u32 m0, s33, 8192
    s_nop 0
    buffer_load_dwordx4 v6, s[20:23], s31 offen lds
    s_add_u32 m0, s33, 12288
    s_nop 0
    buffer_load_dwordx4 v7, s[20:23], s31 offen lds
    s_add_u32 s31, s31, 81920
    s_waitcnt vmcnt(8)
    s_barrier
    s_add_u32 m0, s32, 18432
    s_nop 0
    buffer_load_dwordx4 v2, s[16:19], s30 offen offset:0 sc1 lds
    buffer_load_dwordx4 v3, s[16:19], s30 offen offset:1024 sc1 lds
    s_add_u32 s30, s30, 128
    s_add_u32 m0, s33, 26624
    s_nop 0
    buffer_load_dwordx4 v6, s[20:23], s31 offen lds
    s_add_u32 m0, s33, 30720
    s_nop 0
    buffer_load_dwordx4 v7, s[20:23], s31 offen lds
    s_add_u32 s31, s31, 81920
    s_waitcnt vmcnt(8)
    s_barrier
    s_add_u32 m0, s32, 36864
    s_nop 0
    buffer_load_dwordx4 v2, s[16:19], s30 offen offset:0 sc1 lds
    buffer_load_dwordx4 v3, s[16:19], s30 offen offset:1024 sc1 lds
    s_add_u32 s30, s30, 128
    s_add_u32 m0, s33, 45056
    s_nop 0
    buffer_load_dwordx4 v6, s[20:23], s31 offen lds
    s_add_u32 m0, s33, 49152
    s_nop 0
    buffer_load_dwordx4 v7, s[20:23], s31 offen lds
    s_add_u32 s31, s31, 81920
    s_waitcnt vmcnt(8)
    s_barrier
    s_add_u32 m0, s32, 55296
    s_nop 0
    buffer_load_dwordx4 v2, s[16:19], s30 offen offset:0 sc1 lds
    buffer_load_dwordx4 v3, s[16:19], s30 offen offset:1024 sc1 lds
    s_add_u32 s30, s30, 128
    s_add_u32 m0, s33, 63488
    s_nop 0
    buffer_load_dwordx4 v6, s[20:23], s31 offen lds
    s_add_u32 m0, s33, 67584
    s_nop 0
    buffer_load_dwordx4 v7, s[20:23], s31 offen lds
    s_add_u32 s31, s31, 81920
    s_waitcnt vmcnt(8)
    s_barrier
    s_add_u32 m0, s32, 0
    s_nop 0
    buffer_load_dwordx4 v2, s[16:19], s30 offen offset:0 sc1 lds
    buffer_load_dwordx4 v3, s[16:19], s30 offen offset:1024 sc1 lds
    s_add_u32 s30, s30, 128
    s_add_u32 m0, s33, 8192
    s_nop 0
    buffer_load_dwordx4 v6, s[20:23], s31 offen lds
    s_add_u32 m0, s33, 12288
    s_nop 0
    buffer_load_dwordx4 v7, s[20:23], s31 offen lds
    s_add_u32 s31, s31, 81920
    s_waitcnt vmcnt(8)
    s_barrier
    s_add_u32 m0, s32, 18432
    s_nop 0
    buffer_load_dwordx4 v2, s[16:19], s30 offen offset:0 sc1 lds
    buffer_load_dwordx4 v3, s[16:19], s30 offen offset:1024 sc1 lds
    s_add_u32 s30, s30, 128
    s_add_u32 m0, s33, 26624
    s_nop 0
    buffer_load_dwordx4 v6, s[20:23], s31 offen lds
    s_add_u32 m0, s33, 30720
    s_nop 0
    buffer_load_dwordx4 v7, s[20:23], s31 offen lds
    s_add_u32 s31, s31, 81920
    s_waitcnt vmcnt(8)
    s_barrier
    s_add_u32 m0, s32, 36864
    s_nop 0
    buffer_load_dwordx4 v2, s[16:19], s30 offen offset:0 sc1 lds
    buffer_load_dwordx4 v3, s[16:19], s30 offen offset:1024 sc1 lds
    s_add_u32 s30, s30, 128
    s_add_u32 m0, s33, 45056
    s_nop 0
    buffer_load_dwordx4 v6, s[20:23], s31 offen lds
    s_add_u32 m0, s33, 49152
    s_nop 0
    buffer_load_dwordx4 v7, s[20:23], s31 offen lds
    s_add_u32 s31, s31, 81920
    s_waitcnt vmcnt(8)
    s_barrier
    s_add_u32 m0, s32, 55296
    s_nop 0
    buffer_load_dwordx4 v2, s[16:19], s30 offen offset:0 sc1 lds
    buffer_load_dwordx4 v3, s[16:19], s30 offen offset:1024 sc1 lds
    s_add_u32 s30, s30, 128
    s_add_u32 m0, s33, 63488
    s_nop 0
    buffer_load_dwordx4 v6, s[20:23], s31 offen lds
    s_add_u32 m0, s33, 67584
    s_nop 0
    buffer_load_dwordx4 v7, s[20:23], s31 offen lds
    s_add_u32 s31, s31, 81920
    s_waitcnt vmcnt(8)
    s_barrier
    s_waitcnt vmcnt(4)
    s_barrier
    s_waitcnt vmcnt(0)
    s_barrier
    s_setprio 3
    s_lshr_b32 s40, s96, 3
    s_mul_i32 s40, s40, 25600
    s_lshl_b32 s41, s12, 6
    v_add_u32 v16, s41, v0
    v_min_u32 v16, 199, v16
    v_lshl_add_u32 v16, v16, 7, s40
    global_load_dword v17, v16, s[8:9]
    s_add_u32 s16, s10, 0x1400000
    s_addc_u32 s17, s11, 0
    s_mov_b32 s18, 2621440
    s_mov_b32 s19, 0x20000
    s_mov_b32 s20, s8
    s_mov_b32 s21, s9
    s_mov_b32 s22, 819200
    s_mov_b32 s23, 0x20000
    v_lshrrev_b32 v12, 3, v0
    v_and_b32 v13, 2, v12
    v_and_b32 v21, 7, v0
    v_xor_b32 v13, v13, v21
    v_lshlrev_b32 v12, 7, v12
    v_lshl_add_u32 v2, v13, 4, v12
    v_xor_b32 v13, 4, v13
    v_lshl_add_u32 v3, v13, 4, v12
    s_mul_i32 s30, s13, 81920
    s_lshl_b32 s26, s12, 11
    s_add_u32 s30, s30, s26
    s_mul_i32 s31, s14, 160
    s_add_u32 m0, s33, 8192
    s_nop 0
    buffer_load_dwordx4 v6, s[20:23], s31 offen lds
    s_add_u32 m0, s33, 12288
    s_nop 0
    buffer_load_dwordx4 v7, s[20:23], s31 offen lds
    s_add_u32 s31, s31, 81920
    s_add_u32 m0, s33, 26624
    s_nop 0
    buffer_load_dwordx4 v6, s[20:23], s31 offen lds
    s_add_u32 m0, s33, 30720
    s_nop 0
    buffer_load_dwordx4 v7, s[20:23], s31 offen lds
    s_add_u32 s31, s31, 81920
    s_add_u32 m0, s33, 45056
    s_nop 0
    buffer_load_dwordx4 v6, s[20:23], s31 offen lds
    s_add_u32 m0, s33, 49152
    s_nop 0
    buffer_load_dwordx4 v7, s[20:23], s31 offen lds
    s_add_u32 s31, s31, 81920
    s_barrier
    s_setprio 0
    s_add_u32 m0, s32, 0
    s_nop 0
    buffer_load_dwordx4 v2, s[16:19], s30 offen offset:0 sc1 lds
    buffer_load_dwordx4 v3, s[16:19], s30 offen offset:1024 sc1 lds
    s_add_u32 s30, s30, 8192
    s_add_u32 m0, s32, 18432
    s_nop 0
    buffer_load_dwordx4 v2, s[16:19], s30 offen offset:0 sc1 lds
    buffer_load_dwordx4 v3, s[16:19], s30 offen offset:1024 sc1 lds
    s_add_u32 s30, s30, 8192
    s_waitcnt vmcnt(2)
    s_barrier
    s_add_u32 m0, s32, 36864
    s_nop 0
    buffer_load_dwordx4 v2, s[16:19], s30 offen offset:0 sc1 lds
    buffer_load_dwordx4 v3, s[16:19], s30 offen offset:1024 sc1 lds
    s_add_u32 s30, s30, 8192
    s_add_u32 m0, s32, 55296
    s_nop 0
    buffer_load_dwordx4 v2, s[16:19], s30 offen offset:0 sc1 lds
    buffer_load_dwordx4 v3, s[16:19], s30 offen offset:1024 sc1 lds
    s_add_u32 s30, s30, 8192
    s_add_u32 m0, s33, 63488
    s_nop 0
    buffer_load_dwordx4 v6, s[20:23], s31 offen lds
    s_add_u32 m0, s33, 67584
    s_nop 0
    buffer_load_dwordx4 v7, s[20:23], s31 offen lds
    s_add_u32 s31, s31, 81920
    s_waitcnt vmcnt(6)
    s_barrier
    s_add_u32 m0, s32, 0
    s_nop 0
    buffer_load_dwordx4 v2, s[16:19], s30 offen offset:0 sc1 lds
    buffer_load_dwordx4 v3, s[16:19], s30 offen offset:1024 sc1 lds
    s_add_u32 s30, s30, 8192
    s_add_u32 m0, s33, 8192
    s_nop 0
    buffer_load_dwordx4 v6, s[20:23], s31 offen lds
    s_add_u32 m0, s33, 12288
    s_nop 0
    buffer_load_dwordx4 v7, s[20:23], s31 offen lds
    s_add_u32 s31, s31, 81920
    s_waitcnt vmcnt(8)
    s_barrier
    s_add_u32 m0, s32, 18432
    s_nop 0
    buffer_load_dwordx4 v2, s[16:19], s30 offen offset:0 sc1 lds
    buffer_load_dwordx4 v3, s[16:19], s30 offen offset:1024 sc1 lds
    s_add_u32 s30, s30, 8192
    s_add_u32 m0, s33, 26624
    s_nop 0
    buffer_load_dwordx4 v6, s[20:23], s31 offen lds
    s_add_u32 m0, s33, 30720
    s_nop 0
    buffer_load_dwordx4 v7, s[20:23], s31 offen lds
    s_add_u32 s31, s31, 81920
    s_waitcnt vmcnt(8)
    s_barrier
    s_add_u32 m0, s32, 36864
    s_nop 0
    buffer_load_dwordx4 v2, s[16:19], s30 offen offset:0 sc1 lds
    buffer_load_dwordx4 v3, s[16:19], s30 offen offset:1024 sc1 lds
    s_add_u32 s30, s30, 8192
    s_add_u32 m0, s33, 45056
    s_nop 0
    buffer_load_dwordx4 v6, s[20:23], s31 offen lds
    s_add_u32 m0, s33, 49152
    s_nop 0
    buffer_load_dwordx4 v7, s[20:23], s31 offen lds
    s_add_u32 s31, s31, 81920
    s_waitcnt vmcnt(8)
    s_barrier
    s_add_u32 m0, s32, 55296
    s_nop 0
    buffer_load_dwordx4 v2, s[16:19], s30 offen offset:0 sc1 lds
    buffer_load_dwordx4 v3, s[16:19], s30 offen offset:1024 sc1 lds
    s_add_u32 s30, s30, 8192
    s_add_u32 m0, s33, 63488
    s_nop 0
    buffer_load_dwordx4 v6, s[20:23], s31 offen lds
    s_add_u32 m0, s33, 67584
    s_nop 0
    buffer_load_dwordx4 v7, s[20:23], s31 offen lds
    s_add_u32 s31, s31, 81920
    s_waitcnt vmcnt(8)
    s_barrier
    s_add_u32 m0, s32, 0
    s_nop 0
    buffer_load_dwordx4 v2, s[16:19], s30 offen offset:0 sc1 lds
    buffer_load_dwordx4 v3, s[16:19], s30 offen offset:1024 sc1 lds
    s_add_u32 s30, s30, 8192
    s_add_u32 m0, s33, 8192
    s_nop 0
    buffer_load_dwordx4 v6, s[20:23], s31 offen lds
    s_add_u32 m0, s33, 12288
    s_nop 0
    buffer_load_dwordx4 v7, s[20:23], s31 offen lds
    s_add_u32 s31, s31, 81920
    s_waitcnt vmcnt(8)
    s_barrier
    s_add_u32 m0, s32, 18432
    s_nop 0
    buffer_load_dwordx4 v2, s[16:19], s30 offen offset:0 sc1 lds
    buffer_load_dwordx4 v3, s[16:19], s30 offen offset:1024 sc1 lds
    s_add_u32 s30, s30, 8192
    s_add_u32 m0, s33, 26624
    s_nop 0
    buffer_load_dwordx4 v6, s[20:23], s31 offen lds
    s_add_u32 m0, s33, 30720
    s_nop 0
    buffer_load_dwordx4 v7, s[20:23], s31 offen lds
    s_add_u32 s31, s31, 81920
    s_waitcnt vmcnt(8)
    s_barrier
    s_waitcnt vmcnt(4)
    s_barrier
    s_waitcnt vmcnt(0)
    s_barrier
pk_g2_g_done:
pk_exit:
    s_endpgm
.section .rodata,"a"
.p2align 6
.amdhsa_kernel gated_mix__softmax_full_mha__mixer_channel_mlp__prompt_kernel
  .amdhsa_next_free_vgpr 128
  .amdhsa_next_free_sgpr 102
  .amdhsa_accum_offset 128
  .amdhsa_group_segment_fixed_size 0
  .amdhsa_kernarg_size 96
  .amdhsa_user_sgpr_count 2
  .amdhsa_user_sgpr_kernarg_segment_ptr 1
  .amdhsa_system_sgpr_workgroup_id_x 1
.end_amdhsa_kernel
```
